```python
import torch

def _softmax(x, axis=-1):
    return torch.softmax(x, dim=axis)
def _gelu(x):
    return torch.nn.functional.gelu(x, approximate="tanh")
def _silu(x):
    return torch.nn.functional.silu(x)
def _sigmoid(x):
    return torch.sigmoid(x)
def _layernorm(x, axis=-1, eps=1e-5):
    m = x.mean(dim=axis, keepdim=True)
    v = x.var(dim=axis, keepdim=True, unbiased=False)
    return (x - m) / torch.sqrt(v + eps)
def _scatter_add(tgt, idx, src, axis=0):
    return tgt.clone().index_add_(axis, idx, src)
def _segment_sum(src, seg, n):
    out = torch.zeros((n,) + src.shape[1:], dtype=src.dtype)
    return out.index_add_(0, seg, src)
def _pad(x, pw):
    flat = tuple(v for pair in reversed(pw) for v in pair)
    return torch.nn.functional.pad(x, flat)

kernel_name = 'concat_heads__gqa_block_cached__mha_block_cached__near_ridge'

def setup_inputs():

    _w = (lambda a: (lambda t: t.to(torch.bfloat16) if t.is_floating_point() else t)(torch.as_tensor(a)))
    def _A_setup():
        B, Sq, D = 16, 32, 512
        Hq, Hkv, Sk, Dh = 32, 8, 512, 128
        assert Hq % Hkv == 0, (Hq, Hkv)
        return {
            "x": _w((lambda *s: torch.randn(*s, dtype=torch.bfloat16) * 0.8)(B, Sq, D)),
            "k_cache": _w((lambda *s: torch.randn(*s, dtype=torch.bfloat16) * 0.8)(B, Hkv, Sk, Dh)),
            "v_cache": _w((lambda *s: torch.randn(*s, dtype=torch.bfloat16) * 0.05)(B, Hkv, Sk, Dh)),
            "wq": _w((lambda *s: torch.randn(*s, dtype=torch.bfloat16) * 0.8)(D, Hq * Dh) * (D ** -0.5)),
            "wo": _w((lambda *s: torch.randn(*s, dtype=torch.bfloat16) * 0.05)(Hq * Dh, D) * ((Hq * Dh) ** -0.5)),
        }
    _A_in = _A_setup()

    def _B_setup():
        B, Sq, D = 16, 32, 512
        H, Sk, Dh = 32, 512, 128
        return {
            "x": _w((lambda *s: torch.randn(*s, dtype=torch.bfloat16) * 0.8)(B, Sq, D)),
            "k_cache": _w((lambda *s: torch.randn(*s, dtype=torch.bfloat16) * 0.8)(B, H, Sk, Dh)),
            "v_cache": _w((lambda *s: torch.randn(*s, dtype=torch.bfloat16) * 0.05)(B, H, Sk, Dh)),
            "wq": _w((lambda *s: torch.randn(*s, dtype=torch.bfloat16) * 0.8)(D, H * Dh) * (D ** -0.5)),
            "wo": _w((lambda *s: torch.randn(*s, dtype=torch.bfloat16) * 0.05)(H * Dh, D) * ((H * Dh) ** -0.5)),
        }
    _B_in = _B_setup()

    return {
        "A_x": _A_in["x"],
        "A_k_cache": _A_in["k_cache"],
        "A_v_cache": _A_in["v_cache"],
        "A_wq": _A_in["wq"],
        "A_wo": _A_in["wo"],
        "B_x": _B_in["x"],
        "B_k_cache": _B_in["k_cache"],
        "B_v_cache": _B_in["v_cache"],
        "B_wq": _B_in["wq"],
        "B_wo": _B_in["wo"],
    }

def reference(A_x, A_k_cache, A_v_cache, A_wq, A_wo, B_x, B_k_cache, B_v_cache, B_wq, B_wo):
    def _A_ref(x, k_cache, v_cache, wq, wo):
        B, Sq, D = x.shape
        Hq, Dh = 32, 128
        Hkv = k_cache.shape[1]
        rep = Hq // Hkv
        q = (lambda x, *d: x.permute(*d))((x @ wq).reshape(B, Sq, Hq, Dh), 0, 2, 1, 3)
        k = (lambda x, n, axis: torch.repeat_interleave(x, n, dim=axis))(k_cache, rep, axis=1)
        v = (lambda x, n, axis: torch.repeat_interleave(x, n, dim=axis))(v_cache, rep, axis=1)
        scores = torch.einsum("bhqd,bhkd->bhqk", q, k) * (Dh ** -0.5)
        p = _softmax(scores, axis=-1)
        o = torch.einsum("bhqk,bhkd->bhqd", p, v)
        return (lambda x, *d: x.permute(*d))(o, 0, 2, 1, 3).reshape(B, Sq, Hq * Dh) @ wo

    def _B_ref(x, k_cache, v_cache, wq, wo):
        B, Sq, D = x.shape
        H, Dh = 32, 128
        q = (lambda x, *d: x.permute(*d))((x @ wq).reshape(B, Sq, H, Dh), 0, 2, 1, 3)
        scores = torch.einsum("bhqd,bhkd->bhqk", q, k_cache) * (Dh ** -0.5)
        p = _softmax(scores, axis=-1)
        o = torch.einsum("bhqk,bhkd->bhqd", p, v_cache)
        return (lambda x, *d: x.permute(*d))(o, 0, 2, 1, 3).reshape(B, Sq, H * Dh) @ wo

    a = _A_ref(A_x, A_k_cache, A_v_cache, A_wq, A_wo)
    b = _B_ref(B_x, B_k_cache, B_v_cache, B_wq, B_wo)
    return torch.concatenate([a, b], axis=-1)
```

```asm
; @launch grid=(256,1,1) block=(256,1,1) lds=133120
.amdgcn_target "amdgcn-amd-amdhsa--gfx950"
.text
.p2align 8
.globl concat_heads__gqa_block_cached__mha_block_cached__near_ridge_kernel
.type concat_heads__gqa_block_cached__mha_block_cached__near_ridge_kernel,@function
concat_heads__gqa_block_cached__mha_block_cached__near_ridge_kernel:
    s_cmp_ge_u32 s2, 256
    s_cbranch_scc1 K_END
    s_load_dwordx16 s[8:23], s[0:1], 0
    s_load_dwordx8 s[24:31], s[0:1], 64
    s_load_dwordx2 s[32:33], s[0:1], 96
    v_lshrrev_b32 v1, 6, v0
    v_and_b32 v10, 63, v0
    v_readfirstlane_b32 s3, v1
    s_and_b32 s4, s2, 7
    s_lshr_b32 s5, s2, 3
    s_mul_i32 s98, s3, 33280
    s_mov_b32 s38, 0x05040100
    s_mov_b32 s39, 0x07060302
    s_mov_b32 s96, 0x3e0293ee
    v_and_b32 v11, 15, v10
    v_lshrrev_b32 v12, 4, v10
    v_lshlrev_b32 v0, 4, v10
    v_lshlrev_b32 v13, 2, v12
    v_xor_b32 v13, v13, v11
    v_lshlrev_b32 v13, 4, v13
    v_lshl_add_u32 v1, v12, 10, v13
    v_lshrrev_b32 v13, 2, v11
    v_mul_u32_u24 v13, 1040, v13
    v_and_b32 v14, 3, v11
    v_lshl_add_u32 v13, v14, 8, v13
    v_xor_b32 v14, v14, v12
    v_lshl_add_u32 v13, v14, 6, v13
    v_add_u32 v2, s98, v13
    v_lshlrev_b32 v13, 4, v11
    v_lshl_add_u32 v3, v12, 18, v13
    v_lshl_add_u32 v4, v12, 15, v13
    s_waitcnt lgkmcnt(0)
    s_lshr_b32 s6, s5, 2
    s_and_b32 s6, s6, 3
    s_lshl_b32 s6, s6, 2
    s_add_u32 s34, s6, s3
    s_and_b32 s37, s5, 3
    v_add_u32 v5, s98, v0
    v_add_u32 v6, 0x10000, v0
    v_add_u32 v7, 0x20000, v0
    v_mov_b32 v8, 0
    v_lshrrev_b32 v9, 2, v0
    s_and_b32 s84, s5, 16
    s_cmp_lt_u32 s5, 16
    s_cbranch_scc1 A_PATH
    s_mov_b32 s35, s34
    s_lshl_b32 s7, s4, 2
    s_add_u32 s36, s37, s7
    s_lshl_b32 s6, s3, 16
    s_lshl_b32 s7, s36, 8
    s_add_u32 s6, s6, s7
    s_sub_u32 s7, 0x400000, s6
    s_add_u32 s40, s24, s6
    s_addc_u32 s41, s25, 0
    s_and_b32 s41, s41, 0xffff
    s_mov_b32 s42, s7
    s_mov_b32 s43, 0x20000
    s_lshl_b32 s6, s35, 15
    s_add_u32 s44, s18, s6
    s_addc_u32 s45, s19, 0
    s_and_b32 s45, s45, 0xffff
    s_mov_b32 s46, 32768
    s_mov_b32 s47, 0x20000
    s_add_u32 m0, s98, 0x0
    s_mov_b32 s97, 0x0
    buffer_load_dwordx4 v1, s[44:47], s97 offen lds
    s_add_u32 m0, s98, 0x410
    s_mov_b32 s97, 0x1000
    buffer_load_dwordx4 v1, s[44:47], s97 offen lds
    s_add_u32 m0, s98, 0x820
    s_mov_b32 s97, 0x2000
    buffer_load_dwordx4 v1, s[44:47], s97 offen lds
    s_add_u32 m0, s98, 0xc30
    s_mov_b32 s97, 0x3000
    buffer_load_dwordx4 v1, s[44:47], s97 offen lds
    s_add_u32 m0, s98, 0x1040
    s_mov_b32 s97, 0x4000
    buffer_load_dwordx4 v1, s[44:47], s97 offen lds
    s_add_u32 m0, s98, 0x1450
    s_mov_b32 s97, 0x5000
    buffer_load_dwordx4 v1, s[44:47], s97 offen lds
    s_add_u32 m0, s98, 0x1860
    s_mov_b32 s97, 0x6000
    buffer_load_dwordx4 v1, s[44:47], s97 offen lds
    s_add_u32 m0, s98, 0x1c70
    s_mov_b32 s97, 0x7000
    buffer_load_dwordx4 v1, s[44:47], s97 offen lds
    s_mov_b32 s97, 0x0
    buffer_load_dwordx4 v[96:99], v3, s[40:43], s97 offen
    s_mov_b32 s97, 0x2000
    buffer_load_dwordx4 v[100:103], v3, s[40:43], s97 offen
    s_mov_b32 s97, 0x4000
    buffer_load_dwordx4 v[104:107], v3, s[40:43], s97 offen
    s_mov_b32 s97, 0x6000
    buffer_load_dwordx4 v[108:111], v3, s[40:43], s97 offen
    s_mov_b32 s97, 0x8000
    buffer_load_dwordx4 v[112:115], v3, s[40:43], s97 offen
    s_mov_b32 s97, 0xa000
    buffer_load_dwordx4 v[116:119], v3, s[40:43], s97 offen
    s_mov_b32 s97, 0xc000
    buffer_load_dwordx4 v[120:123], v3, s[40:43], s97 offen
    s_mov_b32 s97, 0xe000
    buffer_load_dwordx4 v[124:127], v3, s[40:43], s97 offen
    s_add_u32 s6, s35, 16
    s_lshl_b32 s6, s6, 5
    s_add_u32 s6, s6, s36
    s_lshr_b32 s7, s6, 2
    s_lshl_b32 s7, s7, 7
    s_and_b32 s80, s36, 3
    s_lshl_b32 s80, s80, 2
    s_add_u32 s80, s80, s7
    s_lshl_b32 s6, s6, 13
    s_add_u32 s6, s6, 0x800000
    s_add_u32 s64, s32, s6
    s_addc_u32 s65, s33, 0
    s_and_b32 s65, s65, 0xffff
    s_mov_b32 s66, 8192
    s_mov_b32 s67, 0x20000
    s_add_u32 s6, s34, 16
    s_lshl_b32 s6, s6, 2
    s_add_u32 s6, s6, s37
    s_lshl_b32 s6, s6, 5
    s_add_u32 s6, s6, s4
    s_lshl_b32 s6, s6, 2
    s_add_u32 s81, s6, 32768
    s_mov_b32 s6, 0x2800000
    s_add_u32 s68, s32, s6
    s_addc_u32 s69, s33, 0
    s_and_b32 s69, s69, 0xffff
    s_mov_b32 s70, 49152
    s_mov_b32 s71, 0x20000
    s_mov_b64 exec, 1
    buffer_store_dword v8, v8, s[68:71], s80 offen sc1
    s_mov_b64 exec, -1
    s_mov_b64 exec, 1
    buffer_store_dword v8, v8, s[68:71], s81 offen sc1
    s_mov_b64 exec, -1
    s_mov_b32 s6, 0
    s_add_u32 s72, s30, s6
    s_addc_u32 s73, s31, 0
    s_and_b32 s73, s73, 0xffff
    s_mov_b32 s74, 256
    s_mov_b32 s75, 0x20000
    s_add_u32 m0, s98, 0x2080
    s_mov_b32 s97, 0x100
    buffer_load_dwordx4 v1, s[44:47], s97 offen lds
    s_add_u32 m0, s98, 0x2490
    s_mov_b32 s97, 0x1100
    buffer_load_dwordx4 v1, s[44:47], s97 offen lds
    s_add_u32 m0, s98, 0x28a0
    s_mov_b32 s97, 0x2100
    buffer_load_dwordx4 v1, s[44:47], s97 offen lds
    s_add_u32 m0, s98, 0x2cb0
    s_mov_b32 s97, 0x3100
    buffer_load_dwordx4 v1, s[44:47], s97 offen lds
    s_add_u32 m0, s98, 0x30c0
    s_mov_b32 s97, 0x4100
    buffer_load_dwordx4 v1, s[44:47], s97 offen lds
    s_add_u32 m0, s98, 0x34d0
    s_mov_b32 s97, 0x5100
    buffer_load_dwordx4 v1, s[44:47], s97 offen lds
    s_add_u32 m0, s98, 0x38e0
    s_mov_b32 s97, 0x6100
    buffer_load_dwordx4 v1, s[44:47], s97 offen lds
    s_add_u32 m0, s98, 0x3cf0
    s_mov_b32 s97, 0x7100
    buffer_load_dwordx4 v1, s[44:47], s97 offen lds
    s_mov_b32 s97, 0x100000
    buffer_load_dwordx4 v[128:131], v3, s[40:43], s97 offen
    s_mov_b32 s97, 0x102000
    buffer_load_dwordx4 v[132:135], v3, s[40:43], s97 offen
    s_mov_b32 s97, 0x104000
    buffer_load_dwordx4 v[136:139], v3, s[40:43], s97 offen
    s_mov_b32 s97, 0x106000
    buffer_load_dwordx4 v[140:143], v3, s[40:43], s97 offen
    s_mov_b32 s97, 0x108000
    buffer_load_dwordx4 v[144:147], v3, s[40:43], s97 offen
    s_mov_b32 s97, 0x10a000
    buffer_load_dwordx4 v[148:151], v3, s[40:43], s97 offen
    s_mov_b32 s97, 0x10c000
    buffer_load_dwordx4 v[152:155], v3, s[40:43], s97 offen
    s_mov_b32 s97, 0x10e000
    buffer_load_dwordx4 v[156:159], v3, s[40:43], s97 offen
    s_lshl_b32 s90, s35, 22
    s_lshl_b32 s7, s36, 17
    s_add_u32 s90, s90, s7
    s_add_u32 s52, s20, s90
    s_addc_u32 s53, s21, 0
    s_and_b32 s53, s53, 0xffff
    s_mov_b32 s54, 131072
    s_mov_b32 s55, 0x20000
    s_add_u32 s56, s22, s90
    s_addc_u32 s57, s23, 0
    s_and_b32 s57, s57, 0xffff
    s_mov_b32 s58, 131072
    s_mov_b32 s59, 0x20000
    s_mul_i32 s7, s36, 3
    s_mul_i32 s91, s35, 5
    s_add_u32 s7, s7, s91
    s_and_b32 s7, s7, 31
    s_lshl_b32 s99, s7, 12
    s_waitcnt vmcnt(26)
    ds_read_b128 a[0:3], v2
    ds_read_b128 a[4:7], v2 offset:16
    ds_read_b128 a[8:11], v2 offset:32
    ds_read_b128 a[12:15], v2 offset:48
    ds_read_b128 a[16:19], v2 offset:4160
    ds_read_b128 a[20:23], v2 offset:4176
    ds_read_b128 a[24:27], v2 offset:4192
    ds_read_b128 a[28:31], v2 offset:4208
    s_waitcnt vmcnt(18)
    v_perm_b32 v32, v100, v96, s38
    v_perm_b32 v33, v108, v104, s38
    v_perm_b32 v34, v116, v112, s38
    v_perm_b32 v35, v124, v120, s38
    v_perm_b32 v36, v100, v96, s39
    v_perm_b32 v37, v108, v104, s39
    v_perm_b32 v38, v116, v112, s39
    v_perm_b32 v39, v124, v120, s39
    v_perm_b32 v40, v101, v97, s38
    v_perm_b32 v41, v109, v105, s38
    v_perm_b32 v42, v117, v113, s38
    v_perm_b32 v43, v125, v121, s38
    v_perm_b32 v44, v101, v97, s39
    v_perm_b32 v45, v109, v105, s39
    v_perm_b32 v46, v117, v113, s39
    v_perm_b32 v47, v125, v121, s39
    v_perm_b32 v48, v102, v98, s38
    v_perm_b32 v49, v110, v106, s38
    v_perm_b32 v50, v118, v114, s38
    v_perm_b32 v51, v126, v122, s38
    v_perm_b32 v52, v102, v98, s39
    v_perm_b32 v53, v110, v106, s39
    v_perm_b32 v54, v118, v114, s39
    v_perm_b32 v55, v126, v122, s39
    v_perm_b32 v56, v103, v99, s38
    v_perm_b32 v57, v111, v107, s38
    v_perm_b32 v58, v119, v115, s38
    v_perm_b32 v59, v127, v123, s38
    v_perm_b32 v60, v103, v99, s39
    v_perm_b32 v61, v111, v107, s39
    v_perm_b32 v62, v119, v115, s39
    v_perm_b32 v63, v127, v123, s39
    s_waitcnt lgkmcnt(0)
    ds_write_b128 v5, v[32:35]
    ds_write_b128 v5, v[36:39] offset:1024
    ds_write_b128 v5, v[40:43] offset:2048
    ds_write_b128 v5, v[44:47] offset:3072
    ds_write_b128 v5, v[48:51] offset:4096
    ds_write_b128 v5, v[52:55] offset:5120
    ds_write_b128 v5, v[56:59] offset:6144
    ds_write_b128 v5, v[60:63] offset:7168
    s_add_u32 m0, s98, 0x4100
    s_mov_b32 s97, 0x200
    buffer_load_dwordx4 v1, s[44:47], s97 offen lds
    s_add_u32 m0, s98, 0x4510
    s_mov_b32 s97, 0x1200
    buffer_load_dwordx4 v1, s[44:47], s97 offen lds
    s_add_u32 m0, s98, 0x4920
    s_mov_b32 s97, 0x2200
    buffer_load_dwordx4 v1, s[44:47], s97 offen lds
    s_add_u32 m0, s98, 0x4d30
    s_mov_b32 s97, 0x3200
    buffer_load_dwordx4 v1, s[44:47], s97 offen lds
    s_add_u32 m0, s98, 0x5140
    s_mov_b32 s97, 0x4200
    buffer_load_dwordx4 v1, s[44:47], s97 offen lds
    s_add_u32 m0, s98, 0x5550
    s_mov_b32 s97, 0x5200
    buffer_load_dwordx4 v1, s[44:47], s97 offen lds
    s_add_u32 m0, s98, 0x5960
    s_mov_b32 s97, 0x6200
    buffer_load_dwordx4 v1, s[44:47], s97 offen lds
    s_add_u32 m0, s98, 0x5d70
    s_mov_b32 s97, 0x7200
    buffer_load_dwordx4 v1, s[44:47], s97 offen lds
    s_mov_b32 s97, 0x200000
    buffer_load_dwordx4 v[160:163], v3, s[40:43], s97 offen
    s_mov_b32 s97, 0x202000
    buffer_load_dwordx4 v[164:167], v3, s[40:43], s97 offen
    s_mov_b32 s97, 0x204000
    buffer_load_dwordx4 v[168:171], v3, s[40:43], s97 offen
    s_mov_b32 s97, 0x206000
    buffer_load_dwordx4 v[172:175], v3, s[40:43], s97 offen
    s_mov_b32 s97, 0x208000
    buffer_load_dwordx4 v[176:179], v3, s[40:43], s97 offen
    s_mov_b32 s97, 0x20a000
    buffer_load_dwordx4 v[180:183], v3, s[40:43], s97 offen
    s_mov_b32 s97, 0x20c000
    buffer_load_dwordx4 v[184:187], v3, s[40:43], s97 offen
    s_mov_b32 s97, 0x20e000
    buffer_load_dwordx4 v[188:191], v3, s[40:43], s97 offen
    s_waitcnt lgkmcnt(0)
    s_waitcnt vmcnt(24)
    ds_read_b128 a[32:35], v2 offset:8320
    ds_read_b128 a[36:39], v2 offset:8336
    ds_read_b128 a[40:43], v2 offset:8352
    ds_read_b128 a[44:47], v2 offset:8368
    ds_read_b128 a[48:51], v2 offset:12480
    ds_read_b128 a[52:55], v2 offset:12496
    ds_read_b128 a[56:59], v2 offset:12512
    ds_read_b128 a[60:63], v2 offset:12528
    s_waitcnt vmcnt(16)
    v_perm_b32 v32, v132, v128, s38
    v_perm_b32 v33, v140, v136, s38
    v_perm_b32 v34, v148, v144, s38
    v_perm_b32 v35, v156, v152, s38
    v_perm_b32 v36, v132, v128, s39
    v_perm_b32 v37, v140, v136, s39
    v_perm_b32 v38, v148, v144, s39
    v_perm_b32 v39, v156, v152, s39
    v_perm_b32 v40, v133, v129, s38
    v_perm_b32 v41, v141, v137, s38
    v_perm_b32 v42, v149, v145, s38
    v_perm_b32 v43, v157, v153, s38
    v_perm_b32 v44, v133, v129, s39
    v_perm_b32 v45, v141, v137, s39
    v_perm_b32 v46, v149, v145, s39
    v_perm_b32 v47, v157, v153, s39
    v_perm_b32 v48, v134, v130, s38
    v_perm_b32 v49, v142, v138, s38
    v_perm_b32 v50, v150, v146, s38
    v_perm_b32 v51, v158, v154, s38
    v_perm_b32 v52, v134, v130, s39
    v_perm_b32 v53, v142, v138, s39
    v_perm_b32 v54, v150, v146, s39
    v_perm_b32 v55, v158, v154, s39
    v_perm_b32 v56, v135, v131, s38
    v_perm_b32 v57, v143, v139, s38
    v_perm_b32 v58, v151, v147, s38
    v_perm_b32 v59, v159, v155, s38
    v_perm_b32 v60, v135, v131, s39
    v_perm_b32 v61, v143, v139, s39
    v_perm_b32 v62, v151, v147, s39
    v_perm_b32 v63, v159, v155, s39
    s_waitcnt lgkmcnt(0)
    ds_write_b128 v5, v[32:35] offset:8320
    ds_write_b128 v5, v[36:39] offset:9344
    ds_write_b128 v5, v[40:43] offset:10368
    ds_write_b128 v5, v[44:47] offset:11392
    ds_write_b128 v5, v[48:51] offset:12416
    ds_write_b128 v5, v[52:55] offset:13440
    ds_write_b128 v5, v[56:59] offset:14464
    ds_write_b128 v5, v[60:63] offset:15488
    s_add_u32 m0, s98, 0x6180
    s_mov_b32 s97, 0x300
    buffer_load_dwordx4 v1, s[44:47], s97 offen lds
    s_add_u32 m0, s98, 0x6590
    s_mov_b32 s97, 0x1300
    buffer_load_dwordx4 v1, s[44:47], s97 offen lds
    s_add_u32 m0, s98, 0x69a0
    s_mov_b32 s97, 0x2300
    buffer_load_dwordx4 v1, s[44:47], s97 offen lds
    s_add_u32 m0, s98, 0x6db0
    s_mov_b32 s97, 0x3300
    buffer_load_dwordx4 v1, s[44:47], s97 offen lds
    s_add_u32 m0, s98, 0x71c0
    s_mov_b32 s97, 0x4300
    buffer_load_dwordx4 v1, s[44:47], s97 offen lds
    s_add_u32 m0, s98, 0x75d0
    s_mov_b32 s97, 0x5300
    buffer_load_dwordx4 v1, s[44:47], s97 offen lds
    s_add_u32 m0, s98, 0x79e0
    s_mov_b32 s97, 0x6300
    buffer_load_dwordx4 v1, s[44:47], s97 offen lds
    s_add_u32 m0, s98, 0x7df0
    s_mov_b32 s97, 0x7300
    buffer_load_dwordx4 v1, s[44:47], s97 offen lds
    s_mov_b32 s97, 0x300000
    buffer_load_dwordx4 v[192:195], v3, s[40:43], s97 offen
    s_mov_b32 s97, 0x302000
    buffer_load_dwordx4 v[196:199], v3, s[40:43], s97 offen
    s_mov_b32 s97, 0x304000
    buffer_load_dwordx4 v[200:203], v3, s[40:43], s97 offen
    s_mov_b32 s97, 0x306000
    buffer_load_dwordx4 v[204:207], v3, s[40:43], s97 offen
    s_mov_b32 s97, 0x308000
    buffer_load_dwordx4 v[208:211], v3, s[40:43], s97 offen
    s_mov_b32 s97, 0x30a000
    buffer_load_dwordx4 v[212:215], v3, s[40:43], s97 offen
    s_mov_b32 s97, 0x30c000
    buffer_load_dwordx4 v[216:219], v3, s[40:43], s97 offen
    s_mov_b32 s97, 0x30e000
    buffer_load_dwordx4 v[220:223], v3, s[40:43], s97 offen
    s_xor_b32 s97, s99, 0x0
    buffer_load_dwordx4 v[64:67], v0, s[56:59], s97 offen nt
    s_xor_b32 s97, s99, 0x400
    buffer_load_dwordx4 v[68:71], v0, s[56:59], s97 offen nt
    s_xor_b32 s97, s99, 0x800
    buffer_load_dwordx4 v[72:75], v0, s[56:59], s97 offen nt
    s_xor_b32 s97, s99, 0xc00
    buffer_load_dwordx4 v[76:79], v0, s[56:59], s97 offen nt
    s_waitcnt lgkmcnt(0)
    s_waitcnt vmcnt(28)
    ds_read_b128 a[64:67], v2 offset:16640
    ds_read_b128 a[68:71], v2 offset:16656
    ds_read_b128 a[72:75], v2 offset:16672
    ds_read_b128 a[76:79], v2 offset:16688
    ds_read_b128 a[80:83], v2 offset:20800
    ds_read_b128 a[84:87], v2 offset:20816
    ds_read_b128 a[88:91], v2 offset:20832
    ds_read_b128 a[92:95], v2 offset:20848
    s_waitcnt vmcnt(20)
    v_perm_b32 v32, v164, v160, s38
    v_perm_b32 v33, v172, v168, s38
    v_perm_b32 v34, v180, v176, s38
    v_perm_b32 v35, v188, v184, s38
    v_perm_b32 v36, v164, v160, s39
    v_perm_b32 v37, v172, v168, s39
    v_perm_b32 v38, v180, v176, s39
    v_perm_b32 v39, v188, v184, s39
    v_perm_b32 v40, v165, v161, s38
    v_perm_b32 v41, v173, v169, s38
    v_perm_b32 v42, v181, v177, s38
    v_perm_b32 v43, v189, v185, s38
    v_perm_b32 v44, v165, v161, s39
    v_perm_b32 v45, v173, v169, s39
    v_perm_b32 v46, v181, v177, s39
    v_perm_b32 v47, v189, v185, s39
    v_perm_b32 v48, v166, v162, s38
    v_perm_b32 v49, v174, v170, s38
    v_perm_b32 v50, v182, v178, s38
    v_perm_b32 v51, v190, v186, s38
    v_perm_b32 v52, v166, v162, s39
    v_perm_b32 v53, v174, v170, s39
    v_perm_b32 v54, v182, v178, s39
    v_perm_b32 v55, v190, v186, s39
    v_perm_b32 v56, v167, v163, s38
    v_perm_b32 v57, v175, v171, s38
    v_perm_b32 v58, v183, v179, s38
    v_perm_b32 v59, v191, v187, s38
    v_perm_b32 v60, v167, v163, s39
    v_perm_b32 v61, v175, v171, s39
    v_perm_b32 v62, v183, v179, s39
    v_perm_b32 v63, v191, v187, s39
    s_waitcnt lgkmcnt(0)
    ds_write_b128 v5, v[32:35] offset:16640
    ds_write_b128 v5, v[36:39] offset:17664
    ds_write_b128 v5, v[40:43] offset:18688
    ds_write_b128 v5, v[44:47] offset:19712
    ds_write_b128 v5, v[48:51] offset:20736
    ds_write_b128 v5, v[52:55] offset:21760
    ds_write_b128 v5, v[56:59] offset:22784
    ds_write_b128 v5, v[60:63] offset:23808
    s_xor_b32 s97, s99, 0x1000
    buffer_load_dwordx4 v[80:83], v0, s[56:59], s97 offen nt
    s_xor_b32 s97, s99, 0x1400
    buffer_load_dwordx4 v[84:87], v0, s[56:59], s97 offen nt
    s_xor_b32 s97, s99, 0x1800
    buffer_load_dwordx4 v[88:91], v0, s[56:59], s97 offen nt
    s_xor_b32 s97, s99, 0x1c00
    buffer_load_dwordx4 v[92:95], v0, s[56:59], s97 offen nt
    s_waitcnt lgkmcnt(0)
    s_waitcnt vmcnt(16)
    ds_read_b128 a[96:99], v2 offset:24960
    ds_read_b128 a[100:103], v2 offset:24976
    ds_read_b128 a[104:107], v2 offset:24992
    ds_read_b128 a[108:111], v2 offset:25008
    ds_read_b128 a[112:115], v2 offset:29120
    ds_read_b128 a[116:119], v2 offset:29136
    ds_read_b128 a[120:123], v2 offset:29152
    ds_read_b128 a[124:127], v2 offset:29168
    s_waitcnt vmcnt(8)
    v_perm_b32 v32, v196, v192, s38
    v_perm_b32 v33, v204, v200, s38
    v_perm_b32 v34, v212, v208, s38
    v_perm_b32 v35, v220, v216, s38
    v_perm_b32 v36, v196, v192, s39
    v_perm_b32 v37, v204, v200, s39
    v_perm_b32 v38, v212, v208, s39
    v_perm_b32 v39, v220, v216, s39
    v_perm_b32 v40, v197, v193, s38
    v_perm_b32 v41, v205, v201, s38
    v_perm_b32 v42, v213, v209, s38
    v_perm_b32 v43, v221, v217, s38
    v_perm_b32 v44, v197, v193, s39
    v_perm_b32 v45, v205, v201, s39
    v_perm_b32 v46, v213, v209, s39
    v_perm_b32 v47, v221, v217, s39
    v_perm_b32 v48, v198, v194, s38
    v_perm_b32 v49, v206, v202, s38
    v_perm_b32 v50, v214, v210, s38
    v_perm_b32 v51, v222, v218, s38
    v_perm_b32 v52, v198, v194, s39
    v_perm_b32 v53, v206, v202, s39
    v_perm_b32 v54, v214, v210, s39
    v_perm_b32 v55, v222, v218, s39
    v_perm_b32 v56, v199, v195, s38
    v_perm_b32 v57, v207, v203, s38
    v_perm_b32 v58, v215, v211, s38
    v_perm_b32 v59, v223, v219, s38
    v_perm_b32 v60, v199, v195, s39
    v_perm_b32 v61, v207, v203, s39
    v_perm_b32 v62, v215, v211, s39
    v_perm_b32 v63, v223, v219, s39
    s_waitcnt lgkmcnt(0)
    ds_write_b128 v5, v[32:35] offset:24960
    ds_write_b128 v5, v[36:39] offset:25984
    ds_write_b128 v5, v[40:43] offset:27008
    ds_write_b128 v5, v[44:47] offset:28032
    ds_write_b128 v5, v[48:51] offset:29056
    ds_write_b128 v5, v[52:55] offset:30080
    ds_write_b128 v5, v[56:59] offset:31104
    ds_write_b128 v5, v[60:63] offset:32128
    s_xor_b32 s97, s99, 0x2000
    buffer_load_dwordx4 v[96:99], v0, s[56:59], s97 offen nt
    s_xor_b32 s97, s99, 0x2400
    buffer_load_dwordx4 v[100:103], v0, s[56:59], s97 offen nt
    s_xor_b32 s97, s99, 0x2800
    buffer_load_dwordx4 v[104:107], v0, s[56:59], s97 offen nt
    s_xor_b32 s97, s99, 0x2c00
    buffer_load_dwordx4 v[108:111], v0, s[56:59], s97 offen nt
    s_waitcnt lgkmcnt(0)
    s_barrier
    v_mov_b32 v10, 1
    s_cmp_eq_u32 s3, 0
    s_cselect_b64 exec, 1, 0
    s_cbranch_scc0 NOCERTB
    buffer_store_byte v10, v8, s[72:75], s2 offen sc1
NOCERTB:
    s_mov_b64 exec, -1
    ds_read_b128 a[192:195], v0
    ds_read_b128 a[196:199], v0 offset:1024
    ds_read_b128 a[200:203], v0 offset:2048
    ds_read_b128 a[204:207], v0 offset:3072
    ds_read_b128 a[208:211], v0 offset:4096
    ds_read_b128 a[212:215], v0 offset:5120
    ds_read_b128 a[216:219], v0 offset:6144
    ds_read_b128 a[220:223], v0 offset:7168
    ds_read_b128 a[224:227], v0 offset:33280
    ds_read_b128 a[228:231], v0 offset:34304
    ds_read_b128 a[232:235], v0 offset:35328
    ds_read_b128 a[236:239], v0 offset:36352
    s_waitcnt lgkmcnt(11)
    s_xor_b32 s97, s99, 0x3000
    buffer_load_dwordx4 v[112:115], v0, s[56:59], s97 offen nt
    v_mfma_f32_16x16x32_bf16 a[128:131], a[192:195], a[0:3], 0
    v_mfma_f32_16x16x32_bf16 a[132:135], a[192:195], a[16:19], 0
    ds_read_b128 a[240:243], v0 offset:37376
    s_waitcnt lgkmcnt(11)
    v_mfma_f32_16x16x32_bf16 a[136:139], a[196:199], a[0:3], 0
    v_mfma_f32_16x16x32_bf16 a[140:143], a[196:199], a[16:19], 0
    ds_read_b128 a[244:247], v0 offset:38400
    s_waitcnt lgkmcnt(11)
    v_mfma_f32_16x16x32_bf16 a[144:147], a[200:203], a[0:3], 0
    v_mfma_f32_16x16x32_bf16 a[148:151], a[200:203], a[16:19], 0
    s_xor_b32 s97, s99, 0x3400
    buffer_load_dwordx4 v[116:119], v0, s[56:59], s97 offen nt
    ds_read_b128 a[248:251], v0 offset:39424
    s_waitcnt lgkmcnt(11)
    v_mfma_f32_16x16x32_bf16 a[152:155], a[204:207], a[0:3], 0
    v_mfma_f32_16x16x32_bf16 a[156:159], a[204:207], a[16:19], 0
    ds_read_b128 a[252:255], v0 offset:40448
    s_waitcnt lgkmcnt(11)
    v_mfma_f32_16x16x32_bf16 a[160:163], a[208:211], a[0:3], 0
    v_mfma_f32_16x16x32_bf16 a[164:167], a[208:211], a[16:19], 0
    ds_read_b128 a[192:195], v6 offset:1024
    s_xor_b32 s97, s99, 0x3800
    buffer_load_dwordx4 v[120:123], v0, s[56:59], s97 offen nt
    s_waitcnt lgkmcnt(11)
    v_mfma_f32_16x16x32_bf16 a[168:171], a[212:215], a[0:3], 0
    v_mfma_f32_16x16x32_bf16 a[172:175], a[212:215], a[16:19], 0
    ds_read_b128 a[196:199], v6 offset:2048
    s_waitcnt lgkmcnt(11)
    v_mfma_f32_16x16x32_bf16 a[176:179], a[216:219], a[0:3], 0
    v_mfma_f32_16x16x32_bf16 a[180:183], a[216:219], a[16:19], 0
    ds_read_b128 a[200:203], v6 offset:3072
    s_waitcnt lgkmcnt(11)
    s_xor_b32 s97, s99, 0x3c00
    buffer_load_dwordx4 v[124:127], v0, s[56:59], s97 offen nt
    v_mfma_f32_16x16x32_bf16 a[184:187], a[220:223], a[0:3], 0
    v_mfma_f32_16x16x32_bf16 a[188:191], a[220:223], a[16:19], 0
    ds_read_b128 a[204:207], v6 offset:4096
    s_waitcnt lgkmcnt(11)
    v_mfma_f32_16x16x32_bf16 a[128:131], a[224:227], a[4:7], a[128:131]
    v_mfma_f32_16x16x32_bf16 a[132:135], a[224:227], a[20:23], a[132:135]
    ds_read_b128 a[208:211], v6 offset:5120
    s_waitcnt lgkmcnt(11)
    v_mfma_f32_16x16x32_bf16 a[136:139], a[228:231], a[4:7], a[136:139]
    v_mfma_f32_16x16x32_bf16 a[140:143], a[228:231], a[20:23], a[140:143]
    s_xor_b32 s97, s99, 0x4000
    buffer_load_dwordx4 v[128:131], v0, s[56:59], s97 offen nt
    ds_read_b128 a[212:215], v6 offset:6144
    s_waitcnt lgkmcnt(11)
    v_mfma_f32_16x16x32_bf16 a[144:147], a[232:235], a[4:7], a[144:147]
    v_mfma_f32_16x16x32_bf16 a[148:151], a[232:235], a[20:23], a[148:151]
    ds_read_b128 a[216:219], v6 offset:7168
    s_waitcnt lgkmcnt(11)
    v_mfma_f32_16x16x32_bf16 a[152:155], a[236:239], a[4:7], a[152:155]
    v_mfma_f32_16x16x32_bf16 a[156:159], a[236:239], a[20:23], a[156:159]
    ds_read_b128 a[220:223], v6 offset:8192
    s_xor_b32 s97, s99, 0x4400
    buffer_load_dwordx4 v[132:135], v0, s[56:59], s97 offen nt
    s_waitcnt lgkmcnt(11)
    v_mfma_f32_16x16x32_bf16 a[160:163], a[240:243], a[4:7], a[160:163]
    v_mfma_f32_16x16x32_bf16 a[164:167], a[240:243], a[20:23], a[164:167]
    ds_read_b128 a[224:227], v6 offset:34304
    s_waitcnt lgkmcnt(11)
    v_mfma_f32_16x16x32_bf16 a[168:171], a[244:247], a[4:7], a[168:171]
    v_mfma_f32_16x16x32_bf16 a[172:175], a[244:247], a[20:23], a[172:175]
    ds_read_b128 a[228:231], v6 offset:35328
    s_waitcnt lgkmcnt(11)
    s_xor_b32 s97, s99, 0x4800
    buffer_load_dwordx4 v[136:139], v0, s[56:59], s97 offen nt
    v_mfma_f32_16x16x32_bf16 a[176:179], a[248:251], a[4:7], a[176:179]
    v_mfma_f32_16x16x32_bf16 a[180:183], a[248:251], a[20:23], a[180:183]
    ds_read_b128 a[232:235], v6 offset:36352
    s_waitcnt lgkmcnt(11)
    v_mfma_f32_16x16x32_bf16 a[184:187], a[252:255], a[4:7], a[184:187]
    v_mfma_f32_16x16x32_bf16 a[188:191], a[252:255], a[20:23], a[188:191]
    ds_read_b128 a[236:239], v6 offset:37376
    s_waitcnt lgkmcnt(11)
    v_mfma_f32_16x16x32_bf16 a[128:131], a[192:195], a[8:11], a[128:131]
    v_mfma_f32_16x16x32_bf16 a[132:135], a[192:195], a[24:27], a[132:135]
    s_xor_b32 s97, s99, 0x4c00
    buffer_load_dwordx4 v[140:143], v0, s[56:59], s97 offen nt
    ds_read_b128 a[240:243], v6 offset:38400
    s_waitcnt lgkmcnt(11)
    v_mfma_f32_16x16x32_bf16 a[136:139], a[196:199], a[8:11], a[136:139]
    v_mfma_f32_16x16x32_bf16 a[140:143], a[196:199], a[24:27], a[140:143]
    ds_read_b128 a[244:247], v6 offset:39424
    s_waitcnt lgkmcnt(11)
    v_mfma_f32_16x16x32_bf16 a[144:147], a[200:203], a[8:11], a[144:147]
    v_mfma_f32_16x16x32_bf16 a[148:151], a[200:203], a[24:27], a[148:151]
    ds_read_b128 a[248:251], v6 offset:40448
    s_xor_b32 s97, s99, 0x5000
    buffer_load_dwordx4 v[144:147], v0, s[56:59], s97 offen nt
    s_waitcnt lgkmcnt(11)
    v_mfma_f32_16x16x32_bf16 a[152:155], a[204:207], a[8:11], a[152:155]
    v_mfma_f32_16x16x32_bf16 a[156:159], a[204:207], a[24:27], a[156:159]
    ds_read_b128 a[252:255], v6 offset:41472
    s_waitcnt lgkmcnt(11)
    v_mfma_f32_16x16x32_bf16 a[160:163], a[208:211], a[8:11], a[160:163]
    v_mfma_f32_16x16x32_bf16 a[164:167], a[208:211], a[24:27], a[164:167]
    ds_read_b128 a[192:195], v0 offset:8320
    s_waitcnt lgkmcnt(11)
    s_xor_b32 s97, s99, 0x5400
    buffer_load_dwordx4 v[148:151], v0, s[56:59], s97 offen nt
    v_mfma_f32_16x16x32_bf16 a[168:171], a[212:215], a[8:11], a[168:171]
    v_mfma_f32_16x16x32_bf16 a[172:175], a[212:215], a[24:27], a[172:175]
    ds_read_b128 a[196:199], v0 offset:9344
    s_waitcnt lgkmcnt(11)
    v_mfma_f32_16x16x32_bf16 a[176:179], a[216:219], a[8:11], a[176:179]
    v_mfma_f32_16x16x32_bf16 a[180:183], a[216:219], a[24:27], a[180:183]
    ds_read_b128 a[200:203], v0 offset:10368
    s_waitcnt lgkmcnt(11)
    v_mfma_f32_16x16x32_bf16 a[184:187], a[220:223], a[8:11], a[184:187]
    v_mfma_f32_16x16x32_bf16 a[188:191], a[220:223], a[24:27], a[188:191]
    s_xor_b32 s97, s99, 0x5800
    buffer_load_dwordx4 v[152:155], v0, s[56:59], s97 offen nt
    ds_read_b128 a[204:207], v0 offset:11392
    s_waitcnt lgkmcnt(11)
    v_mfma_f32_16x16x32_bf16 a[128:131], a[224:227], a[12:15], a[128:131]
    v_mfma_f32_16x16x32_bf16 a[132:135], a[224:227], a[28:31], a[132:135]
    ds_read_b128 a[208:211], v0 offset:12416
    s_waitcnt lgkmcnt(11)
    v_mfma_f32_16x16x32_bf16 a[136:139], a[228:231], a[12:15], a[136:139]
    v_mfma_f32_16x16x32_bf16 a[140:143], a[228:231], a[28:31], a[140:143]
    ds_read_b128 a[212:215], v0 offset:13440
    s_xor_b32 s97, s99, 0x5c00
    buffer_load_dwordx4 v[156:159], v0, s[56:59], s97 offen nt
    s_waitcnt lgkmcnt(11)
    v_mfma_f32_16x16x32_bf16 a[144:147], a[232:235], a[12:15], a[144:147]
    v_mfma_f32_16x16x32_bf16 a[148:151], a[232:235], a[28:31], a[148:151]
    ds_read_b128 a[216:219], v0 offset:14464
    s_waitcnt lgkmcnt(11)
    v_mfma_f32_16x16x32_bf16 a[152:155], a[236:239], a[12:15], a[152:155]
    v_mfma_f32_16x16x32_bf16 a[156:159], a[236:239], a[28:31], a[156:159]
    ds_read_b128 a[220:223], v0 offset:15488
    s_waitcnt lgkmcnt(11)
    s_xor_b32 s97, s99, 0x6000
    buffer_load_dwordx4 v[160:163], v0, s[56:59], s97 offen nt
    v_mfma_f32_16x16x32_bf16 a[160:163], a[240:243], a[12:15], a[160:163]
    v_mfma_f32_16x16x32_bf16 a[164:167], a[240:243], a[28:31], a[164:167]
    ds_read_b128 a[224:227], v0 offset:41600
    s_waitcnt lgkmcnt(11)
    v_mfma_f32_16x16x32_bf16 a[168:171], a[244:247], a[12:15], a[168:171]
    v_mfma_f32_16x16x32_bf16 a[172:175], a[244:247], a[28:31], a[172:175]
    ds_read_b128 a[228:231], v0 offset:42624
    s_waitcnt lgkmcnt(11)
    v_mfma_f32_16x16x32_bf16 a[176:179], a[248:251], a[12:15], a[176:179]
    v_mfma_f32_16x16x32_bf16 a[180:183], a[248:251], a[28:31], a[180:183]
    s_xor_b32 s97, s99, 0x6400
    buffer_load_dwordx4 v[164:167], v0, s[56:59], s97 offen nt
    ds_read_b128 a[232:235], v0 offset:43648
    s_waitcnt lgkmcnt(11)
    v_mfma_f32_16x16x32_bf16 a[184:187], a[252:255], a[12:15], a[184:187]
    v_mfma_f32_16x16x32_bf16 a[188:191], a[252:255], a[28:31], a[188:191]
    ds_read_b128 a[236:239], v0 offset:44672
    s_waitcnt lgkmcnt(11)
    v_mfma_f32_16x16x32_bf16 a[128:131], a[192:195], a[32:35], a[128:131]
    v_mfma_f32_16x16x32_bf16 a[132:135], a[192:195], a[48:51], a[132:135]
    ds_read_b128 a[240:243], v0 offset:45696
    s_xor_b32 s97, s99, 0x6800
    buffer_load_dwordx4 v[168:171], v0, s[56:59], s97 offen nt
    s_waitcnt lgkmcnt(11)
    v_mfma_f32_16x16x32_bf16 a[136:139], a[196:199], a[32:35], a[136:139]
    v_mfma_f32_16x16x32_bf16 a[140:143], a[196:199], a[48:51], a[140:143]
    ds_read_b128 a[244:247], v0 offset:46720
    s_waitcnt lgkmcnt(11)
    v_mfma_f32_16x16x32_bf16 a[144:147], a[200:203], a[32:35], a[144:147]
    v_mfma_f32_16x16x32_bf16 a[148:151], a[200:203], a[48:51], a[148:151]
    ds_read_b128 a[248:251], v0 offset:47744
    s_waitcnt lgkmcnt(11)
    s_xor_b32 s97, s99, 0x6c00
    buffer_load_dwordx4 v[172:175], v0, s[56:59], s97 offen nt
    v_mfma_f32_16x16x32_bf16 a[152:155], a[204:207], a[32:35], a[152:155]
    v_mfma_f32_16x16x32_bf16 a[156:159], a[204:207], a[48:51], a[156:159]
    ds_read_b128 a[252:255], v0 offset:48768
    s_waitcnt lgkmcnt(11)
    v_mfma_f32_16x16x32_bf16 a[160:163], a[208:211], a[32:35], a[160:163]
    v_mfma_f32_16x16x32_bf16 a[164:167], a[208:211], a[48:51], a[164:167]
    ds_read_b128 a[192:195], v6 offset:9344
    s_waitcnt lgkmcnt(11)
    v_mfma_f32_16x16x32_bf16 a[168:171], a[212:215], a[32:35], a[168:171]
    v_mfma_f32_16x16x32_bf16 a[172:175], a[212:215], a[48:51], a[172:175]
    s_xor_b32 s97, s99, 0x7000
    buffer_load_dwordx4 v[176:179], v0, s[56:59], s97 offen nt
    ds_read_b128 a[196:199], v6 offset:10368
    s_waitcnt lgkmcnt(11)
    v_mfma_f32_16x16x32_bf16 a[176:179], a[216:219], a[32:35], a[176:179]
    v_mfma_f32_16x16x32_bf16 a[180:183], a[216:219], a[48:51], a[180:183]
    ds_read_b128 a[200:203], v6 offset:11392
    s_waitcnt lgkmcnt(11)
    v_mfma_f32_16x16x32_bf16 a[184:187], a[220:223], a[32:35], a[184:187]
    v_mfma_f32_16x16x32_bf16 a[188:191], a[220:223], a[48:51], a[188:191]
    ds_read_b128 a[204:207], v6 offset:12416
    s_xor_b32 s97, s99, 0x7400
    buffer_load_dwordx4 v[180:183], v0, s[56:59], s97 offen nt
    s_waitcnt lgkmcnt(11)
    v_mfma_f32_16x16x32_bf16 a[128:131], a[224:227], a[36:39], a[128:131]
    v_mfma_f32_16x16x32_bf16 a[132:135], a[224:227], a[52:55], a[132:135]
    ds_read_b128 a[208:211], v6 offset:13440
    s_waitcnt lgkmcnt(11)
    v_mfma_f32_16x16x32_bf16 a[136:139], a[228:231], a[36:39], a[136:139]
    v_mfma_f32_16x16x32_bf16 a[140:143], a[228:231], a[52:55], a[140:143]
    ds_read_b128 a[212:215], v6 offset:14464
    s_waitcnt lgkmcnt(11)
    s_xor_b32 s97, s99, 0x7800
    buffer_load_dwordx4 v[184:187], v0, s[56:59], s97 offen nt
    v_mfma_f32_16x16x32_bf16 a[144:147], a[232:235], a[36:39], a[144:147]
    v_mfma_f32_16x16x32_bf16 a[148:151], a[232:235], a[52:55], a[148:151]
    ds_read_b128 a[216:219], v6 offset:15488
    s_waitcnt lgkmcnt(11)
    v_mfma_f32_16x16x32_bf16 a[152:155], a[236:239], a[36:39], a[152:155]
    v_mfma_f32_16x16x32_bf16 a[156:159], a[236:239], a[52:55], a[156:159]
    ds_read_b128 a[220:223], v6 offset:16512
    s_waitcnt lgkmcnt(11)
    v_mfma_f32_16x16x32_bf16 a[160:163], a[240:243], a[36:39], a[160:163]
    v_mfma_f32_16x16x32_bf16 a[164:167], a[240:243], a[52:55], a[164:167]
    s_xor_b32 s97, s99, 0x7c00
    buffer_load_dwordx4 v[188:191], v0, s[56:59], s97 offen nt
    ds_read_b128 a[224:227], v6 offset:42624
    s_waitcnt lgkmcnt(11)
    v_mfma_f32_16x16x32_bf16 a[168:171], a[244:247], a[36:39], a[168:171]
    v_mfma_f32_16x16x32_bf16 a[172:175], a[244:247], a[52:55], a[172:175]
    ds_read_b128 a[228:231], v6 offset:43648
    s_waitcnt lgkmcnt(11)
    v_mfma_f32_16x16x32_bf16 a[176:179], a[248:251], a[36:39], a[176:179]
    v_mfma_f32_16x16x32_bf16 a[180:183], a[248:251], a[52:55], a[180:183]
    ds_read_b128 a[232:235], v6 offset:44672
    s_xor_b32 s97, s99, 0x8000
    buffer_load_dwordx4 v[192:195], v0, s[56:59], s97 offen nt
    s_waitcnt lgkmcnt(11)
    v_mfma_f32_16x16x32_bf16 a[184:187], a[252:255], a[36:39], a[184:187]
    v_mfma_f32_16x16x32_bf16 a[188:191], a[252:255], a[52:55], a[188:191]
    ds_read_b128 a[236:239], v6 offset:45696
    s_waitcnt lgkmcnt(11)
    v_mfma_f32_16x16x32_bf16 a[128:131], a[192:195], a[40:43], a[128:131]
    v_mfma_f32_16x16x32_bf16 a[132:135], a[192:195], a[56:59], a[132:135]
    ds_read_b128 a[240:243], v6 offset:46720
    s_waitcnt lgkmcnt(11)
    s_xor_b32 s97, s99, 0x8400
    buffer_load_dwordx4 v[196:199], v0, s[56:59], s97 offen nt
    v_mfma_f32_16x16x32_bf16 a[136:139], a[196:199], a[40:43], a[136:139]
    v_mfma_f32_16x16x32_bf16 a[140:143], a[196:199], a[56:59], a[140:143]
    ds_read_b128 a[244:247], v6 offset:47744
    s_waitcnt lgkmcnt(11)
    v_mfma_f32_16x16x32_bf16 a[144:147], a[200:203], a[40:43], a[144:147]
    v_mfma_f32_16x16x32_bf16 a[148:151], a[200:203], a[56:59], a[148:151]
    ds_read_b128 a[248:251], v6 offset:48768
    s_waitcnt lgkmcnt(11)
    v_mfma_f32_16x16x32_bf16 a[152:155], a[204:207], a[40:43], a[152:155]
    v_mfma_f32_16x16x32_bf16 a[156:159], a[204:207], a[56:59], a[156:159]
    s_xor_b32 s97, s99, 0x8800
    buffer_load_dwordx4 v[200:203], v0, s[56:59], s97 offen nt
    ds_read_b128 a[252:255], v6 offset:49792
    s_waitcnt lgkmcnt(11)
    v_mfma_f32_16x16x32_bf16 a[160:163], a[208:211], a[40:43], a[160:163]
    v_mfma_f32_16x16x32_bf16 a[164:167], a[208:211], a[56:59], a[164:167]
    ds_read_b128 a[192:195], v0 offset:16640
    s_waitcnt lgkmcnt(11)
    v_mfma_f32_16x16x32_bf16 a[168:171], a[212:215], a[40:43], a[168:171]
    v_mfma_f32_16x16x32_bf16 a[172:175], a[212:215], a[56:59], a[172:175]
    ds_read_b128 a[196:199], v0 offset:17664
    s_xor_b32 s97, s99, 0x8c00
    buffer_load_dwordx4 v[204:207], v0, s[56:59], s97 offen nt
    s_waitcnt lgkmcnt(11)
    v_mfma_f32_16x16x32_bf16 a[176:179], a[216:219], a[40:43], a[176:179]
    v_mfma_f32_16x16x32_bf16 a[180:183], a[216:219], a[56:59], a[180:183]
    ds_read_b128 a[200:203], v0 offset:18688
    s_waitcnt lgkmcnt(11)
    v_mfma_f32_16x16x32_bf16 a[184:187], a[220:223], a[40:43], a[184:187]
    v_mfma_f32_16x16x32_bf16 a[188:191], a[220:223], a[56:59], a[188:191]
    ds_read_b128 a[204:207], v0 offset:19712
    s_waitcnt lgkmcnt(11)
    s_xor_b32 s97, s99, 0x9000
    buffer_load_dwordx4 v[208:211], v0, s[56:59], s97 offen nt
    v_mfma_f32_16x16x32_bf16 a[128:131], a[224:227], a[44:47], a[128:131]
    v_mfma_f32_16x16x32_bf16 a[132:135], a[224:227], a[60:63], a[132:135]
    ds_read_b128 a[208:211], v0 offset:20736
    s_waitcnt lgkmcnt(11)
    v_mfma_f32_16x16x32_bf16 a[136:139], a[228:231], a[44:47], a[136:139]
    v_mfma_f32_16x16x32_bf16 a[140:143], a[228:231], a[60:63], a[140:143]
    ds_read_b128 a[212:215], v0 offset:21760
    s_waitcnt lgkmcnt(11)
    v_mfma_f32_16x16x32_bf16 a[144:147], a[232:235], a[44:47], a[144:147]
    v_mfma_f32_16x16x32_bf16 a[148:151], a[232:235], a[60:63], a[148:151]
    s_xor_b32 s97, s99, 0x9400
    buffer_load_dwordx4 v[212:215], v0, s[56:59], s97 offen nt
    ds_read_b128 a[216:219], v0 offset:22784
    s_waitcnt lgkmcnt(11)
    v_mfma_f32_16x16x32_bf16 a[152:155], a[236:239], a[44:47], a[152:155]
    v_mfma_f32_16x16x32_bf16 a[156:159], a[236:239], a[60:63], a[156:159]
    ds_read_b128 a[220:223], v0 offset:23808
    s_waitcnt lgkmcnt(11)
    v_mfma_f32_16x16x32_bf16 a[160:163], a[240:243], a[44:47], a[160:163]
    v_mfma_f32_16x16x32_bf16 a[164:167], a[240:243], a[60:63], a[164:167]
    ds_read_b128 a[224:227], v0 offset:49920
    s_xor_b32 s97, s99, 0x9800
    buffer_load_dwordx4 v[216:219], v0, s[56:59], s97 offen nt
    s_waitcnt lgkmcnt(11)
    v_mfma_f32_16x16x32_bf16 a[168:171], a[244:247], a[44:47], a[168:171]
    v_mfma_f32_16x16x32_bf16 a[172:175], a[244:247], a[60:63], a[172:175]
    ds_read_b128 a[228:231], v0 offset:50944
    s_waitcnt lgkmcnt(11)
    v_mfma_f32_16x16x32_bf16 a[176:179], a[248:251], a[44:47], a[176:179]
    v_mfma_f32_16x16x32_bf16 a[180:183], a[248:251], a[60:63], a[180:183]
    ds_read_b128 a[232:235], v0 offset:51968
    s_waitcnt lgkmcnt(11)
    s_xor_b32 s97, s99, 0x9c00
    buffer_load_dwordx4 v[220:223], v0, s[56:59], s97 offen nt
    v_mfma_f32_16x16x32_bf16 a[184:187], a[252:255], a[44:47], a[184:187]
    v_mfma_f32_16x16x32_bf16 a[188:191], a[252:255], a[60:63], a[188:191]
    ds_read_b128 a[236:239], v0 offset:52992
    s_waitcnt lgkmcnt(11)
    v_mfma_f32_16x16x32_bf16 a[128:131], a[192:195], a[64:67], a[128:131]
    v_mfma_f32_16x16x32_bf16 a[132:135], a[192:195], a[80:83], a[132:135]
    ds_read_b128 a[240:243], v0 offset:54016
    s_waitcnt lgkmcnt(11)
    v_mfma_f32_16x16x32_bf16 a[136:139], a[196:199], a[64:67], a[136:139]
    v_mfma_f32_16x16x32_bf16 a[140:143], a[196:199], a[80:83], a[140:143]
    ds_read_b128 a[244:247], v0 offset:55040
    s_waitcnt lgkmcnt(11)
    v_mfma_f32_16x16x32_bf16 a[144:147], a[200:203], a[64:67], a[144:147]
    v_mfma_f32_16x16x32_bf16 a[148:151], a[200:203], a[80:83], a[148:151]
    ds_read_b128 a[248:251], v0 offset:56064
    s_waitcnt lgkmcnt(11)
    v_mfma_f32_16x16x32_bf16 a[152:155], a[204:207], a[64:67], a[152:155]
    v_mfma_f32_16x16x32_bf16 a[156:159], a[204:207], a[80:83], a[156:159]
    ds_read_b128 a[252:255], v0 offset:57088
    s_waitcnt lgkmcnt(11)
    v_mfma_f32_16x16x32_bf16 a[160:163], a[208:211], a[64:67], a[160:163]
    v_mfma_f32_16x16x32_bf16 a[164:167], a[208:211], a[80:83], a[164:167]
    ds_read_b128 a[192:195], v6 offset:17664
    s_waitcnt lgkmcnt(11)
    v_mfma_f32_16x16x32_bf16 a[168:171], a[212:215], a[64:67], a[168:171]
    v_mfma_f32_16x16x32_bf16 a[172:175], a[212:215], a[80:83], a[172:175]
    ds_read_b128 a[196:199], v6 offset:18688
    s_waitcnt lgkmcnt(11)
    v_mfma_f32_16x16x32_bf16 a[176:179], a[216:219], a[64:67], a[176:179]
    v_mfma_f32_16x16x32_bf16 a[180:183], a[216:219], a[80:83], a[180:183]
    ds_read_b128 a[200:203], v6 offset:19712
    s_waitcnt lgkmcnt(11)
    v_mfma_f32_16x16x32_bf16 a[184:187], a[220:223], a[64:67], a[184:187]
    v_mfma_f32_16x16x32_bf16 a[188:191], a[220:223], a[80:83], a[188:191]
    ds_read_b128 a[204:207], v6 offset:20736
    s_waitcnt lgkmcnt(11)
    v_mfma_f32_16x16x32_bf16 a[128:131], a[224:227], a[68:71], a[128:131]
    v_mfma_f32_16x16x32_bf16 a[132:135], a[224:227], a[84:87], a[132:135]
    ds_read_b128 a[208:211], v6 offset:21760
    s_waitcnt lgkmcnt(11)
    v_mfma_f32_16x16x32_bf16 a[136:139], a[228:231], a[68:71], a[136:139]
    v_mfma_f32_16x16x32_bf16 a[140:143], a[228:231], a[84:87], a[140:143]
    ds_read_b128 a[212:215], v6 offset:22784
    s_waitcnt lgkmcnt(11)
    v_mfma_f32_16x16x32_bf16 a[144:147], a[232:235], a[68:71], a[144:147]
    v_mfma_f32_16x16x32_bf16 a[148:151], a[232:235], a[84:87], a[148:151]
    ds_read_b128 a[216:219], v6 offset:23808
    s_waitcnt lgkmcnt(11)
    v_mfma_f32_16x16x32_bf16 a[152:155], a[236:239], a[68:71], a[152:155]
    v_mfma_f32_16x16x32_bf16 a[156:159], a[236:239], a[84:87], a[156:159]
    ds_read_b128 a[220:223], v6 offset:24832
    s_waitcnt lgkmcnt(11)
    v_mfma_f32_16x16x32_bf16 a[160:163], a[240:243], a[68:71], a[160:163]
    v_mfma_f32_16x16x32_bf16 a[164:167], a[240:243], a[84:87], a[164:167]
    ds_read_b128 a[224:227], v6 offset:50944
    s_waitcnt lgkmcnt(11)
    v_mfma_f32_16x16x32_bf16 a[168:171], a[244:247], a[68:71], a[168:171]
    v_mfma_f32_16x16x32_bf16 a[172:175], a[244:247], a[84:87], a[172:175]
    ds_read_b128 a[228:231], v6 offset:51968
    s_waitcnt lgkmcnt(11)
    v_mfma_f32_16x16x32_bf16 a[176:179], a[248:251], a[68:71], a[176:179]
    v_mfma_f32_16x16x32_bf16 a[180:183], a[248:251], a[84:87], a[180:183]
    ds_read_b128 a[232:235], v6 offset:52992
    s_waitcnt lgkmcnt(11)
    v_mfma_f32_16x16x32_bf16 a[184:187], a[252:255], a[68:71], a[184:187]
    v_mfma_f32_16x16x32_bf16 a[188:191], a[252:255], a[84:87], a[188:191]
    ds_read_b128 a[236:239], v6 offset:54016
    s_waitcnt lgkmcnt(11)
    v_mfma_f32_16x16x32_bf16 a[128:131], a[192:195], a[72:75], a[128:131]
    v_mfma_f32_16x16x32_bf16 a[132:135], a[192:195], a[88:91], a[132:135]
    ds_read_b128 a[240:243], v6 offset:55040
    s_waitcnt lgkmcnt(11)
    v_mfma_f32_16x16x32_bf16 a[136:139], a[196:199], a[72:75], a[136:139]
    v_mfma_f32_16x16x32_bf16 a[140:143], a[196:199], a[88:91], a[140:143]
    ds_read_b128 a[244:247], v6 offset:56064
    s_waitcnt lgkmcnt(11)
    v_mfma_f32_16x16x32_bf16 a[144:147], a[200:203], a[72:75], a[144:147]
    v_mfma_f32_16x16x32_bf16 a[148:151], a[200:203], a[88:91], a[148:151]
    ds_read_b128 a[248:251], v6 offset:57088
    s_waitcnt lgkmcnt(11)
    v_mfma_f32_16x16x32_bf16 a[152:155], a[204:207], a[72:75], a[152:155]
    v_mfma_f32_16x16x32_bf16 a[156:159], a[204:207], a[88:91], a[156:159]
    ds_read_b128 a[252:255], v6 offset:58112
    s_waitcnt lgkmcnt(11)
    v_mfma_f32_16x16x32_bf16 a[160:163], a[208:211], a[72:75], a[160:163]
    v_mfma_f32_16x16x32_bf16 a[164:167], a[208:211], a[88:91], a[164:167]
    ds_read_b128 a[192:195], v0 offset:24960
    s_waitcnt lgkmcnt(11)
    v_mfma_f32_16x16x32_bf16 a[168:171], a[212:215], a[72:75], a[168:171]
    v_mfma_f32_16x16x32_bf16 a[172:175], a[212:215], a[88:91], a[172:175]
    ds_read_b128 a[196:199], v0 offset:25984
    s_waitcnt lgkmcnt(11)
    v_mfma_f32_16x16x32_bf16 a[176:179], a[216:219], a[72:75], a[176:179]
    v_mfma_f32_16x16x32_bf16 a[180:183], a[216:219], a[88:91], a[180:183]
    ds_read_b128 a[200:203], v0 offset:27008
    s_waitcnt lgkmcnt(11)
    v_mfma_f32_16x16x32_bf16 a[184:187], a[220:223], a[72:75], a[184:187]
    v_mfma_f32_16x16x32_bf16 a[188:191], a[220:223], a[88:91], a[188:191]
    ds_read_b128 a[204:207], v0 offset:28032
    s_waitcnt lgkmcnt(11)
    v_mfma_f32_16x16x32_bf16 a[128:131], a[224:227], a[76:79], a[128:131]
    v_mfma_f32_16x16x32_bf16 a[132:135], a[224:227], a[92:95], a[132:135]
    ds_read_b128 a[208:211], v0 offset:29056
    s_waitcnt lgkmcnt(11)
    v_mfma_f32_16x16x32_bf16 a[136:139], a[228:231], a[76:79], a[136:139]
    v_mfma_f32_16x16x32_bf16 a[140:143], a[228:231], a[92:95], a[140:143]
    ds_read_b128 a[212:215], v0 offset:30080
    s_waitcnt lgkmcnt(11)
    v_mfma_f32_16x16x32_bf16 a[144:147], a[232:235], a[76:79], a[144:147]
    v_mfma_f32_16x16x32_bf16 a[148:151], a[232:235], a[92:95], a[148:151]
    ds_read_b128 a[216:219], v0 offset:31104
    s_waitcnt lgkmcnt(11)
    v_mfma_f32_16x16x32_bf16 a[152:155], a[236:239], a[76:79], a[152:155]
    v_mfma_f32_16x16x32_bf16 a[156:159], a[236:239], a[92:95], a[156:159]
    ds_read_b128 a[220:223], v0 offset:32128
    s_waitcnt lgkmcnt(11)
    v_mfma_f32_16x16x32_bf16 a[160:163], a[240:243], a[76:79], a[160:163]
    v_mfma_f32_16x16x32_bf16 a[164:167], a[240:243], a[92:95], a[164:167]
    ds_read_b128 a[224:227], v0 offset:58240
    s_waitcnt lgkmcnt(11)
    v_mfma_f32_16x16x32_bf16 a[168:171], a[244:247], a[76:79], a[168:171]
    v_mfma_f32_16x16x32_bf16 a[172:175], a[244:247], a[92:95], a[172:175]
    ds_read_b128 a[228:231], v0 offset:59264
    s_waitcnt lgkmcnt(11)
    v_mfma_f32_16x16x32_bf16 a[176:179], a[248:251], a[76:79], a[176:179]
    v_mfma_f32_16x16x32_bf16 a[180:183], a[248:251], a[92:95], a[180:183]
    ds_read_b128 a[232:235], v0 offset:60288
    s_waitcnt lgkmcnt(11)
    v_mfma_f32_16x16x32_bf16 a[184:187], a[252:255], a[76:79], a[184:187]
    v_mfma_f32_16x16x32_bf16 a[188:191], a[252:255], a[92:95], a[188:191]
    ds_read_b128 a[236:239], v0 offset:61312
    s_waitcnt lgkmcnt(11)
    v_mfma_f32_16x16x32_bf16 a[128:131], a[192:195], a[96:99], a[128:131]
    v_mfma_f32_16x16x32_bf16 a[132:135], a[192:195], a[112:115], a[132:135]
    ds_read_b128 a[240:243], v0 offset:62336
    s_waitcnt lgkmcnt(11)
    v_mfma_f32_16x16x32_bf16 a[136:139], a[196:199], a[96:99], a[136:139]
    v_mfma_f32_16x16x32_bf16 a[140:143], a[196:199], a[112:115], a[140:143]
    ds_read_b128 a[244:247], v0 offset:63360
    s_waitcnt lgkmcnt(11)
    v_mfma_f32_16x16x32_bf16 a[144:147], a[200:203], a[96:99], a[144:147]
    v_mfma_f32_16x16x32_bf16 a[148:151], a[200:203], a[112:115], a[148:151]
    ds_read_b128 a[248:251], v0 offset:64384
    s_waitcnt lgkmcnt(11)
    v_mfma_f32_16x16x32_bf16 a[152:155], a[204:207], a[96:99], a[152:155]
    v_mfma_f32_16x16x32_bf16 a[156:159], a[204:207], a[112:115], a[156:159]
    ds_read_b128 a[252:255], v0 offset:65408
    s_waitcnt lgkmcnt(11)
    v_mfma_f32_16x16x32_bf16 a[160:163], a[208:211], a[96:99], a[160:163]
    v_mfma_f32_16x16x32_bf16 a[164:167], a[208:211], a[112:115], a[164:167]
    ds_read_b128 a[192:195], v6 offset:25984
    s_waitcnt lgkmcnt(11)
    v_mfma_f32_16x16x32_bf16 a[168:171], a[212:215], a[96:99], a[168:171]
    v_mfma_f32_16x16x32_bf16 a[172:175], a[212:215], a[112:115], a[172:175]
    ds_read_b128 a[196:199], v6 offset:27008
    s_waitcnt lgkmcnt(11)
    v_mfma_f32_16x16x32_bf16 a[176:179], a[216:219], a[96:99], a[176:179]
    v_mfma_f32_16x16x32_bf16 a[180:183], a[216:219], a[112:115], a[180:183]
    ds_read_b128 a[200:203], v6 offset:28032
    s_waitcnt lgkmcnt(11)
    v_mfma_f32_16x16x32_bf16 a[184:187], a[220:223], a[96:99], a[184:187]
    v_mfma_f32_16x16x32_bf16 a[188:191], a[220:223], a[112:115], a[188:191]
    ds_read_b128 a[204:207], v6 offset:29056
    s_waitcnt lgkmcnt(11)
    v_mfma_f32_16x16x32_bf16 a[128:131], a[224:227], a[100:103], a[128:131]
    v_mfma_f32_16x16x32_bf16 a[132:135], a[224:227], a[116:119], a[132:135]
    ds_read_b128 a[208:211], v6 offset:30080
    s_waitcnt lgkmcnt(11)
    v_mfma_f32_16x16x32_bf16 a[136:139], a[228:231], a[100:103], a[136:139]
    v_mfma_f32_16x16x32_bf16 a[140:143], a[228:231], a[116:119], a[140:143]
    ds_read_b128 a[212:215], v6 offset:31104
    s_waitcnt lgkmcnt(11)
    v_mfma_f32_16x16x32_bf16 a[144:147], a[232:235], a[100:103], a[144:147]
    v_mfma_f32_16x16x32_bf16 a[148:151], a[232:235], a[116:119], a[148:151]
    ds_read_b128 a[216:219], v6 offset:32128
    s_waitcnt lgkmcnt(11)
    v_mfma_f32_16x16x32_bf16 a[152:155], a[236:239], a[100:103], a[152:155]
    v_mfma_f32_16x16x32_bf16 a[156:159], a[236:239], a[116:119], a[156:159]
    ds_read_b128 a[220:223], v6 offset:33152
    s_waitcnt lgkmcnt(11)
    v_mfma_f32_16x16x32_bf16 a[160:163], a[240:243], a[100:103], a[160:163]
    v_mfma_f32_16x16x32_bf16 a[164:167], a[240:243], a[116:119], a[164:167]
    ds_read_b128 a[224:227], v6 offset:59264
    s_waitcnt lgkmcnt(11)
    v_mfma_f32_16x16x32_bf16 a[168:171], a[244:247], a[100:103], a[168:171]
    v_mfma_f32_16x16x32_bf16 a[172:175], a[244:247], a[116:119], a[172:175]
    ds_read_b128 a[228:231], v6 offset:60288
    s_waitcnt lgkmcnt(11)
    v_mfma_f32_16x16x32_bf16 a[176:179], a[248:251], a[100:103], a[176:179]
    v_mfma_f32_16x16x32_bf16 a[180:183], a[248:251], a[116:119], a[180:183]
    ds_read_b128 a[232:235], v6 offset:61312
    s_waitcnt lgkmcnt(11)
    v_mfma_f32_16x16x32_bf16 a[184:187], a[252:255], a[100:103], a[184:187]
    v_mfma_f32_16x16x32_bf16 a[188:191], a[252:255], a[116:119], a[188:191]
    ds_read_b128 a[236:239], v6 offset:62336
    s_waitcnt lgkmcnt(11)
    v_mfma_f32_16x16x32_bf16 a[128:131], a[192:195], a[104:107], a[128:131]
    v_mfma_f32_16x16x32_bf16 a[132:135], a[192:195], a[120:123], a[132:135]
    ds_read_b128 a[240:243], v6 offset:63360
    s_waitcnt lgkmcnt(11)
    v_mfma_f32_16x16x32_bf16 a[136:139], a[196:199], a[104:107], a[136:139]
    v_mfma_f32_16x16x32_bf16 a[140:143], a[196:199], a[120:123], a[140:143]
    ds_read_b128 a[244:247], v6 offset:64384
    s_waitcnt lgkmcnt(11)
    v_mfma_f32_16x16x32_bf16 a[144:147], a[200:203], a[104:107], a[144:147]
    v_mfma_f32_16x16x32_bf16 a[148:151], a[200:203], a[120:123], a[148:151]
    ds_read_b128 a[248:251], v6 offset:65408
    s_waitcnt lgkmcnt(11)
    v_mfma_f32_16x16x32_bf16 a[152:155], a[204:207], a[104:107], a[152:155]
    v_mfma_f32_16x16x32_bf16 a[156:159], a[204:207], a[120:123], a[156:159]
    ds_read_b128 a[252:255], v7 offset:896
    s_waitcnt lgkmcnt(11)
    v_mfma_f32_16x16x32_bf16 a[160:163], a[208:211], a[104:107], a[160:163]
    v_mfma_f32_16x16x32_bf16 a[164:167], a[208:211], a[120:123], a[164:167]
    s_waitcnt lgkmcnt(10)
    v_mfma_f32_16x16x32_bf16 a[168:171], a[212:215], a[104:107], a[168:171]
    v_mfma_f32_16x16x32_bf16 a[172:175], a[212:215], a[120:123], a[172:175]
    s_waitcnt lgkmcnt(9)
    v_mfma_f32_16x16x32_bf16 a[176:179], a[216:219], a[104:107], a[176:179]
    v_mfma_f32_16x16x32_bf16 a[180:183], a[216:219], a[120:123], a[180:183]
    s_waitcnt lgkmcnt(8)
    v_mfma_f32_16x16x32_bf16 a[184:187], a[220:223], a[104:107], a[184:187]
    v_mfma_f32_16x16x32_bf16 a[188:191], a[220:223], a[120:123], a[188:191]
    s_waitcnt lgkmcnt(7)
    v_mfma_f32_16x16x32_bf16 a[128:131], a[224:227], a[108:111], a[128:131]
    v_mfma_f32_16x16x32_bf16 a[132:135], a[224:227], a[124:127], a[132:135]
    s_waitcnt lgkmcnt(6)
    v_mfma_f32_16x16x32_bf16 a[136:139], a[228:231], a[108:111], a[136:139]
    v_mfma_f32_16x16x32_bf16 a[140:143], a[228:231], a[124:127], a[140:143]
    s_waitcnt lgkmcnt(5)
    v_mfma_f32_16x16x32_bf16 a[144:147], a[232:235], a[108:111], a[144:147]
    v_mfma_f32_16x16x32_bf16 a[148:151], a[232:235], a[124:127], a[148:151]
    s_waitcnt lgkmcnt(4)
    v_mfma_f32_16x16x32_bf16 a[152:155], a[236:239], a[108:111], a[152:155]
    v_mfma_f32_16x16x32_bf16 a[156:159], a[236:239], a[124:127], a[156:159]
    s_waitcnt lgkmcnt(3)
    v_mfma_f32_16x16x32_bf16 a[160:163], a[240:243], a[108:111], a[160:163]
    v_mfma_f32_16x16x32_bf16 a[164:167], a[240:243], a[124:127], a[164:167]
    s_waitcnt lgkmcnt(2)
    v_mfma_f32_16x16x32_bf16 a[168:171], a[244:247], a[108:111], a[168:171]
    v_mfma_f32_16x16x32_bf16 a[172:175], a[244:247], a[124:127], a[172:175]
    s_waitcnt lgkmcnt(1)
    v_mfma_f32_16x16x32_bf16 a[176:179], a[248:251], a[108:111], a[176:179]
    v_mfma_f32_16x16x32_bf16 a[180:183], a[248:251], a[124:127], a[180:183]
    s_waitcnt lgkmcnt(0)
    v_mfma_f32_16x16x32_bf16 a[184:187], a[252:255], a[108:111], a[184:187]
    v_mfma_f32_16x16x32_bf16 a[188:191], a[252:255], a[124:127], a[188:191]
    s_waitcnt lgkmcnt(0)
    s_barrier
    s_add_u32 m0, s98, 0x0
    s_xor_b32 s97, s99, 0x0
    buffer_load_dwordx4 v1, s[52:55], s97 offen nt lds
    s_add_u32 m0, s98, 0x310
    s_xor_b32 s97, s99, 0x0
    buffer_load_dwordx4 v1, s[52:55], s97 offen offset:256 nt lds
    s_add_u32 m0, s98, 0x620
    s_xor_b32 s97, s99, 0x0
    buffer_load_dwordx4 v1, s[52:55], s97 offen offset:512 nt lds
    s_add_u32 m0, s98, 0x930
    s_xor_b32 s97, s99, 0x0
    buffer_load_dwordx4 v1, s[52:55], s97 offen offset:768 nt lds
    s_add_u32 m0, s98, 0x1040
    s_xor_b32 s97, s99, 0x1000
    buffer_load_dwordx4 v1, s[52:55], s97 offen nt lds
    s_add_u32 m0, s98, 0x1350
    s_xor_b32 s97, s99, 0x1000
    buffer_load_dwordx4 v1, s[52:55], s97 offen offset:256 nt lds
    s_add_u32 m0, s98, 0x1660
    s_xor_b32 s97, s99, 0x1000
    buffer_load_dwordx4 v1, s[52:55], s97 offen offset:512 nt lds
    s_add_u32 m0, s98, 0x1970
    s_xor_b32 s97, s99, 0x1000
    buffer_load_dwordx4 v1, s[52:55], s97 offen offset:768 nt lds
    s_add_u32 m0, s98, 0x2080
    s_xor_b32 s97, s99, 0x2000
    buffer_load_dwordx4 v1, s[52:55], s97 offen nt lds
    s_add_u32 m0, s98, 0x2390
    s_xor_b32 s97, s99, 0x2000
    buffer_load_dwordx4 v1, s[52:55], s97 offen offset:256 nt lds
    s_add_u32 m0, s98, 0x26a0
    s_xor_b32 s97, s99, 0x2000
    buffer_load_dwordx4 v1, s[52:55], s97 offen offset:512 nt lds
    s_add_u32 m0, s98, 0x29b0
    s_xor_b32 s97, s99, 0x2000
    buffer_load_dwordx4 v1, s[52:55], s97 offen offset:768 nt lds
    s_add_u32 m0, s98, 0x30c0
    s_xor_b32 s97, s99, 0x3000
    buffer_load_dwordx4 v1, s[52:55], s97 offen nt lds
    s_add_u32 m0, s98, 0x33d0
    s_xor_b32 s97, s99, 0x3000
    buffer_load_dwordx4 v1, s[52:55], s97 offen offset:256 nt lds
    s_add_u32 m0, s98, 0x36e0
    s_xor_b32 s97, s99, 0x3000
    buffer_load_dwordx4 v1, s[52:55], s97 offen offset:512 nt lds
    s_add_u32 m0, s98, 0x39f0
    s_xor_b32 s97, s99, 0x3000
    buffer_load_dwordx4 v1, s[52:55], s97 offen offset:768 nt lds
    s_add_u32 m0, s98, 0x4100
    s_xor_b32 s97, s99, 0x4000
    buffer_load_dwordx4 v1, s[52:55], s97 offen nt lds
    s_add_u32 m0, s98, 0x4410
    s_xor_b32 s97, s99, 0x4000
    buffer_load_dwordx4 v1, s[52:55], s97 offen offset:256 nt lds
    s_add_u32 m0, s98, 0x4720
    s_xor_b32 s97, s99, 0x4000
    buffer_load_dwordx4 v1, s[52:55], s97 offen offset:512 nt lds
    s_add_u32 m0, s98, 0x4a30
    s_xor_b32 s97, s99, 0x4000
    buffer_load_dwordx4 v1, s[52:55], s97 offen offset:768 nt lds
    s_add_u32 m0, s98, 0x5140
    s_xor_b32 s97, s99, 0x5000
    buffer_load_dwordx4 v1, s[52:55], s97 offen nt lds
    s_add_u32 m0, s98, 0x5450
    s_xor_b32 s97, s99, 0x5000
    buffer_load_dwordx4 v1, s[52:55], s97 offen offset:256 nt lds
    s_waitcnt vmcnt(61)
    s_add_u32 m0, s98, 0x5760
    s_xor_b32 s97, s99, 0x5000
    buffer_load_dwordx4 v1, s[52:55], s97 offen offset:512 nt lds
    s_waitcnt vmcnt(61)
    s_add_u32 m0, s98, 0x5a70
    s_xor_b32 s97, s99, 0x5000
    buffer_load_dwordx4 v1, s[52:55], s97 offen offset:768 nt lds
    s_waitcnt vmcnt(61)
    s_add_u32 m0, s98, 0x6180
    s_xor_b32 s97, s99, 0x6000
    buffer_load_dwordx4 v1, s[52:55], s97 offen nt lds
    s_waitcnt vmcnt(61)
    s_add_u32 m0, s98, 0x6490
    s_xor_b32 s97, s99, 0x6000
    buffer_load_dwordx4 v1, s[52:55], s97 offen offset:256 nt lds
    s_waitcnt vmcnt(61)
    s_add_u32 m0, s98, 0x67a0
    s_xor_b32 s97, s99, 0x6000
    buffer_load_dwordx4 v1, s[52:55], s97 offen offset:512 nt lds
    s_waitcnt vmcnt(61)
    s_add_u32 m0, s98, 0x6ab0
    s_xor_b32 s97, s99, 0x6000
    buffer_load_dwordx4 v1, s[52:55], s97 offen offset:768 nt lds
    s_waitcnt vmcnt(61)
    s_add_u32 m0, s98, 0x71c0
    s_xor_b32 s97, s99, 0x7000
    buffer_load_dwordx4 v1, s[52:55], s97 offen nt lds
    s_waitcnt vmcnt(61)
    s_add_u32 m0, s98, 0x74d0
    s_xor_b32 s97, s99, 0x7000
    buffer_load_dwordx4 v1, s[52:55], s97 offen offset:256 nt lds
    s_waitcnt vmcnt(61)
    s_add_u32 m0, s98, 0x77e0
    s_xor_b32 s97, s99, 0x7000
    buffer_load_dwordx4 v1, s[52:55], s97 offen offset:512 nt lds
    s_waitcnt vmcnt(61)
    s_add_u32 m0, s98, 0x7af0
    s_xor_b32 s97, s99, 0x7000
    buffer_load_dwordx4 v1, s[52:55], s97 offen offset:768 nt lds
    v_accvgpr_read_b32 v10, a128
    v_accvgpr_read_b32 v11, a136
    v_accvgpr_read_b32 v12, a144
    v_accvgpr_read_b32 v13, a152
    v_accvgpr_read_b32 v14, a160
    v_accvgpr_read_b32 v15, a168
    v_accvgpr_read_b32 v16, a176
    v_accvgpr_read_b32 v17, a184
    v_cvt_pk_bf16_f32 v18, v10, v11
    v_cvt_pk_bf16_f32 v19, v12, v13
    v_cvt_pk_bf16_f32 v20, v14, v15
    v_cvt_pk_bf16_f32 v21, v16, v17
    v_accvgpr_write_b32 a192, v18
    v_accvgpr_write_b32 a193, v19
    v_accvgpr_write_b32 a194, v20
    v_accvgpr_write_b32 a195, v21
    v_accvgpr_read_b32 v10, a129
    v_accvgpr_read_b32 v11, a137
    v_accvgpr_read_b32 v12, a145
    v_accvgpr_read_b32 v13, a153
    v_accvgpr_read_b32 v14, a161
    v_accvgpr_read_b32 v15, a169
    v_accvgpr_read_b32 v16, a177
    v_accvgpr_read_b32 v17, a185
    v_cvt_pk_bf16_f32 v18, v10, v11
    v_cvt_pk_bf16_f32 v19, v12, v13
    v_cvt_pk_bf16_f32 v20, v14, v15
    v_cvt_pk_bf16_f32 v21, v16, v17
    v_accvgpr_write_b32 a200, v18
    v_accvgpr_write_b32 a201, v19
    v_accvgpr_write_b32 a202, v20
    v_accvgpr_write_b32 a203, v21
    v_accvgpr_read_b32 v10, a130
    v_accvgpr_read_b32 v11, a138
    v_accvgpr_read_b32 v12, a146
    v_accvgpr_read_b32 v13, a154
    v_accvgpr_read_b32 v14, a162
    v_accvgpr_read_b32 v15, a170
    v_accvgpr_read_b32 v16, a178
    v_accvgpr_read_b32 v17, a186
    v_cvt_pk_bf16_f32 v18, v10, v11
    v_cvt_pk_bf16_f32 v19, v12, v13
    v_cvt_pk_bf16_f32 v20, v14, v15
    v_cvt_pk_bf16_f32 v21, v16, v17
    v_accvgpr_write_b32 a208, v18
    v_accvgpr_write_b32 a209, v19
    v_accvgpr_write_b32 a210, v20
    v_accvgpr_write_b32 a211, v21
    v_accvgpr_read_b32 v10, a131
    v_accvgpr_read_b32 v11, a139
    v_accvgpr_read_b32 v12, a147
    v_accvgpr_read_b32 v13, a155
    v_accvgpr_read_b32 v14, a163
    v_accvgpr_read_b32 v15, a171
    v_accvgpr_read_b32 v16, a179
    v_accvgpr_read_b32 v17, a187
    v_cvt_pk_bf16_f32 v18, v10, v11
    v_cvt_pk_bf16_f32 v19, v12, v13
    v_cvt_pk_bf16_f32 v20, v14, v15
    v_cvt_pk_bf16_f32 v21, v16, v17
    v_accvgpr_write_b32 a216, v18
    v_accvgpr_write_b32 a217, v19
    v_accvgpr_write_b32 a218, v20
    v_accvgpr_write_b32 a219, v21
    v_accvgpr_read_b32 v10, a132
    v_accvgpr_read_b32 v11, a140
    v_accvgpr_read_b32 v12, a148
    v_accvgpr_read_b32 v13, a156
    v_accvgpr_read_b32 v14, a164
    v_accvgpr_read_b32 v15, a172
    v_accvgpr_read_b32 v16, a180
    v_accvgpr_read_b32 v17, a188
    v_cvt_pk_bf16_f32 v18, v10, v11
    v_cvt_pk_bf16_f32 v19, v12, v13
    v_cvt_pk_bf16_f32 v20, v14, v15
    v_cvt_pk_bf16_f32 v21, v16, v17
    v_accvgpr_write_b32 a196, v18
    v_accvgpr_write_b32 a197, v19
    v_accvgpr_write_b32 a198, v20
    v_accvgpr_write_b32 a199, v21
    v_accvgpr_read_b32 v10, a133
    v_accvgpr_read_b32 v11, a141
    v_accvgpr_read_b32 v12, a149
    v_accvgpr_read_b32 v13, a157
    v_accvgpr_read_b32 v14, a165
    v_accvgpr_read_b32 v15, a173
    v_accvgpr_read_b32 v16, a181
    v_accvgpr_read_b32 v17, a189
    v_cvt_pk_bf16_f32 v18, v10, v11
    v_cvt_pk_bf16_f32 v19, v12, v13
    v_cvt_pk_bf16_f32 v20, v14, v15
    v_cvt_pk_bf16_f32 v21, v16, v17
    v_accvgpr_write_b32 a204, v18
    v_accvgpr_write_b32 a205, v19
    v_accvgpr_write_b32 a206, v20
    v_accvgpr_write_b32 a207, v21
    v_accvgpr_read_b32 v10, a134
    v_accvgpr_read_b32 v11, a142
    v_accvgpr_read_b32 v12, a150
    v_accvgpr_read_b32 v13, a158
    v_accvgpr_read_b32 v14, a166
    v_accvgpr_read_b32 v15, a174
    v_accvgpr_read_b32 v16, a182
    v_accvgpr_read_b32 v17, a190
    v_cvt_pk_bf16_f32 v18, v10, v11
    v_cvt_pk_bf16_f32 v19, v12, v13
    v_cvt_pk_bf16_f32 v20, v14, v15
    v_cvt_pk_bf16_f32 v21, v16, v17
    v_accvgpr_write_b32 a212, v18
    v_accvgpr_write_b32 a213, v19
    v_accvgpr_write_b32 a214, v20
    v_accvgpr_write_b32 a215, v21
    v_accvgpr_read_b32 v10, a135
    v_accvgpr_read_b32 v11, a143
    v_accvgpr_read_b32 v12, a151
    v_accvgpr_read_b32 v13, a159
    v_accvgpr_read_b32 v14, a167
    v_accvgpr_read_b32 v15, a175
    v_accvgpr_read_b32 v16, a183
    v_accvgpr_read_b32 v17, a191
    v_cvt_pk_bf16_f32 v18, v10, v11
    v_cvt_pk_bf16_f32 v19, v12, v13
    v_cvt_pk_bf16_f32 v20, v14, v15
    v_cvt_pk_bf16_f32 v21, v16, v17
    v_accvgpr_write_b32 a220, v18
    v_accvgpr_write_b32 a221, v19
    v_accvgpr_write_b32 a222, v20
    v_accvgpr_write_b32 a223, v21
    s_waitcnt vmcnt(24)
    ds_read_b128 v[224:227], v2
    ds_read_b128 v[228:231], v2 offset:16
    ds_read_b128 v[232:235], v2 offset:32
    ds_read_b128 v[236:239], v2 offset:48
    ds_read_b128 v[240:243], v2 offset:4160
    ds_read_b128 v[244:247], v2 offset:4176
    ds_read_b128 v[248:251], v2 offset:4192
    ds_read_b128 v[252:255], v2 offset:4208
    s_waitcnt lgkmcnt(0)
    v_mfma_f32_16x16x32_bf16 a[0:3], v[224:227], a[192:195], 0
    s_add_u32 m0, s98, 0x0
    s_xor_b32 s97, s99, 0x8000
    buffer_load_dwordx4 v1, s[52:55], s97 offen nt lds
    v_mfma_f32_16x16x32_bf16 a[4:7], v[224:227], a[196:199], 0
    v_mfma_f32_16x16x32_bf16 a[8:11], v[240:243], a[192:195], 0
    v_mfma_f32_16x16x32_bf16 a[12:15], v[240:243], a[196:199], 0
    v_mfma_f32_16x16x32_bf16 a[0:3], v[228:231], a[200:203], a[0:3]
    v_mfma_f32_16x16x32_bf16 a[4:7], v[228:231], a[204:207], a[4:7]
    v_mfma_f32_16x16x32_bf16 a[8:11], v[244:247], a[200:203], a[8:11]
    v_mfma_f32_16x16x32_bf16 a[12:15], v[244:247], a[204:207], a[12:15]
    v_mfma_f32_16x16x32_bf16 a[0:3], v[232:235], a[208:211], a[0:3]
    v_mfma_f32_16x16x32_bf16 a[4:7], v[232:235], a[212:215], a[4:7]
    v_mfma_f32_16x16x32_bf16 a[8:11], v[248:251], a[208:211], a[8:11]
    v_mfma_f32_16x16x32_bf16 a[12:15], v[248:251], a[212:215], a[12:15]
    v_mfma_f32_16x16x32_bf16 a[0:3], v[236:239], a[216:219], a[0:3]
    v_mfma_f32_16x16x32_bf16 a[4:7], v[236:239], a[220:223], a[4:7]
    s_add_u32 m0, s98, 0x310
    s_xor_b32 s97, s99, 0x8000
    buffer_load_dwordx4 v1, s[52:55], s97 offen offset:256 nt lds
    v_mfma_f32_16x16x32_bf16 a[8:11], v[252:255], a[216:219], a[8:11]
    v_mfma_f32_16x16x32_bf16 a[12:15], v[252:255], a[220:223], a[12:15]
    s_waitcnt vmcnt(18)
    ds_read_b128 v[32:35], v2 offset:8320
    ds_read_b128 v[36:39], v2 offset:8336
    ds_read_b128 v[40:43], v2 offset:8352
    ds_read_b128 v[44:47], v2 offset:8368
    ds_read_b128 v[48:51], v2 offset:12480
    ds_read_b128 v[52:55], v2 offset:12496
    ds_read_b128 v[56:59], v2 offset:12512
    ds_read_b128 v[60:63], v2 offset:12528
    s_waitcnt lgkmcnt(0)
    v_mfma_f32_16x16x32_bf16 a[16:19], v[32:35], a[192:195], 0
    v_mfma_f32_16x16x32_bf16 a[20:23], v[32:35], a[196:199], 0
    v_mfma_f32_16x16x32_bf16 a[24:27], v[48:51], a[192:195], 0
    s_add_u32 m0, s98, 0x620
    s_xor_b32 s97, s99, 0x8000
    buffer_load_dwordx4 v1, s[52:55], s97 offen offset:512 nt lds
    v_mfma_f32_16x16x32_bf16 a[28:31], v[48:51], a[196:199], 0
    v_accvgpr_read_b32 v10, a0
    v_accvgpr_read_b32 v11, a1
    v_mfma_f32_16x16x32_bf16 a[16:19], v[36:39], a[200:203], a[16:19]
    v_accvgpr_read_b32 v12, a2
    v_accvgpr_read_b32 v13, a3
    v_mfma_f32_16x16x32_bf16 a[20:23], v[36:39], a[204:207], a[20:23]
    v_accvgpr_read_b32 v14, a8
    v_accvgpr_read_b32 v15, a9
    v_mfma_f32_16x16x32_bf16 a[24:27], v[52:55], a[200:203], a[24:27]
    v_accvgpr_read_b32 v16, a10
    v_accvgpr_read_b32 v17, a11
    v_mfma_f32_16x16x32_bf16 a[28:31], v[52:55], a[204:207], a[28:31]
    v_accvgpr_read_b32 v18, a4
    v_accvgpr_read_b32 v19, a5
    v_mfma_f32_16x16x32_bf16 a[16:19], v[40:43], a[208:211], a[16:19]
    v_accvgpr_read_b32 v20, a6
    v_accvgpr_read_b32 v21, a7
    v_mfma_f32_16x16x32_bf16 a[20:23], v[40:43], a[212:215], a[20:23]
    v_accvgpr_read_b32 v22, a12
    v_accvgpr_read_b32 v23, a13
    v_mfma_f32_16x16x32_bf16 a[24:27], v[56:59], a[208:211], a[24:27]
    v_accvgpr_read_b32 v24, a14
    v_accvgpr_read_b32 v25, a15
    v_mfma_f32_16x16x32_bf16 a[28:31], v[56:59], a[212:215], a[28:31]
    v_max3_f32 v26, v10, v11, v12
    v_max3_f32 v26, v26, v13, v14
    v_mfma_f32_16x16x32_bf16 a[16:19], v[44:47], a[216:219], a[16:19]
    v_max3_f32 v26, v26, v15, v16
    v_max_f32 v26, v26, v17
    v_mfma_f32_16x16x32_bf16 a[20:23], v[44:47], a[220:223], a[20:23]
    v_max3_f32 v27, v18, v19, v20
    v_max3_f32 v27, v27, v21, v22
    v_mfma_f32_16x16x32_bf16 a[24:27], v[60:63], a[216:219], a[24:27]
    v_max3_f32 v27, v27, v23, v24
    v_max_f32 v27, v27, v25
    v_mfma_f32_16x16x32_bf16 a[28:31], v[60:63], a[220:223], a[28:31]
    s_add_u32 m0, s98, 0x930
    s_xor_b32 s97, s99, 0x8000
    buffer_load_dwordx4 v1, s[52:55], s97 offen offset:768 nt lds
    s_add_u32 m0, s98, 0x1040
    s_xor_b32 s97, s99, 0x9000
    buffer_load_dwordx4 v1, s[52:55], s97 offen nt lds
    s_add_u32 m0, s98, 0x1350
    s_xor_b32 s97, s99, 0x9000
    buffer_load_dwordx4 v1, s[52:55], s97 offen offset:256 nt lds
    s_add_u32 m0, s98, 0x1660
    s_xor_b32 s97, s99, 0x9000
    buffer_load_dwordx4 v1, s[52:55], s97 offen offset:512 nt lds
    s_add_u32 m0, s98, 0x1970
    s_xor_b32 s97, s99, 0x9000
    buffer_load_dwordx4 v1, s[52:55], s97 offen offset:768 nt lds
    s_waitcnt vmcnt(16)
    ds_read_b128 v[224:227], v2 offset:16640
    ds_read_b128 v[228:231], v2 offset:16656
    ds_read_b128 v[232:235], v2 offset:16672
    ds_read_b128 v[236:239], v2 offset:16688
    ds_read_b128 v[240:243], v2 offset:20800
    ds_read_b128 v[244:247], v2 offset:20816
    ds_read_b128 v[248:251], v2 offset:20832
    ds_read_b128 v[252:255], v2 offset:20848
    s_waitcnt lgkmcnt(0)
    v_mfma_f32_16x16x32_bf16 a[32:35], v[224:227], a[192:195], 0
    v_mfma_f32_16x16x32_bf16 a[36:39], v[224:227], a[196:199], 0
    v_mfma_f32_16x16x32_bf16 a[40:43], v[240:243], a[192:195], 0
    v_mfma_f32_16x16x32_bf16 a[44:47], v[240:243], a[196:199], 0
    s_add_u32 m0, s98, 0x2080
    s_xor_b32 s97, s99, 0xa000
    buffer_load_dwordx4 v1, s[52:55], s97 offen nt lds
    v_accvgpr_read_b32 v10, a16
    v_accvgpr_read_b32 v11, a17
    v_mfma_f32_16x16x32_bf16 a[32:35], v[228:231], a[200:203], a[32:35]
    v_accvgpr_read_b32 v12, a18
    v_accvgpr_read_b32 v13, a19
    v_mfma_f32_16x16x32_bf16 a[36:39], v[228:231], a[204:207], a[36:39]
    v_accvgpr_read_b32 v14, a24
    v_accvgpr_read_b32 v15, a25
    v_mfma_f32_16x16x32_bf16 a[40:43], v[244:247], a[200:203], a[40:43]
    v_accvgpr_read_b32 v16, a26
    v_accvgpr_read_b32 v17, a27
    v_mfma_f32_16x16x32_bf16 a[44:47], v[244:247], a[204:207], a[44:47]
    v_accvgpr_read_b32 v18, a20
    v_accvgpr_read_b32 v19, a21
    v_mfma_f32_16x16x32_bf16 a[32:35], v[232:235], a[208:211], a[32:35]
    v_accvgpr_read_b32 v20, a22
    v_accvgpr_read_b32 v21, a23
    v_mfma_f32_16x16x32_bf16 a[36:39], v[232:235], a[212:215], a[36:39]
    v_accvgpr_read_b32 v22, a28
    v_accvgpr_read_b32 v23, a29
    v_mfma_f32_16x16x32_bf16 a[40:43], v[248:251], a[208:211], a[40:43]
    v_accvgpr_read_b32 v24, a30
    v_accvgpr_read_b32 v25, a31
    v_mfma_f32_16x16x32_bf16 a[44:47], v[248:251], a[212:215], a[44:47]
    v_max3_f32 v26, v26, v10, v11
    v_max3_f32 v26, v26, v12, v13
    v_mfma_f32_16x16x32_bf16 a[32:35], v[236:239], a[216:219], a[32:35]
    v_max3_f32 v26, v26, v14, v15
    v_max3_f32 v26, v26, v16, v17
    v_mfma_f32_16x16x32_bf16 a[36:39], v[236:239], a[220:223], a[36:39]
    v_max3_f32 v27, v27, v18, v19
    v_max3_f32 v27, v27, v20, v21
    v_mfma_f32_16x16x32_bf16 a[40:43], v[252:255], a[216:219], a[40:43]
    v_max3_f32 v27, v27, v22, v23
    v_max3_f32 v27, v27, v24, v25
    v_mfma_f32_16x16x32_bf16 a[44:47], v[252:255], a[220:223], a[44:47]
    s_add_u32 m0, s98, 0x2390
    s_xor_b32 s97, s99, 0xa000
    buffer_load_dwordx4 v1, s[52:55], s97 offen offset:256 nt lds
    s_add_u32 m0, s98, 0x26a0
    s_xor_b32 s97, s99, 0xa000
    buffer_load_dwordx4 v1, s[52:55], s97 offen offset:512 nt lds
    s_add_u32 m0, s98, 0x29b0
    s_xor_b32 s97, s99, 0xa000
    buffer_load_dwordx4 v1, s[52:55], s97 offen offset:768 nt lds
    s_add_u32 m0, s98, 0x30c0
    s_xor_b32 s97, s99, 0xb000
    buffer_load_dwordx4 v1, s[52:55], s97 offen nt lds
    s_add_u32 m0, s98, 0x33d0
    s_xor_b32 s97, s99, 0xb000
    buffer_load_dwordx4 v1, s[52:55], s97 offen offset:256 nt lds
    s_add_u32 m0, s98, 0x36e0
    s_xor_b32 s97, s99, 0xb000
    buffer_load_dwordx4 v1, s[52:55], s97 offen offset:512 nt lds
    s_add_u32 m0, s98, 0x39f0
    s_xor_b32 s97, s99, 0xb000
    buffer_load_dwordx4 v1, s[52:55], s97 offen offset:768 nt lds
    s_waitcnt vmcnt(16)
    ds_read_b128 v[32:35], v2 offset:24960
    ds_read_b128 v[36:39], v2 offset:24976
    ds_read_b128 v[40:43], v2 offset:24992
    ds_read_b128 v[44:47], v2 offset:25008
    ds_read_b128 v[48:51], v2 offset:29120
    ds_read_b128 v[52:55], v2 offset:29136
    ds_read_b128 v[56:59], v2 offset:29152
    ds_read_b128 v[60:63], v2 offset:29168
    s_waitcnt lgkmcnt(0)
    v_mfma_f32_16x16x32_bf16 a[48:51], v[32:35], a[192:195], 0
    v_mfma_f32_16x16x32_bf16 a[52:55], v[32:35], a[196:199], 0
    v_mfma_f32_16x16x32_bf16 a[56:59], v[48:51], a[192:195], 0
    v_mfma_f32_16x16x32_bf16 a[60:63], v[48:51], a[196:199], 0
    s_add_u32 m0, s98, 0x4100
    s_xor_b32 s97, s99, 0xc000
    buffer_load_dwordx4 v1, s[52:55], s97 offen nt lds
    v_accvgpr_read_b32 v10, a32
    v_accvgpr_read_b32 v11, a33
    v_mfma_f32_16x16x32_bf16 a[48:51], v[36:39], a[200:203], a[48:51]
    v_accvgpr_read_b32 v12, a34
    v_accvgpr_read_b32 v13, a35
    v_mfma_f32_16x16x32_bf16 a[52:55], v[36:39], a[204:207], a[52:55]
    v_accvgpr_read_b32 v14, a40
    v_accvgpr_read_b32 v15, a41
    v_mfma_f32_16x16x32_bf16 a[56:59], v[52:55], a[200:203], a[56:59]
    v_accvgpr_read_b32 v16, a42
    v_accvgpr_read_b32 v17, a43
    v_mfma_f32_16x16x32_bf16 a[60:63], v[52:55], a[204:207], a[60:63]
    v_accvgpr_read_b32 v18, a36
    v_accvgpr_read_b32 v19, a37
    v_mfma_f32_16x16x32_bf16 a[48:51], v[40:43], a[208:211], a[48:51]
    v_accvgpr_read_b32 v20, a38
    v_accvgpr_read_b32 v21, a39
    v_mfma_f32_16x16x32_bf16 a[52:55], v[40:43], a[212:215], a[52:55]
    v_accvgpr_read_b32 v22, a44
    v_accvgpr_read_b32 v23, a45
    v_mfma_f32_16x16x32_bf16 a[56:59], v[56:59], a[208:211], a[56:59]
    v_accvgpr_read_b32 v24, a46
    v_accvgpr_read_b32 v25, a47
    v_mfma_f32_16x16x32_bf16 a[60:63], v[56:59], a[212:215], a[60:63]
    v_max3_f32 v26, v26, v10, v11
    v_max3_f32 v26, v26, v12, v13
    v_mfma_f32_16x16x32_bf16 a[48:51], v[44:47], a[216:219], a[48:51]
    v_max3_f32 v26, v26, v14, v15
    v_max3_f32 v26, v26, v16, v17
    v_mfma_f32_16x16x32_bf16 a[52:55], v[44:47], a[220:223], a[52:55]
    v_max3_f32 v27, v27, v18, v19
    v_max3_f32 v27, v27, v20, v21
    v_mfma_f32_16x16x32_bf16 a[56:59], v[60:63], a[216:219], a[56:59]
    v_max3_f32 v27, v27, v22, v23
    v_max3_f32 v27, v27, v24, v25
    v_mfma_f32_16x16x32_bf16 a[60:63], v[60:63], a[220:223], a[60:63]
    s_add_u32 m0, s98, 0x4410
    s_xor_b32 s97, s99, 0xc000
    buffer_load_dwordx4 v1, s[52:55], s97 offen offset:256 nt lds
    s_add_u32 m0, s98, 0x4720
    s_xor_b32 s97, s99, 0xc000
    buffer_load_dwordx4 v1, s[52:55], s97 offen offset:512 nt lds
    s_add_u32 m0, s98, 0x4a30
    s_xor_b32 s97, s99, 0xc000
    buffer_load_dwordx4 v1, s[52:55], s97 offen offset:768 nt lds
    s_add_u32 m0, s98, 0x5140
    s_xor_b32 s97, s99, 0xd000
    buffer_load_dwordx4 v1, s[52:55], s97 offen nt lds
    s_add_u32 m0, s98, 0x5450
    s_xor_b32 s97, s99, 0xd000
    buffer_load_dwordx4 v1, s[52:55], s97 offen offset:256 nt lds
    s_add_u32 m0, s98, 0x5760
    s_xor_b32 s97, s99, 0xd000
    buffer_load_dwordx4 v1, s[52:55], s97 offen offset:512 nt lds
    s_add_u32 m0, s98, 0x5a70
    s_xor_b32 s97, s99, 0xd000
    buffer_load_dwordx4 v1, s[52:55], s97 offen offset:768 nt lds
    s_waitcnt vmcnt(16)
    ds_read_b128 v[224:227], v2
    ds_read_b128 v[228:231], v2 offset:16
    ds_read_b128 v[232:235], v2 offset:32
    ds_read_b128 v[236:239], v2 offset:48
    ds_read_b128 v[240:243], v2 offset:4160
    ds_read_b128 v[244:247], v2 offset:4176
    ds_read_b128 v[248:251], v2 offset:4192
    ds_read_b128 v[252:255], v2 offset:4208
    s_waitcnt lgkmcnt(0)
    v_mfma_f32_16x16x32_bf16 a[64:67], v[224:227], a[192:195], 0
    v_mfma_f32_16x16x32_bf16 a[68:71], v[224:227], a[196:199], 0
    v_mfma_f32_16x16x32_bf16 a[72:75], v[240:243], a[192:195], 0
    v_mfma_f32_16x16x32_bf16 a[76:79], v[240:243], a[196:199], 0
    s_add_u32 m0, s98, 0x6180
    s_xor_b32 s97, s99, 0xe000
    buffer_load_dwordx4 v1, s[52:55], s97 offen nt lds
    v_accvgpr_read_b32 v10, a48
    v_accvgpr_read_b32 v11, a49
    v_mfma_f32_16x16x32_bf16 a[64:67], v[228:231], a[200:203], a[64:67]
    v_accvgpr_read_b32 v12, a50
    v_accvgpr_read_b32 v13, a51
    v_mfma_f32_16x16x32_bf16 a[68:71], v[228:231], a[204:207], a[68:71]
    v_accvgpr_read_b32 v14, a56
    v_accvgpr_read_b32 v15, a57
    v_mfma_f32_16x16x32_bf16 a[72:75], v[244:247], a[200:203], a[72:75]
    v_accvgpr_read_b32 v16, a58
    v_accvgpr_read_b32 v17, a59
    v_mfma_f32_16x16x32_bf16 a[76:79], v[244:247], a[204:207], a[76:79]
    v_accvgpr_read_b32 v18, a52
    v_accvgpr_read_b32 v19, a53
    v_mfma_f32_16x16x32_bf16 a[64:67], v[232:235], a[208:211], a[64:67]
    v_accvgpr_read_b32 v20, a54
    v_accvgpr_read_b32 v21, a55
    v_mfma_f32_16x16x32_bf16 a[68:71], v[232:235], a[212:215], a[68:71]
    v_accvgpr_read_b32 v22, a60
    v_accvgpr_read_b32 v23, a61
    v_mfma_f32_16x16x32_bf16 a[72:75], v[248:251], a[208:211], a[72:75]
    v_accvgpr_read_b32 v24, a62
    v_accvgpr_read_b32 v25, a63
    v_mfma_f32_16x16x32_bf16 a[76:79], v[248:251], a[212:215], a[76:79]
    v_max3_f32 v26, v26, v10, v11
    v_max3_f32 v26, v26, v12, v13
    v_mfma_f32_16x16x32_bf16 a[64:67], v[236:239], a[216:219], a[64:67]
    v_max3_f32 v26, v26, v14, v15
    v_max3_f32 v26, v26, v16, v17
    v_mfma_f32_16x16x32_bf16 a[68:71], v[236:239], a[220:223], a[68:71]
    v_max3_f32 v27, v27, v18, v19
    v_max3_f32 v27, v27, v20, v21
    v_mfma_f32_16x16x32_bf16 a[72:75], v[252:255], a[216:219], a[72:75]
    v_max3_f32 v27, v27, v22, v23
    v_max3_f32 v27, v27, v24, v25
    v_mfma_f32_16x16x32_bf16 a[76:79], v[252:255], a[220:223], a[76:79]
    s_add_u32 m0, s98, 0x6490
    s_xor_b32 s97, s99, 0xe000
    buffer_load_dwordx4 v1, s[52:55], s97 offen offset:256 nt lds
    s_add_u32 m0, s98, 0x67a0
    s_xor_b32 s97, s99, 0xe000
    buffer_load_dwordx4 v1, s[52:55], s97 offen offset:512 nt lds
    s_add_u32 m0, s98, 0x6ab0
    s_xor_b32 s97, s99, 0xe000
    buffer_load_dwordx4 v1, s[52:55], s97 offen offset:768 nt lds
    s_add_u32 m0, s98, 0x71c0
    s_xor_b32 s97, s99, 0xf000
    buffer_load_dwordx4 v1, s[52:55], s97 offen nt lds
    s_add_u32 m0, s98, 0x74d0
    s_xor_b32 s97, s99, 0xf000
    buffer_load_dwordx4 v1, s[52:55], s97 offen offset:256 nt lds
    s_add_u32 m0, s98, 0x77e0
    s_xor_b32 s97, s99, 0xf000
    buffer_load_dwordx4 v1, s[52:55], s97 offen offset:512 nt lds
    s_add_u32 m0, s98, 0x7af0
    s_xor_b32 s97, s99, 0xf000
    buffer_load_dwordx4 v1, s[52:55], s97 offen offset:768 nt lds
    s_waitcnt vmcnt(16)
    ds_read_b128 v[32:35], v2 offset:8320
    ds_read_b128 v[36:39], v2 offset:8336
    ds_read_b128 v[40:43], v2 offset:8352
    ds_read_b128 v[44:47], v2 offset:8368
    ds_read_b128 v[48:51], v2 offset:12480
    ds_read_b128 v[52:55], v2 offset:12496
    ds_read_b128 v[56:59], v2 offset:12512
    ds_read_b128 v[60:63], v2 offset:12528
    s_waitcnt lgkmcnt(0)
    v_mfma_f32_16x16x32_bf16 a[80:83], v[32:35], a[192:195], 0
    v_mfma_f32_16x16x32_bf16 a[84:87], v[32:35], a[196:199], 0
    v_mfma_f32_16x16x32_bf16 a[88:91], v[48:51], a[192:195], 0
    v_mfma_f32_16x16x32_bf16 a[92:95], v[48:51], a[196:199], 0
    s_add_u32 m0, s98, 0x0
    s_xor_b32 s97, s99, 0x10000
    buffer_load_dwordx4 v1, s[52:55], s97 offen nt lds
    v_accvgpr_read_b32 v10, a64
    v_accvgpr_read_b32 v11, a65
    v_mfma_f32_16x16x32_bf16 a[80:83], v[36:39], a[200:203], a[80:83]
    v_accvgpr_read_b32 v12, a66
    v_accvgpr_read_b32 v13, a67
    v_mfma_f32_16x16x32_bf16 a[84:87], v[36:39], a[204:207], a[84:87]
    v_accvgpr_read_b32 v14, a72
    v_accvgpr_read_b32 v15, a73
    v_mfma_f32_16x16x32_bf16 a[88:91], v[52:55], a[200:203], a[88:91]
    v_accvgpr_read_b32 v16, a74
    v_accvgpr_read_b32 v17, a75
    v_mfma_f32_16x16x32_bf16 a[92:95], v[52:55], a[204:207], a[92:95]
    v_accvgpr_read_b32 v18, a68
    v_accvgpr_read_b32 v19, a69
    v_mfma_f32_16x16x32_bf16 a[80:83], v[40:43], a[208:211], a[80:83]
    v_accvgpr_read_b32 v20, a70
    v_accvgpr_read_b32 v21, a71
    v_mfma_f32_16x16x32_bf16 a[84:87], v[40:43], a[212:215], a[84:87]
    v_accvgpr_read_b32 v22, a76
    v_accvgpr_read_b32 v23, a77
    v_mfma_f32_16x16x32_bf16 a[88:91], v[56:59], a[208:211], a[88:91]
    v_accvgpr_read_b32 v24, a78
    v_accvgpr_read_b32 v25, a79
    v_mfma_f32_16x16x32_bf16 a[92:95], v[56:59], a[212:215], a[92:95]
    v_max3_f32 v26, v26, v10, v11
    v_max3_f32 v26, v26, v12, v13
    v_mfma_f32_16x16x32_bf16 a[80:83], v[44:47], a[216:219], a[80:83]
    v_max3_f32 v26, v26, v14, v15
    v_max3_f32 v26, v26, v16, v17
    v_mfma_f32_16x16x32_bf16 a[84:87], v[44:47], a[220:223], a[84:87]
    v_max3_f32 v27, v27, v18, v19
    v_max3_f32 v27, v27, v20, v21
    v_mfma_f32_16x16x32_bf16 a[88:91], v[60:63], a[216:219], a[88:91]
    v_max3_f32 v27, v27, v22, v23
    v_max3_f32 v27, v27, v24, v25
    v_mfma_f32_16x16x32_bf16 a[92:95], v[60:63], a[220:223], a[92:95]
    s_add_u32 m0, s98, 0x310
    s_xor_b32 s97, s99, 0x10000
    buffer_load_dwordx4 v1, s[52:55], s97 offen offset:256 nt lds
    s_add_u32 m0, s98, 0x620
    s_xor_b32 s97, s99, 0x10000
    buffer_load_dwordx4 v1, s[52:55], s97 offen offset:512 nt lds
    s_add_u32 m0, s98, 0x930
    s_xor_b32 s97, s99, 0x10000
    buffer_load_dwordx4 v1, s[52:55], s97 offen offset:768 nt lds
    s_add_u32 m0, s98, 0x1040
    s_xor_b32 s97, s99, 0x11000
    buffer_load_dwordx4 v1, s[52:55], s97 offen nt lds
    s_add_u32 m0, s98, 0x1350
    s_xor_b32 s97, s99, 0x11000
    buffer_load_dwordx4 v1, s[52:55], s97 offen offset:256 nt lds
    s_add_u32 m0, s98, 0x1660
    s_xor_b32 s97, s99, 0x11000
    buffer_load_dwordx4 v1, s[52:55], s97 offen offset:512 nt lds
    s_add_u32 m0, s98, 0x1970
    s_xor_b32 s97, s99, 0x11000
    buffer_load_dwordx4 v1, s[52:55], s97 offen offset:768 nt lds
    s_waitcnt vmcnt(16)
    ds_read_b128 v[224:227], v2 offset:16640
    ds_read_b128 v[228:231], v2 offset:16656
    ds_read_b128 v[232:235], v2 offset:16672
    ds_read_b128 v[236:239], v2 offset:16688
    ds_read_b128 v[240:243], v2 offset:20800
    ds_read_b128 v[244:247], v2 offset:20816
    ds_read_b128 v[248:251], v2 offset:20832
    ds_read_b128 v[252:255], v2 offset:20848
    s_waitcnt lgkmcnt(0)
    v_mfma_f32_16x16x32_bf16 a[96:99], v[224:227], a[192:195], 0
    v_mfma_f32_16x16x32_bf16 a[100:103], v[224:227], a[196:199], 0
    v_mfma_f32_16x16x32_bf16 a[104:107], v[240:243], a[192:195], 0
    v_mfma_f32_16x16x32_bf16 a[108:111], v[240:243], a[196:199], 0
    s_add_u32 m0, s98, 0x2080
    s_xor_b32 s97, s99, 0x12000
    buffer_load_dwordx4 v1, s[52:55], s97 offen nt lds
    v_accvgpr_read_b32 v10, a80
    v_accvgpr_read_b32 v11, a81
    v_mfma_f32_16x16x32_bf16 a[96:99], v[228:231], a[200:203], a[96:99]
    v_accvgpr_read_b32 v12, a82
    v_accvgpr_read_b32 v13, a83
    v_mfma_f32_16x16x32_bf16 a[100:103], v[228:231], a[204:207], a[100:103]
    v_accvgpr_read_b32 v14, a88
    v_accvgpr_read_b32 v15, a89
    v_mfma_f32_16x16x32_bf16 a[104:107], v[244:247], a[200:203], a[104:107]
    v_accvgpr_read_b32 v16, a90
    v_accvgpr_read_b32 v17, a91
    v_mfma_f32_16x16x32_bf16 a[108:111], v[244:247], a[204:207], a[108:111]
    v_accvgpr_read_b32 v18, a84
    v_accvgpr_read_b32 v19, a85
    v_mfma_f32_16x16x32_bf16 a[96:99], v[232:235], a[208:211], a[96:99]
    v_accvgpr_read_b32 v20, a86
    v_accvgpr_read_b32 v21, a87
    v_mfma_f32_16x16x32_bf16 a[100:103], v[232:235], a[212:215], a[100:103]
    v_accvgpr_read_b32 v22, a92
    v_accvgpr_read_b32 v23, a93
    v_mfma_f32_16x16x32_bf16 a[104:107], v[248:251], a[208:211], a[104:107]
    v_accvgpr_read_b32 v24, a94
    v_accvgpr_read_b32 v25, a95
    v_mfma_f32_16x16x32_bf16 a[108:111], v[248:251], a[212:215], a[108:111]
    v_max3_f32 v26, v26, v10, v11
    v_max3_f32 v26, v26, v12, v13
    v_mfma_f32_16x16x32_bf16 a[96:99], v[236:239], a[216:219], a[96:99]
    v_max3_f32 v26, v26, v14, v15
    v_max3_f32 v26, v26, v16, v17
    v_mfma_f32_16x16x32_bf16 a[100:103], v[236:239], a[220:223], a[100:103]
    v_max3_f32 v27, v27, v18, v19
    v_max3_f32 v27, v27, v20, v21
    v_mfma_f32_16x16x32_bf16 a[104:107], v[252:255], a[216:219], a[104:107]
    v_max3_f32 v27, v27, v22, v23
    v_max3_f32 v27, v27, v24, v25
    v_mfma_f32_16x16x32_bf16 a[108:111], v[252:255], a[220:223], a[108:111]
    s_add_u32 m0, s98, 0x2390
    s_xor_b32 s97, s99, 0x12000
    buffer_load_dwordx4 v1, s[52:55], s97 offen offset:256 nt lds
    s_add_u32 m0, s98, 0x26a0
    s_xor_b32 s97, s99, 0x12000
    buffer_load_dwordx4 v1, s[52:55], s97 offen offset:512 nt lds
    s_add_u32 m0, s98, 0x29b0
    s_xor_b32 s97, s99, 0x12000
    buffer_load_dwordx4 v1, s[52:55], s97 offen offset:768 nt lds
    s_add_u32 m0, s98, 0x30c0
    s_xor_b32 s97, s99, 0x13000
    buffer_load_dwordx4 v1, s[52:55], s97 offen nt lds
    s_add_u32 m0, s98, 0x33d0
    s_xor_b32 s97, s99, 0x13000
    buffer_load_dwordx4 v1, s[52:55], s97 offen offset:256 nt lds
    s_add_u32 m0, s98, 0x36e0
    s_xor_b32 s97, s99, 0x13000
    buffer_load_dwordx4 v1, s[52:55], s97 offen offset:512 nt lds
    s_add_u32 m0, s98, 0x39f0
    s_xor_b32 s97, s99, 0x13000
    buffer_load_dwordx4 v1, s[52:55], s97 offen offset:768 nt lds
    s_waitcnt vmcnt(16)
    ds_read_b128 v[32:35], v2 offset:24960
    ds_read_b128 v[36:39], v2 offset:24976
    ds_read_b128 v[40:43], v2 offset:24992
    ds_read_b128 v[44:47], v2 offset:25008
    ds_read_b128 v[48:51], v2 offset:29120
    ds_read_b128 v[52:55], v2 offset:29136
    ds_read_b128 v[56:59], v2 offset:29152
    ds_read_b128 v[60:63], v2 offset:29168
    s_waitcnt lgkmcnt(0)
    v_mfma_f32_16x16x32_bf16 a[112:115], v[32:35], a[192:195], 0
    v_mfma_f32_16x16x32_bf16 a[116:119], v[32:35], a[196:199], 0
    v_mfma_f32_16x16x32_bf16 a[120:123], v[48:51], a[192:195], 0
    v_mfma_f32_16x16x32_bf16 a[124:127], v[48:51], a[196:199], 0
    s_add_u32 m0, s98, 0x4100
    s_xor_b32 s97, s99, 0x14000
    buffer_load_dwordx4 v1, s[52:55], s97 offen nt lds
    v_accvgpr_read_b32 v10, a96
    v_accvgpr_read_b32 v11, a97
    v_mfma_f32_16x16x32_bf16 a[112:115], v[36:39], a[200:203], a[112:115]
    v_accvgpr_read_b32 v12, a98
    v_accvgpr_read_b32 v13, a99
    v_mfma_f32_16x16x32_bf16 a[116:119], v[36:39], a[204:207], a[116:119]
    v_accvgpr_read_b32 v14, a104
    v_accvgpr_read_b32 v15, a105
    v_mfma_f32_16x16x32_bf16 a[120:123], v[52:55], a[200:203], a[120:123]
    v_accvgpr_read_b32 v16, a106
    v_accvgpr_read_b32 v17, a107
    v_mfma_f32_16x16x32_bf16 a[124:127], v[52:55], a[204:207], a[124:127]
    v_accvgpr_read_b32 v18, a100
    v_accvgpr_read_b32 v19, a101
    v_mfma_f32_16x16x32_bf16 a[112:115], v[40:43], a[208:211], a[112:115]
    v_accvgpr_read_b32 v20, a102
    v_accvgpr_read_b32 v21, a103
    v_mfma_f32_16x16x32_bf16 a[116:119], v[40:43], a[212:215], a[116:119]
    v_accvgpr_read_b32 v22, a108
    v_accvgpr_read_b32 v23, a109
    v_mfma_f32_16x16x32_bf16 a[120:123], v[56:59], a[208:211], a[120:123]
    v_accvgpr_read_b32 v24, a110
    v_accvgpr_read_b32 v25, a111
    v_mfma_f32_16x16x32_bf16 a[124:127], v[56:59], a[212:215], a[124:127]
    v_max3_f32 v26, v26, v10, v11
    v_max3_f32 v26, v26, v12, v13
    v_mfma_f32_16x16x32_bf16 a[112:115], v[44:47], a[216:219], a[112:115]
    v_max3_f32 v26, v26, v14, v15
    v_max3_f32 v26, v26, v16, v17
    v_mfma_f32_16x16x32_bf16 a[116:119], v[44:47], a[220:223], a[116:119]
    v_max3_f32 v27, v27, v18, v19
    v_max3_f32 v27, v27, v20, v21
    v_mfma_f32_16x16x32_bf16 a[120:123], v[60:63], a[216:219], a[120:123]
    v_max3_f32 v27, v27, v22, v23
    v_max3_f32 v27, v27, v24, v25
    v_mfma_f32_16x16x32_bf16 a[124:127], v[60:63], a[220:223], a[124:127]
    v_accvgpr_read_b32 v10, a112
    s_add_u32 m0, s98, 0x4410
    s_xor_b32 s97, s99, 0x14000
    buffer_load_dwordx4 v1, s[52:55], s97 offen offset:256 nt lds
    v_accvgpr_read_b32 v11, a113
    v_accvgpr_read_b32 v12, a114
    v_accvgpr_read_b32 v13, a115
    v_accvgpr_read_b32 v14, a120
    v_accvgpr_read_b32 v15, a121
    v_accvgpr_read_b32 v16, a122
    v_accvgpr_read_b32 v17, a123
    v_accvgpr_read_b32 v18, a116
    v_accvgpr_read_b32 v19, a117
    v_accvgpr_read_b32 v20, a118
    v_accvgpr_read_b32 v21, a119
    v_accvgpr_read_b32 v22, a124
    v_accvgpr_read_b32 v23, a125
    v_accvgpr_read_b32 v24, a126
    v_accvgpr_read_b32 v25, a127
    v_max3_f32 v26, v26, v10, v11
    v_max3_f32 v26, v26, v12, v13
    v_max3_f32 v26, v26, v14, v15
    v_max3_f32 v26, v26, v16, v17
    v_max3_f32 v27, v27, v18, v19
    v_max3_f32 v27, v27, v20, v21
    v_max3_f32 v27, v27, v22, v23
    v_max3_f32 v27, v27, v24, v25
    v_mov_b32 v10, v26
    s_nop 1
    v_permlane32_swap_b32 v26, v10
    v_max_f32 v26, v26, v10
    v_mov_b32 v10, v26
    s_nop 1
    v_permlane16_swap_b32 v26, v10
    v_max_f32 v26, v26, v10
    v_mul_f32 v26, s96, v26
    v_mov_b32 v28, 0
    v_mov_b32 v10, v27
    s_nop 1
    v_permlane32_swap_b32 v27, v10
    v_max_f32 v27, v27, v10
    v_mov_b32 v10, v27
    s_nop 1
    v_permlane16_swap_b32 v27, v10
    v_max_f32 v27, v27, v10
    v_mul_f32 v27, s96, v27
    v_mov_b32 v29, 0
    v_accvgpr_read_b32 v10, a0
    s_add_u32 m0, s98, 0x4720
    s_xor_b32 s97, s99, 0x14000
    buffer_load_dwordx4 v1, s[52:55], s97 offen offset:512 nt lds
    v_accvgpr_read_b32 v11, a1
    v_accvgpr_read_b32 v12, a2
    v_accvgpr_read_b32 v13, a3
    v_accvgpr_read_b32 v14, a8
    v_accvgpr_read_b32 v15, a9
    v_accvgpr_read_b32 v16, a10
    v_accvgpr_read_b32 v17, a11
    v_accvgpr_read_b32 v18, a4
    v_accvgpr_read_b32 v19, a5
    v_accvgpr_read_b32 v20, a6
    v_accvgpr_read_b32 v21, a7
    v_accvgpr_read_b32 v22, a12
    v_accvgpr_read_b32 v23, a13
    v_accvgpr_read_b32 v24, a14
    v_accvgpr_read_b32 v25, a15
    v_fma_f32 v10, v10, s96, -v26
    v_fma_f32 v11, v11, s96, -v26
    v_fma_f32 v12, v12, s96, -v26
    v_fma_f32 v13, v13, s96, -v26
    v_fma_f32 v14, v14, s96, -v26
    v_fma_f32 v15, v15, s96, -v26
    v_fma_f32 v16, v16, s96, -v26
    v_fma_f32 v17, v17, s96, -v26
    v_fma_f32 v18, v18, s96, -v27
    v_fma_f32 v19, v19, s96, -v27
    v_fma_f32 v20, v20, s96, -v27
    v_fma_f32 v21, v21, s96, -v27
    v_fma_f32 v22, v22, s96, -v27
    v_fma_f32 v23, v23, s96, -v27
    v_fma_f32 v24, v24, s96, -v27
    v_fma_f32 v25, v25, s96, -v27
    v_exp_f32 v10, v10
    v_exp_f32 v11, v11
    v_exp_f32 v12, v12
    v_exp_f32 v13, v13
    v_exp_f32 v14, v14
    v_exp_f32 v15, v15
    v_exp_f32 v16, v16
    v_exp_f32 v17, v17
    v_exp_f32 v18, v18
    s_add_u32 m0, s98, 0x4a30
    s_xor_b32 s97, s99, 0x14000
    buffer_load_dwordx4 v1, s[52:55], s97 offen offset:768 nt lds
    v_exp_f32 v19, v19
    v_exp_f32 v20, v20
    v_exp_f32 v21, v21
    v_exp_f32 v22, v22
    v_exp_f32 v23, v23
    v_exp_f32 v24, v24
    v_exp_f32 v25, v25
    v_add_f32 v28, v28, v10
    v_add_f32 v28, v28, v11
    v_add_f32 v28, v28, v12
    v_add_f32 v28, v28, v13
    v_add_f32 v28, v28, v14
    v_add_f32 v28, v28, v15
    v_add_f32 v28, v28, v16
    v_add_f32 v28, v28, v17
    v_add_f32 v29, v29, v18
    v_add_f32 v29, v29, v19
    v_add_f32 v29, v29, v20
    v_add_f32 v29, v29, v21
    v_add_f32 v29, v29, v22
    v_add_f32 v29, v29, v23
    v_add_f32 v29, v29, v24
    v_add_f32 v29, v29, v25
    v_cvt_pk_bf16_f32 v10, v10, v11
    v_cvt_pk_bf16_f32 v12, v12, v13
    v_cvt_pk_bf16_f32 v14, v14, v15
    v_cvt_pk_bf16_f32 v16, v16, v17
    v_cvt_pk_bf16_f32 v18, v18, v19
    v_cvt_pk_bf16_f32 v20, v20, v21
    v_cvt_pk_bf16_f32 v22, v22, v23
    v_cvt_pk_bf16_f32 v24, v24, v25
    v_accvgpr_write_b32 a0, v10
    v_accvgpr_write_b32 a1, v12
    v_accvgpr_write_b32 a2, v14
    v_accvgpr_write_b32 a3, v16
    v_accvgpr_write_b32 a4, v18
    v_accvgpr_write_b32 a5, v20
    v_accvgpr_write_b32 a6, v22
    v_accvgpr_write_b32 a7, v24
    v_perm_b32 v32, v68, v64, s38
    v_perm_b32 v33, v76, v72, s38
    s_add_u32 m0, s98, 0x5140
    s_xor_b32 s97, s99, 0x15000
    buffer_load_dwordx4 v1, s[52:55], s97 offen nt lds
    v_perm_b32 v34, v84, v80, s38
    v_perm_b32 v35, v92, v88, s38
    v_perm_b32 v36, v68, v64, s39
    v_perm_b32 v37, v76, v72, s39
    v_mfma_f32_16x16x32_bf16 a[128:131], v[32:35], a[0:3], 0
    v_perm_b32 v38, v84, v80, s39
    v_perm_b32 v39, v92, v88, s39
    v_accvgpr_read_b32 v10, a16
    v_accvgpr_read_b32 v11, a17
    v_accvgpr_read_b32 v12, a18
    v_accvgpr_read_b32 v13, a19
    v_accvgpr_read_b32 v14, a24
    v_mfma_f32_16x16x32_bf16 a[132:135], v[32:35], a[4:7], 0
    v_perm_b32 v40, v69, v65, s38
    v_perm_b32 v41, v77, v73, s38
    v_accvgpr_read_b32 v15, a25
    v_accvgpr_read_b32 v16, a26
    v_accvgpr_read_b32 v17, a27
    v_accvgpr_read_b32 v18, a20
    v_accvgpr_read_b32 v19, a21
    v_mfma_f32_16x16x32_bf16 a[136:139], v[36:39], a[0:3], 0
    v_perm_b32 v42, v85, v81, s38
    v_perm_b32 v43, v93, v89, s38
    v_accvgpr_read_b32 v20, a22
    v_accvgpr_read_b32 v21, a23
    v_accvgpr_read_b32 v22, a28
    v_accvgpr_read_b32 v23, a29
    v_accvgpr_read_b32 v24, a30
    v_mfma_f32_16x16x32_bf16 a[140:143], v[36:39], a[4:7], 0
    v_perm_b32 v44, v69, v65, s39
    v_perm_b32 v45, v77, v73, s39
    v_accvgpr_read_b32 v25, a31
    v_fma_f32 v10, v10, s96, -v26
    v_fma_f32 v11, v11, s96, -v26
    v_fma_f32 v12, v12, s96, -v26
    v_fma_f32 v13, v13, s96, -v26
    v_mfma_f32_16x16x32_bf16 a[144:147], v[40:43], a[0:3], 0
    v_perm_b32 v46, v85, v81, s39
    v_perm_b32 v47, v93, v89, s39
    v_fma_f32 v14, v14, s96, -v26
    v_fma_f32 v15, v15, s96, -v26
    v_fma_f32 v16, v16, s96, -v26
    v_fma_f32 v17, v17, s96, -v26
    v_fma_f32 v18, v18, s96, -v27
    v_mfma_f32_16x16x32_bf16 a[148:151], v[40:43], a[4:7], 0
    v_perm_b32 v48, v70, v66, s38
    v_perm_b32 v49, v78, v74, s38
    v_fma_f32 v19, v19, s96, -v27
    s_add_u32 m0, s98, 0x5450
    s_xor_b32 s97, s99, 0x15000
    buffer_load_dwordx4 v1, s[52:55], s97 offen offset:256 nt lds
    v_fma_f32 v20, v20, s96, -v27
    v_fma_f32 v21, v21, s96, -v27
    v_fma_f32 v22, v22, s96, -v27
    v_fma_f32 v23, v23, s96, -v27
    v_mfma_f32_16x16x32_bf16 a[152:155], v[44:47], a[0:3], 0
    v_perm_b32 v50, v86, v82, s38
    v_perm_b32 v51, v94, v90, s38
    v_fma_f32 v24, v24, s96, -v27
    v_fma_f32 v25, v25, s96, -v27
    v_exp_f32 v10, v10
    v_exp_f32 v11, v11
    v_exp_f32 v12, v12
    v_mfma_f32_16x16x32_bf16 a[156:159], v[44:47], a[4:7], 0
    v_perm_b32 v52, v70, v66, s39
    v_perm_b32 v53, v78, v74, s39
    v_exp_f32 v13, v13
    v_exp_f32 v14, v14
    v_exp_f32 v15, v15
    v_exp_f32 v16, v16
    v_exp_f32 v17, v17
    v_mfma_f32_16x16x32_bf16 a[160:163], v[48:51], a[0:3], 0
    v_perm_b32 v54, v86, v82, s39
    v_perm_b32 v55, v94, v90, s39
    v_exp_f32 v18, v18
    v_exp_f32 v19, v19
    v_exp_f32 v20, v20
    v_exp_f32 v21, v21
    v_exp_f32 v22, v22
    v_mfma_f32_16x16x32_bf16 a[164:167], v[48:51], a[4:7], 0
    v_perm_b32 v56, v71, v67, s38
    v_perm_b32 v57, v79, v75, s38
    v_exp_f32 v23, v23
    v_exp_f32 v24, v24
    s_add_u32 m0, s98, 0x5760
    s_xor_b32 s97, s99, 0x15000
    buffer_load_dwordx4 v1, s[52:55], s97 offen offset:512 nt lds
    v_exp_f32 v25, v25
    v_add_f32 v28, v28, v10
    v_add_f32 v28, v28, v11
    v_mfma_f32_16x16x32_bf16 a[168:171], v[52:55], a[0:3], 0
    v_perm_b32 v58, v87, v83, s38
    v_perm_b32 v59, v95, v91, s38
    v_add_f32 v28, v28, v12
    v_add_f32 v28, v28, v13
    v_add_f32 v28, v28, v14
    v_add_f32 v28, v28, v15
    v_add_f32 v28, v28, v16
    v_mfma_f32_16x16x32_bf16 a[172:175], v[52:55], a[4:7], 0
    v_perm_b32 v60, v71, v67, s39
    v_perm_b32 v61, v79, v75, s39
    v_add_f32 v28, v28, v17
    v_add_f32 v29, v29, v18
    v_add_f32 v29, v29, v19
    v_add_f32 v29, v29, v20
    v_add_f32 v29, v29, v21
    v_mfma_f32_16x16x32_bf16 a[176:179], v[56:59], a[0:3], 0
    v_perm_b32 v62, v87, v83, s39
    v_perm_b32 v63, v95, v91, s39
    v_add_f32 v29, v29, v22
    v_add_f32 v29, v29, v23
    v_add_f32 v29, v29, v24
    v_add_f32 v29, v29, v25
    v_cvt_pk_bf16_f32 v10, v10, v11
    v_mfma_f32_16x16x32_bf16 a[180:183], v[56:59], a[4:7], 0
    v_cvt_pk_bf16_f32 v12, v12, v13
    v_cvt_pk_bf16_f32 v14, v14, v15
    v_cvt_pk_bf16_f32 v16, v16, v17
    v_cvt_pk_bf16_f32 v18, v18, v19
    v_cvt_pk_bf16_f32 v20, v20, v21
    v_mfma_f32_16x16x32_bf16 a[184:187], v[60:63], a[0:3], 0
    v_cvt_pk_bf16_f32 v22, v22, v23
    v_cvt_pk_bf16_f32 v24, v24, v25
    v_accvgpr_write_b32 a16, v10
    v_accvgpr_write_b32 a17, v12
    v_accvgpr_write_b32 a18, v14
    v_mfma_f32_16x16x32_bf16 a[188:191], v[60:63], a[4:7], 0
    v_accvgpr_write_b32 a19, v16
    v_accvgpr_write_b32 a20, v18
    v_accvgpr_write_b32 a21, v20
    v_accvgpr_write_b32 a22, v22
    v_accvgpr_write_b32 a23, v24
    v_perm_b32 v32, v100, v96, s38
    v_perm_b32 v33, v108, v104, s38
    s_add_u32 m0, s98, 0x5a70
    s_xor_b32 s97, s99, 0x15000
    buffer_load_dwordx4 v1, s[52:55], s97 offen offset:768 nt lds
    v_perm_b32 v34, v116, v112, s38
    v_perm_b32 v35, v124, v120, s38
    v_perm_b32 v36, v100, v96, s39
    v_perm_b32 v37, v108, v104, s39
    v_mfma_f32_16x16x32_bf16 a[128:131], v[32:35], a[16:19], a[128:131]
    v_perm_b32 v38, v116, v112, s39
    v_perm_b32 v39, v124, v120, s39
    v_accvgpr_read_b32 v10, a32
    v_accvgpr_read_b32 v11, a33
    v_accvgpr_read_b32 v12, a34
    v_accvgpr_read_b32 v13, a35
    v_accvgpr_read_b32 v14, a40
    v_mfma_f32_16x16x32_bf16 a[132:135], v[32:35], a[20:23], a[132:135]
    v_perm_b32 v40, v101, v97, s38
    v_perm_b32 v41, v109, v105, s38
    v_accvgpr_read_b32 v15, a41
    v_accvgpr_read_b32 v16, a42
    v_accvgpr_read_b32 v17, a43
    v_accvgpr_read_b32 v18, a36
    v_accvgpr_read_b32 v19, a37
    v_mfma_f32_16x16x32_bf16 a[136:139], v[36:39], a[16:19], a[136:139]
    v_perm_b32 v42, v117, v113, s38
    v_perm_b32 v43, v125, v121, s38
    v_accvgpr_read_b32 v20, a38
    v_accvgpr_read_b32 v21, a39
    v_accvgpr_read_b32 v22, a44
    v_accvgpr_read_b32 v23, a45
    v_accvgpr_read_b32 v24, a46
    v_mfma_f32_16x16x32_bf16 a[140:143], v[36:39], a[20:23], a[140:143]
    v_perm_b32 v44, v101, v97, s39
    v_perm_b32 v45, v109, v105, s39
    v_accvgpr_read_b32 v25, a47
    v_fma_f32 v10, v10, s96, -v26
    v_fma_f32 v11, v11, s96, -v26
    v_fma_f32 v12, v12, s96, -v26
    v_fma_f32 v13, v13, s96, -v26
    v_mfma_f32_16x16x32_bf16 a[144:147], v[40:43], a[16:19], a[144:147]
    v_perm_b32 v46, v117, v113, s39
    v_perm_b32 v47, v125, v121, s39
    v_fma_f32 v14, v14, s96, -v26
    v_fma_f32 v15, v15, s96, -v26
    v_fma_f32 v16, v16, s96, -v26
    v_fma_f32 v17, v17, s96, -v26
    v_fma_f32 v18, v18, s96, -v27
    v_mfma_f32_16x16x32_bf16 a[148:151], v[40:43], a[20:23], a[148:151]
    v_perm_b32 v48, v102, v98, s38
    v_perm_b32 v49, v110, v106, s38
    v_fma_f32 v19, v19, s96, -v27
    s_xor_b32 s97, s99, 0xa000
    buffer_load_dwordx4 v[64:67], v0, s[56:59], s97 offen nt
    v_fma_f32 v20, v20, s96, -v27
    v_fma_f32 v21, v21, s96, -v27
    v_fma_f32 v22, v22, s96, -v27
    v_fma_f32 v23, v23, s96, -v27
    v_mfma_f32_16x16x32_bf16 a[152:155], v[44:47], a[16:19], a[152:155]
    v_perm_b32 v50, v118, v114, s38
    v_perm_b32 v51, v126, v122, s38
    v_fma_f32 v24, v24, s96, -v27
    v_fma_f32 v25, v25, s96, -v27
    v_exp_f32 v10, v10
    v_exp_f32 v11, v11
    v_exp_f32 v12, v12
    v_mfma_f32_16x16x32_bf16 a[156:159], v[44:47], a[20:23], a[156:159]
    v_perm_b32 v52, v102, v98, s39
    v_perm_b32 v53, v110, v106, s39
    v_exp_f32 v13, v13
    v_exp_f32 v14, v14
    v_exp_f32 v15, v15
    v_exp_f32 v16, v16
    v_exp_f32 v17, v17
    v_mfma_f32_16x16x32_bf16 a[160:163], v[48:51], a[16:19], a[160:163]
    v_perm_b32 v54, v118, v114, s39
    v_perm_b32 v55, v126, v122, s39
    v_exp_f32 v18, v18
    v_exp_f32 v19, v19
    v_exp_f32 v20, v20
    v_exp_f32 v21, v21
    v_exp_f32 v22, v22
    v_mfma_f32_16x16x32_bf16 a[164:167], v[48:51], a[20:23], a[164:167]
    v_perm_b32 v56, v103, v99, s38
    v_perm_b32 v57, v111, v107, s38
    v_exp_f32 v23, v23
    v_exp_f32 v24, v24
    s_xor_b32 s97, s99, 0xa400
    buffer_load_dwordx4 v[68:71], v0, s[56:59], s97 offen nt
    v_exp_f32 v25, v25
    v_add_f32 v28, v28, v10
    v_add_f32 v28, v28, v11
    v_mfma_f32_16x16x32_bf16 a[168:171], v[52:55], a[16:19], a[168:171]
    v_perm_b32 v58, v119, v115, s38
    v_perm_b32 v59, v127, v123, s38
    v_add_f32 v28, v28, v12
    v_add_f32 v28, v28, v13
    v_add_f32 v28, v28, v14
    v_add_f32 v28, v28, v15
    v_add_f32 v28, v28, v16
    v_mfma_f32_16x16x32_bf16 a[172:175], v[52:55], a[20:23], a[172:175]
    v_perm_b32 v60, v103, v99, s39
    v_perm_b32 v61, v111, v107, s39
    v_add_f32 v28, v28, v17
    v_add_f32 v29, v29, v18
    v_add_f32 v29, v29, v19
    v_add_f32 v29, v29, v20
    v_add_f32 v29, v29, v21
    v_mfma_f32_16x16x32_bf16 a[176:179], v[56:59], a[16:19], a[176:179]
    v_perm_b32 v62, v119, v115, s39
    v_perm_b32 v63, v127, v123, s39
    v_add_f32 v29, v29, v22
    v_add_f32 v29, v29, v23
    v_add_f32 v29, v29, v24
    v_add_f32 v29, v29, v25
    v_cvt_pk_bf16_f32 v10, v10, v11
    v_mfma_f32_16x16x32_bf16 a[180:183], v[56:59], a[20:23], a[180:183]
    v_cvt_pk_bf16_f32 v12, v12, v13
    v_cvt_pk_bf16_f32 v14, v14, v15
    v_cvt_pk_bf16_f32 v16, v16, v17
    v_cvt_pk_bf16_f32 v18, v18, v19
    v_cvt_pk_bf16_f32 v20, v20, v21
    v_mfma_f32_16x16x32_bf16 a[184:187], v[60:63], a[16:19], a[184:187]
    v_cvt_pk_bf16_f32 v22, v22, v23
    v_cvt_pk_bf16_f32 v24, v24, v25
    v_accvgpr_write_b32 a32, v10
    v_accvgpr_write_b32 a33, v12
    v_accvgpr_write_b32 a34, v14
    v_mfma_f32_16x16x32_bf16 a[188:191], v[60:63], a[20:23], a[188:191]
    v_accvgpr_write_b32 a35, v16
    v_accvgpr_write_b32 a36, v18
    v_accvgpr_write_b32 a37, v20
    v_accvgpr_write_b32 a38, v22
    v_accvgpr_write_b32 a39, v24
    v_perm_b32 v32, v132, v128, s38
    v_perm_b32 v33, v140, v136, s38
    s_xor_b32 s97, s99, 0xa800
    buffer_load_dwordx4 v[72:75], v0, s[56:59], s97 offen nt
    v_perm_b32 v34, v148, v144, s38
    v_perm_b32 v35, v156, v152, s38
    v_perm_b32 v36, v132, v128, s39
    v_perm_b32 v37, v140, v136, s39
    v_mfma_f32_16x16x32_bf16 a[128:131], v[32:35], a[32:35], a[128:131]
    v_perm_b32 v38, v148, v144, s39
    v_perm_b32 v39, v156, v152, s39
    v_accvgpr_read_b32 v10, a48
    v_accvgpr_read_b32 v11, a49
    v_accvgpr_read_b32 v12, a50
    v_accvgpr_read_b32 v13, a51
    v_accvgpr_read_b32 v14, a56
    v_mfma_f32_16x16x32_bf16 a[132:135], v[32:35], a[36:39], a[132:135]
    v_perm_b32 v40, v133, v129, s38
    v_perm_b32 v41, v141, v137, s38
    v_accvgpr_read_b32 v15, a57
    v_accvgpr_read_b32 v16, a58
    v_accvgpr_read_b32 v17, a59
    v_accvgpr_read_b32 v18, a52
    v_accvgpr_read_b32 v19, a53
    v_mfma_f32_16x16x32_bf16 a[136:139], v[36:39], a[32:35], a[136:139]
    v_perm_b32 v42, v149, v145, s38
    v_perm_b32 v43, v157, v153, s38
    v_accvgpr_read_b32 v20, a54
    v_accvgpr_read_b32 v21, a55
    v_accvgpr_read_b32 v22, a60
    v_accvgpr_read_b32 v23, a61
    v_accvgpr_read_b32 v24, a62
    v_mfma_f32_16x16x32_bf16 a[140:143], v[36:39], a[36:39], a[140:143]
    v_perm_b32 v44, v133, v129, s39
    v_perm_b32 v45, v141, v137, s39
    v_accvgpr_read_b32 v25, a63
    v_fma_f32 v10, v10, s96, -v26
    v_fma_f32 v11, v11, s96, -v26
    v_fma_f32 v12, v12, s96, -v26
    v_fma_f32 v13, v13, s96, -v26
    v_mfma_f32_16x16x32_bf16 a[144:147], v[40:43], a[32:35], a[144:147]
    v_perm_b32 v46, v149, v145, s39
    v_perm_b32 v47, v157, v153, s39
    v_fma_f32 v14, v14, s96, -v26
    v_fma_f32 v15, v15, s96, -v26
    v_fma_f32 v16, v16, s96, -v26
    v_fma_f32 v17, v17, s96, -v26
    v_fma_f32 v18, v18, s96, -v27
    v_mfma_f32_16x16x32_bf16 a[148:151], v[40:43], a[36:39], a[148:151]
    v_perm_b32 v48, v134, v130, s38
    v_perm_b32 v49, v142, v138, s38
    v_fma_f32 v19, v19, s96, -v27
    s_xor_b32 s97, s99, 0xac00
    buffer_load_dwordx4 v[76:79], v0, s[56:59], s97 offen nt
    v_fma_f32 v20, v20, s96, -v27
    v_fma_f32 v21, v21, s96, -v27
    v_fma_f32 v22, v22, s96, -v27
    v_fma_f32 v23, v23, s96, -v27
    v_mfma_f32_16x16x32_bf16 a[152:155], v[44:47], a[32:35], a[152:155]
    v_perm_b32 v50, v150, v146, s38
    v_perm_b32 v51, v158, v154, s38
    v_fma_f32 v24, v24, s96, -v27
    v_fma_f32 v25, v25, s96, -v27
    v_exp_f32 v10, v10
    v_exp_f32 v11, v11
    v_exp_f32 v12, v12
    v_mfma_f32_16x16x32_bf16 a[156:159], v[44:47], a[36:39], a[156:159]
    v_perm_b32 v52, v134, v130, s39
    v_perm_b32 v53, v142, v138, s39
    v_exp_f32 v13, v13
    v_exp_f32 v14, v14
    v_exp_f32 v15, v15
    v_exp_f32 v16, v16
    v_exp_f32 v17, v17
    v_mfma_f32_16x16x32_bf16 a[160:163], v[48:51], a[32:35], a[160:163]
    v_perm_b32 v54, v150, v146, s39
    v_perm_b32 v55, v158, v154, s39
    v_exp_f32 v18, v18
    v_exp_f32 v19, v19
    v_exp_f32 v20, v20
    v_exp_f32 v21, v21
    v_exp_f32 v22, v22
    v_mfma_f32_16x16x32_bf16 a[164:167], v[48:51], a[36:39], a[164:167]
    v_perm_b32 v56, v135, v131, s38
    v_perm_b32 v57, v143, v139, s38
    v_exp_f32 v23, v23
    v_exp_f32 v24, v24
    s_xor_b32 s97, s99, 0xb000
    buffer_load_dwordx4 v[80:83], v0, s[56:59], s97 offen nt
    v_exp_f32 v25, v25
    v_add_f32 v28, v28, v10
    v_add_f32 v28, v28, v11
    v_mfma_f32_16x16x32_bf16 a[168:171], v[52:55], a[32:35], a[168:171]
    v_perm_b32 v58, v151, v147, s38
    v_perm_b32 v59, v159, v155, s38
    v_add_f32 v28, v28, v12
    v_add_f32 v28, v28, v13
    v_add_f32 v28, v28, v14
    v_add_f32 v28, v28, v15
    v_add_f32 v28, v28, v16
    v_mfma_f32_16x16x32_bf16 a[172:175], v[52:55], a[36:39], a[172:175]
    v_perm_b32 v60, v135, v131, s39
    v_perm_b32 v61, v143, v139, s39
    v_add_f32 v28, v28, v17
    v_add_f32 v29, v29, v18
    v_add_f32 v29, v29, v19
    v_add_f32 v29, v29, v20
    v_add_f32 v29, v29, v21
    v_mfma_f32_16x16x32_bf16 a[176:179], v[56:59], a[32:35], a[176:179]
    v_perm_b32 v62, v151, v147, s39
    v_perm_b32 v63, v159, v155, s39
    v_add_f32 v29, v29, v22
    v_add_f32 v29, v29, v23
    v_add_f32 v29, v29, v24
    v_add_f32 v29, v29, v25
    v_cvt_pk_bf16_f32 v10, v10, v11
    v_mfma_f32_16x16x32_bf16 a[180:183], v[56:59], a[36:39], a[180:183]
    v_cvt_pk_bf16_f32 v12, v12, v13
    v_cvt_pk_bf16_f32 v14, v14, v15
    v_cvt_pk_bf16_f32 v16, v16, v17
    v_cvt_pk_bf16_f32 v18, v18, v19
    v_cvt_pk_bf16_f32 v20, v20, v21
    v_mfma_f32_16x16x32_bf16 a[184:187], v[60:63], a[32:35], a[184:187]
    v_cvt_pk_bf16_f32 v22, v22, v23
    v_cvt_pk_bf16_f32 v24, v24, v25
    v_accvgpr_write_b32 a48, v10
    v_accvgpr_write_b32 a49, v12
    v_accvgpr_write_b32 a50, v14
    v_mfma_f32_16x16x32_bf16 a[188:191], v[60:63], a[36:39], a[188:191]
    v_accvgpr_write_b32 a51, v16
    v_accvgpr_write_b32 a52, v18
    v_accvgpr_write_b32 a53, v20
    v_accvgpr_write_b32 a54, v22
    v_accvgpr_write_b32 a55, v24
    v_perm_b32 v32, v164, v160, s38
    v_perm_b32 v33, v172, v168, s38
    s_xor_b32 s97, s99, 0xb400
    buffer_load_dwordx4 v[84:87], v0, s[56:59], s97 offen nt
    v_perm_b32 v34, v180, v176, s38
    v_perm_b32 v35, v188, v184, s38
    v_perm_b32 v36, v164, v160, s39
    v_perm_b32 v37, v172, v168, s39
    v_mfma_f32_16x16x32_bf16 a[128:131], v[32:35], a[48:51], a[128:131]
    v_perm_b32 v38, v180, v176, s39
    v_perm_b32 v39, v188, v184, s39
    v_accvgpr_read_b32 v10, a64
    v_accvgpr_read_b32 v11, a65
    v_accvgpr_read_b32 v12, a66
    v_accvgpr_read_b32 v13, a67
    v_accvgpr_read_b32 v14, a72
    v_mfma_f32_16x16x32_bf16 a[132:135], v[32:35], a[52:55], a[132:135]
    v_perm_b32 v40, v165, v161, s38
    v_perm_b32 v41, v173, v169, s38
    v_accvgpr_read_b32 v15, a73
    v_accvgpr_read_b32 v16, a74
    v_accvgpr_read_b32 v17, a75
    v_accvgpr_read_b32 v18, a68
    v_accvgpr_read_b32 v19, a69
    v_mfma_f32_16x16x32_bf16 a[136:139], v[36:39], a[48:51], a[136:139]
    v_perm_b32 v42, v181, v177, s38
    v_perm_b32 v43, v189, v185, s38
    v_accvgpr_read_b32 v20, a70
    v_accvgpr_read_b32 v21, a71
    v_accvgpr_read_b32 v22, a76
    v_accvgpr_read_b32 v23, a77
    v_accvgpr_read_b32 v24, a78
    v_mfma_f32_16x16x32_bf16 a[140:143], v[36:39], a[52:55], a[140:143]
    v_perm_b32 v44, v165, v161, s39
    v_perm_b32 v45, v173, v169, s39
    v_accvgpr_read_b32 v25, a79
    v_fma_f32 v10, v10, s96, -v26
    v_fma_f32 v11, v11, s96, -v26
    v_fma_f32 v12, v12, s96, -v26
    v_fma_f32 v13, v13, s96, -v26
    v_mfma_f32_16x16x32_bf16 a[144:147], v[40:43], a[48:51], a[144:147]
    v_perm_b32 v46, v181, v177, s39
    v_perm_b32 v47, v189, v185, s39
    v_fma_f32 v14, v14, s96, -v26
    v_fma_f32 v15, v15, s96, -v26
    v_fma_f32 v16, v16, s96, -v26
    v_fma_f32 v17, v17, s96, -v26
    v_fma_f32 v18, v18, s96, -v27
    v_mfma_f32_16x16x32_bf16 a[148:151], v[40:43], a[52:55], a[148:151]
    v_perm_b32 v48, v166, v162, s38
    v_perm_b32 v49, v174, v170, s38
    v_fma_f32 v19, v19, s96, -v27
    s_xor_b32 s97, s99, 0xb800
    buffer_load_dwordx4 v[88:91], v0, s[56:59], s97 offen nt
    v_fma_f32 v20, v20, s96, -v27
    v_fma_f32 v21, v21, s96, -v27
    v_fma_f32 v22, v22, s96, -v27
    v_fma_f32 v23, v23, s96, -v27
    v_mfma_f32_16x16x32_bf16 a[152:155], v[44:47], a[48:51], a[152:155]
    v_perm_b32 v50, v182, v178, s38
    v_perm_b32 v51, v190, v186, s38
    v_fma_f32 v24, v24, s96, -v27
    v_fma_f32 v25, v25, s96, -v27
    v_exp_f32 v10, v10
    v_exp_f32 v11, v11
    v_exp_f32 v12, v12
    v_mfma_f32_16x16x32_bf16 a[156:159], v[44:47], a[52:55], a[156:159]
    v_perm_b32 v52, v166, v162, s39
    v_perm_b32 v53, v174, v170, s39
    v_exp_f32 v13, v13
    v_exp_f32 v14, v14
    v_exp_f32 v15, v15
    v_exp_f32 v16, v16
    v_exp_f32 v17, v17
    v_mfma_f32_16x16x32_bf16 a[160:163], v[48:51], a[48:51], a[160:163]
    v_perm_b32 v54, v182, v178, s39
    v_perm_b32 v55, v190, v186, s39
    v_exp_f32 v18, v18
    v_exp_f32 v19, v19
    v_exp_f32 v20, v20
    v_exp_f32 v21, v21
    v_exp_f32 v22, v22
    v_mfma_f32_16x16x32_bf16 a[164:167], v[48:51], a[52:55], a[164:167]
    v_perm_b32 v56, v167, v163, s38
    v_perm_b32 v57, v175, v171, s38
    v_exp_f32 v23, v23
    v_exp_f32 v24, v24
    s_xor_b32 s97, s99, 0xbc00
    buffer_load_dwordx4 v[92:95], v0, s[56:59], s97 offen nt
    v_exp_f32 v25, v25
    v_add_f32 v28, v28, v10
    v_add_f32 v28, v28, v11
    v_mfma_f32_16x16x32_bf16 a[168:171], v[52:55], a[48:51], a[168:171]
    v_perm_b32 v58, v183, v179, s38
    v_perm_b32 v59, v191, v187, s38
    v_add_f32 v28, v28, v12
    v_add_f32 v28, v28, v13
    v_add_f32 v28, v28, v14
    v_add_f32 v28, v28, v15
    v_add_f32 v28, v28, v16
    v_mfma_f32_16x16x32_bf16 a[172:175], v[52:55], a[52:55], a[172:175]
    v_perm_b32 v60, v167, v163, s39
    v_perm_b32 v61, v175, v171, s39
    v_add_f32 v28, v28, v17
    v_add_f32 v29, v29, v18
    v_add_f32 v29, v29, v19
    v_add_f32 v29, v29, v20
    v_add_f32 v29, v29, v21
    v_mfma_f32_16x16x32_bf16 a[176:179], v[56:59], a[48:51], a[176:179]
    v_perm_b32 v62, v183, v179, s39
    v_perm_b32 v63, v191, v187, s39
    v_add_f32 v29, v29, v22
    v_add_f32 v29, v29, v23
    v_add_f32 v29, v29, v24
    v_add_f32 v29, v29, v25
    v_cvt_pk_bf16_f32 v10, v10, v11
    v_mfma_f32_16x16x32_bf16 a[180:183], v[56:59], a[52:55], a[180:183]
    v_cvt_pk_bf16_f32 v12, v12, v13
    v_cvt_pk_bf16_f32 v14, v14, v15
    v_cvt_pk_bf16_f32 v16, v16, v17
    v_cvt_pk_bf16_f32 v18, v18, v19
    v_cvt_pk_bf16_f32 v20, v20, v21
    v_mfma_f32_16x16x32_bf16 a[184:187], v[60:63], a[48:51], a[184:187]
    v_cvt_pk_bf16_f32 v22, v22, v23
    v_cvt_pk_bf16_f32 v24, v24, v25
    v_accvgpr_write_b32 a64, v10
    v_accvgpr_write_b32 a65, v12
    v_accvgpr_write_b32 a66, v14
    v_mfma_f32_16x16x32_bf16 a[188:191], v[60:63], a[52:55], a[188:191]
    v_accvgpr_write_b32 a67, v16
    v_accvgpr_write_b32 a68, v18
    v_accvgpr_write_b32 a69, v20
    v_accvgpr_write_b32 a70, v22
    v_accvgpr_write_b32 a71, v24
    v_perm_b32 v32, v196, v192, s38
    v_perm_b32 v33, v204, v200, s38
    s_xor_b32 s97, s99, 0xc000
    buffer_load_dwordx4 v[96:99], v0, s[56:59], s97 offen nt
    v_perm_b32 v34, v212, v208, s38
    v_perm_b32 v35, v220, v216, s38
    v_perm_b32 v36, v196, v192, s39
    v_perm_b32 v37, v204, v200, s39
    v_mfma_f32_16x16x32_bf16 a[128:131], v[32:35], a[64:67], a[128:131]
    v_perm_b32 v38, v212, v208, s39
    v_perm_b32 v39, v220, v216, s39
    v_accvgpr_read_b32 v10, a80
    v_accvgpr_read_b32 v11, a81
    v_accvgpr_read_b32 v12, a82
    v_accvgpr_read_b32 v13, a83
    v_accvgpr_read_b32 v14, a88
    v_mfma_f32_16x16x32_bf16 a[132:135], v[32:35], a[68:71], a[132:135]
    v_perm_b32 v40, v197, v193, s38
    v_perm_b32 v41, v205, v201, s38
    v_accvgpr_read_b32 v15, a89
    v_accvgpr_read_b32 v16, a90
    v_accvgpr_read_b32 v17, a91
    v_accvgpr_read_b32 v18, a84
    v_accvgpr_read_b32 v19, a85
    v_mfma_f32_16x16x32_bf16 a[136:139], v[36:39], a[64:67], a[136:139]
    v_perm_b32 v42, v213, v209, s38
    v_perm_b32 v43, v221, v217, s38
    v_accvgpr_read_b32 v20, a86
    v_accvgpr_read_b32 v21, a87
    v_accvgpr_read_b32 v22, a92
    v_accvgpr_read_b32 v23, a93
    v_accvgpr_read_b32 v24, a94
    v_mfma_f32_16x16x32_bf16 a[140:143], v[36:39], a[68:71], a[140:143]
    v_perm_b32 v44, v197, v193, s39
    v_perm_b32 v45, v205, v201, s39
    v_accvgpr_read_b32 v25, a95
    v_fma_f32 v10, v10, s96, -v26
    v_fma_f32 v11, v11, s96, -v26
    v_fma_f32 v12, v12, s96, -v26
    v_fma_f32 v13, v13, s96, -v26
    v_mfma_f32_16x16x32_bf16 a[144:147], v[40:43], a[64:67], a[144:147]
    v_perm_b32 v46, v213, v209, s39
    v_perm_b32 v47, v221, v217, s39
    v_fma_f32 v14, v14, s96, -v26
    v_fma_f32 v15, v15, s96, -v26
    v_fma_f32 v16, v16, s96, -v26
    v_fma_f32 v17, v17, s96, -v26
    v_fma_f32 v18, v18, s96, -v27
    v_mfma_f32_16x16x32_bf16 a[148:151], v[40:43], a[68:71], a[148:151]
    v_perm_b32 v48, v198, v194, s38
    v_perm_b32 v49, v206, v202, s38
    v_fma_f32 v19, v19, s96, -v27
    s_xor_b32 s97, s99, 0xc400
    buffer_load_dwordx4 v[100:103], v0, s[56:59], s97 offen nt
    v_fma_f32 v20, v20, s96, -v27
    v_fma_f32 v21, v21, s96, -v27
    v_fma_f32 v22, v22, s96, -v27
    v_fma_f32 v23, v23, s96, -v27
    v_mfma_f32_16x16x32_bf16 a[152:155], v[44:47], a[64:67], a[152:155]
    v_perm_b32 v50, v214, v210, s38
    v_perm_b32 v51, v222, v218, s38
    v_fma_f32 v24, v24, s96, -v27
    v_fma_f32 v25, v25, s96, -v27
    v_exp_f32 v10, v10
    v_exp_f32 v11, v11
    v_exp_f32 v12, v12
    v_mfma_f32_16x16x32_bf16 a[156:159], v[44:47], a[68:71], a[156:159]
    v_perm_b32 v52, v198, v194, s39
    v_perm_b32 v53, v206, v202, s39
    v_exp_f32 v13, v13
    v_exp_f32 v14, v14
    v_exp_f32 v15, v15
    v_exp_f32 v16, v16
    v_exp_f32 v17, v17
    v_mfma_f32_16x16x32_bf16 a[160:163], v[48:51], a[64:67], a[160:163]
    v_perm_b32 v54, v214, v210, s39
    v_perm_b32 v55, v222, v218, s39
    v_exp_f32 v18, v18
    v_exp_f32 v19, v19
    v_exp_f32 v20, v20
    v_exp_f32 v21, v21
    v_exp_f32 v22, v22
    v_mfma_f32_16x16x32_bf16 a[164:167], v[48:51], a[68:71], a[164:167]
    v_perm_b32 v56, v199, v195, s38
    v_perm_b32 v57, v207, v203, s38
    v_exp_f32 v23, v23
    v_exp_f32 v24, v24
    s_xor_b32 s97, s99, 0xc800
    buffer_load_dwordx4 v[104:107], v0, s[56:59], s97 offen nt
    v_exp_f32 v25, v25
    v_add_f32 v28, v28, v10
    v_add_f32 v28, v28, v11
    v_mfma_f32_16x16x32_bf16 a[168:171], v[52:55], a[64:67], a[168:171]
    v_perm_b32 v58, v215, v211, s38
    v_perm_b32 v59, v223, v219, s38
    v_add_f32 v28, v28, v12
    v_add_f32 v28, v28, v13
    v_add_f32 v28, v28, v14
    v_add_f32 v28, v28, v15
    v_add_f32 v28, v28, v16
    v_mfma_f32_16x16x32_bf16 a[172:175], v[52:55], a[68:71], a[172:175]
    v_perm_b32 v60, v199, v195, s39
    v_perm_b32 v61, v207, v203, s39
    v_add_f32 v28, v28, v17
    v_add_f32 v29, v29, v18
    v_add_f32 v29, v29, v19
    v_add_f32 v29, v29, v20
    v_add_f32 v29, v29, v21
    v_mfma_f32_16x16x32_bf16 a[176:179], v[56:59], a[64:67], a[176:179]
    v_perm_b32 v62, v215, v211, s39
    v_perm_b32 v63, v223, v219, s39
    v_add_f32 v29, v29, v22
    v_add_f32 v29, v29, v23
    v_add_f32 v29, v29, v24
    v_add_f32 v29, v29, v25
    v_cvt_pk_bf16_f32 v10, v10, v11
    v_mfma_f32_16x16x32_bf16 a[180:183], v[56:59], a[68:71], a[180:183]
    v_cvt_pk_bf16_f32 v12, v12, v13
    v_cvt_pk_bf16_f32 v14, v14, v15
    v_cvt_pk_bf16_f32 v16, v16, v17
    v_cvt_pk_bf16_f32 v18, v18, v19
    v_cvt_pk_bf16_f32 v20, v20, v21
    v_mfma_f32_16x16x32_bf16 a[184:187], v[60:63], a[64:67], a[184:187]
    v_cvt_pk_bf16_f32 v22, v22, v23
    v_cvt_pk_bf16_f32 v24, v24, v25
    v_accvgpr_write_b32 a80, v10
    v_accvgpr_write_b32 a81, v12
    v_accvgpr_write_b32 a82, v14
    v_mfma_f32_16x16x32_bf16 a[188:191], v[60:63], a[68:71], a[188:191]
    v_accvgpr_write_b32 a83, v16
    v_accvgpr_write_b32 a84, v18
    v_accvgpr_write_b32 a85, v20
    v_accvgpr_write_b32 a86, v22
    v_accvgpr_write_b32 a87, v24
    s_xor_b32 s97, s99, 0xcc00
    buffer_load_dwordx4 v[108:111], v0, s[56:59], s97 offen nt
    s_xor_b32 s97, s99, 0xd000
    buffer_load_dwordx4 v[112:115], v0, s[56:59], s97 offen nt
    s_xor_b32 s97, s99, 0xd400
    buffer_load_dwordx4 v[116:119], v0, s[56:59], s97 offen nt
    s_xor_b32 s97, s99, 0xd800
    buffer_load_dwordx4 v[120:123], v0, s[56:59], s97 offen nt
    s_xor_b32 s97, s99, 0xdc00
    buffer_load_dwordx4 v[124:127], v0, s[56:59], s97 offen nt
    s_xor_b32 s97, s99, 0xe000
    buffer_load_dwordx4 v[128:131], v0, s[56:59], s97 offen nt
    s_xor_b32 s97, s99, 0xe400
    buffer_load_dwordx4 v[132:135], v0, s[56:59], s97 offen nt
    s_xor_b32 s97, s99, 0xe800
    buffer_load_dwordx4 v[136:139], v0, s[56:59], s97 offen nt
    s_xor_b32 s97, s99, 0xec00
    buffer_load_dwordx4 v[140:143], v0, s[56:59], s97 offen nt
    s_xor_b32 s97, s99, 0xf000
    buffer_load_dwordx4 v[144:147], v0, s[56:59], s97 offen nt
    s_xor_b32 s97, s99, 0xf400
    buffer_load_dwordx4 v[148:151], v0, s[56:59], s97 offen nt
    s_xor_b32 s97, s99, 0xf800
    buffer_load_dwordx4 v[152:155], v0, s[56:59], s97 offen nt
    s_xor_b32 s97, s99, 0xfc00
    buffer_load_dwordx4 v[156:159], v0, s[56:59], s97 offen nt
    s_waitcnt vmcnt(16)
    v_perm_b32 v32, v68, v64, s38
    v_perm_b32 v33, v76, v72, s38
    v_perm_b32 v34, v84, v80, s38
    v_perm_b32 v35, v92, v88, s38
    v_perm_b32 v36, v68, v64, s39
    v_perm_b32 v37, v76, v72, s39
    v_mfma_f32_16x16x32_bf16 a[128:131], v[32:35], a[80:83], a[128:131]
    v_perm_b32 v38, v84, v80, s39
    v_perm_b32 v39, v92, v88, s39
    v_accvgpr_read_b32 v10, a96
    v_accvgpr_read_b32 v11, a97
    v_accvgpr_read_b32 v12, a98
    v_accvgpr_read_b32 v13, a99
    v_accvgpr_read_b32 v14, a104
    v_mfma_f32_16x16x32_bf16 a[132:135], v[32:35], a[84:87], a[132:135]
    v_perm_b32 v40, v69, v65, s38
    v_perm_b32 v41, v77, v73, s38
    v_accvgpr_read_b32 v15, a105
    v_accvgpr_read_b32 v16, a106
    v_accvgpr_read_b32 v17, a107
    v_accvgpr_read_b32 v18, a100
    v_accvgpr_read_b32 v19, a101
    v_mfma_f32_16x16x32_bf16 a[136:139], v[36:39], a[80:83], a[136:139]
    v_perm_b32 v42, v85, v81, s38
    v_perm_b32 v43, v93, v89, s38
    v_accvgpr_read_b32 v20, a102
    v_accvgpr_read_b32 v21, a103
    v_accvgpr_read_b32 v22, a108
    v_accvgpr_read_b32 v23, a109
    v_accvgpr_read_b32 v24, a110
    v_mfma_f32_16x16x32_bf16 a[140:143], v[36:39], a[84:87], a[140:143]
    v_perm_b32 v44, v69, v65, s39
    v_perm_b32 v45, v77, v73, s39
    v_accvgpr_read_b32 v25, a111
    v_fma_f32 v10, v10, s96, -v26
    v_fma_f32 v11, v11, s96, -v26
    v_fma_f32 v12, v12, s96, -v26
    v_fma_f32 v13, v13, s96, -v26
    v_mfma_f32_16x16x32_bf16 a[144:147], v[40:43], a[80:83], a[144:147]
    v_perm_b32 v46, v85, v81, s39
    v_perm_b32 v47, v93, v89, s39
    v_fma_f32 v14, v14, s96, -v26
    v_fma_f32 v15, v15, s96, -v26
    v_fma_f32 v16, v16, s96, -v26
    v_fma_f32 v17, v17, s96, -v26
    v_fma_f32 v18, v18, s96, -v27
    v_mfma_f32_16x16x32_bf16 a[148:151], v[40:43], a[84:87], a[148:151]
    s_add_u32 m0, s98, 0x6180
    s_xor_b32 s97, s99, 0x16000
    buffer_load_dwordx4 v1, s[52:55], s97 offen nt lds
    v_perm_b32 v48, v70, v66, s38
    v_perm_b32 v49, v78, v74, s38
    v_fma_f32 v19, v19, s96, -v27
    v_fma_f32 v20, v20, s96, -v27
    v_fma_f32 v21, v21, s96, -v27
    v_fma_f32 v22, v22, s96, -v27
    v_fma_f32 v23, v23, s96, -v27
    v_mfma_f32_16x16x32_bf16 a[152:155], v[44:47], a[80:83], a[152:155]
    v_perm_b32 v50, v86, v82, s38
    v_perm_b32 v51, v94, v90, s38
    v_fma_f32 v24, v24, s96, -v27
    v_fma_f32 v25, v25, s96, -v27
    v_exp_f32 v10, v10
    v_exp_f32 v11, v11
    v_exp_f32 v12, v12
    v_mfma_f32_16x16x32_bf16 a[156:159], v[44:47], a[84:87], a[156:159]
    v_perm_b32 v52, v70, v66, s39
    v_perm_b32 v53, v78, v74, s39
    v_exp_f32 v13, v13
    v_exp_f32 v14, v14
    v_exp_f32 v15, v15
    v_exp_f32 v16, v16
    v_exp_f32 v17, v17
    v_mfma_f32_16x16x32_bf16 a[160:163], v[48:51], a[80:83], a[160:163]
    v_perm_b32 v54, v86, v82, s39
    v_perm_b32 v55, v94, v90, s39
    v_exp_f32 v18, v18
    v_exp_f32 v19, v19
    v_exp_f32 v20, v20
    v_exp_f32 v21, v21
    v_exp_f32 v22, v22
    v_mfma_f32_16x16x32_bf16 a[164:167], v[48:51], a[84:87], a[164:167]
    v_perm_b32 v56, v71, v67, s38
    v_perm_b32 v57, v79, v75, s38
    v_exp_f32 v23, v23
    s_add_u32 m0, s98, 0x6490
    s_xor_b32 s97, s99, 0x16000
    buffer_load_dwordx4 v1, s[52:55], s97 offen offset:256 nt lds
    v_exp_f32 v24, v24
    v_exp_f32 v25, v25
    v_add_f32 v28, v28, v10
    v_add_f32 v28, v28, v11
    v_mfma_f32_16x16x32_bf16 a[168:171], v[52:55], a[80:83], a[168:171]
    v_perm_b32 v58, v87, v83, s38
    v_perm_b32 v59, v95, v91, s38
    v_add_f32 v28, v28, v12
    v_add_f32 v28, v28, v13
    v_add_f32 v28, v28, v14
    v_add_f32 v28, v28, v15
    v_add_f32 v28, v28, v16
    v_mfma_f32_16x16x32_bf16 a[172:175], v[52:55], a[84:87], a[172:175]
    v_perm_b32 v60, v71, v67, s39
    v_perm_b32 v61, v79, v75, s39
    v_add_f32 v28, v28, v17
    v_add_f32 v29, v29, v18
    v_add_f32 v29, v29, v19
    v_add_f32 v29, v29, v20
    v_add_f32 v29, v29, v21
    v_mfma_f32_16x16x32_bf16 a[176:179], v[56:59], a[80:83], a[176:179]
    v_perm_b32 v62, v87, v83, s39
    v_perm_b32 v63, v95, v91, s39
    v_add_f32 v29, v29, v22
    v_add_f32 v29, v29, v23
    v_add_f32 v29, v29, v24
    v_add_f32 v29, v29, v25
    v_cvt_pk_bf16_f32 v10, v10, v11
    v_mfma_f32_16x16x32_bf16 a[180:183], v[56:59], a[84:87], a[180:183]
    v_cvt_pk_bf16_f32 v12, v12, v13
    v_cvt_pk_bf16_f32 v14, v14, v15
    v_cvt_pk_bf16_f32 v16, v16, v17
    v_cvt_pk_bf16_f32 v18, v18, v19
    v_cvt_pk_bf16_f32 v20, v20, v21
    v_mfma_f32_16x16x32_bf16 a[184:187], v[60:63], a[80:83], a[184:187]
    v_cvt_pk_bf16_f32 v22, v22, v23
    v_cvt_pk_bf16_f32 v24, v24, v25
    v_accvgpr_write_b32 a96, v10
    v_accvgpr_write_b32 a97, v12
    v_accvgpr_write_b32 a98, v14
    v_mfma_f32_16x16x32_bf16 a[188:191], v[60:63], a[84:87], a[188:191]
    v_accvgpr_write_b32 a99, v16
    v_accvgpr_write_b32 a100, v18
    v_accvgpr_write_b32 a101, v20
    v_accvgpr_write_b32 a102, v22
    v_accvgpr_write_b32 a103, v24
    s_add_u32 m0, s98, 0x67a0
    s_xor_b32 s97, s99, 0x16000
    buffer_load_dwordx4 v1, s[52:55], s97 offen offset:512 nt lds
    s_add_u32 m0, s98, 0x6ab0
    s_xor_b32 s97, s99, 0x16000
    buffer_load_dwordx4 v1, s[52:55], s97 offen offset:768 nt lds
    s_add_u32 m0, s98, 0x71c0
    s_xor_b32 s97, s99, 0x17000
    buffer_load_dwordx4 v1, s[52:55], s97 offen nt lds
    s_add_u32 m0, s98, 0x74d0
    s_xor_b32 s97, s99, 0x17000
    buffer_load_dwordx4 v1, s[52:55], s97 offen offset:256 nt lds
    s_add_u32 m0, s98, 0x77e0
    s_xor_b32 s97, s99, 0x17000
    buffer_load_dwordx4 v1, s[52:55], s97 offen offset:512 nt lds
    s_add_u32 m0, s98, 0x7af0
    s_xor_b32 s97, s99, 0x17000
    buffer_load_dwordx4 v1, s[52:55], s97 offen offset:768 nt lds
    s_waitcnt vmcnt(16)
    v_perm_b32 v32, v100, v96, s38
    v_perm_b32 v33, v108, v104, s38
    v_perm_b32 v34, v116, v112, s38
    v_perm_b32 v35, v124, v120, s38
    v_perm_b32 v36, v100, v96, s39
    v_perm_b32 v37, v108, v104, s39
    v_mfma_f32_16x16x32_bf16 a[128:131], v[32:35], a[96:99], a[128:131]
    v_perm_b32 v38, v116, v112, s39
    v_perm_b32 v39, v124, v120, s39
    v_accvgpr_read_b32 v10, a112
    v_accvgpr_read_b32 v11, a113
    v_accvgpr_read_b32 v12, a114
    v_accvgpr_read_b32 v13, a115
    v_accvgpr_read_b32 v14, a120
    v_mfma_f32_16x16x32_bf16 a[132:135], v[32:35], a[100:103], a[132:135]
    v_perm_b32 v40, v101, v97, s38
    v_perm_b32 v41, v109, v105, s38
    v_accvgpr_read_b32 v15, a121
    v_accvgpr_read_b32 v16, a122
    v_accvgpr_read_b32 v17, a123
    v_accvgpr_read_b32 v18, a116
    v_accvgpr_read_b32 v19, a117
    v_mfma_f32_16x16x32_bf16 a[136:139], v[36:39], a[96:99], a[136:139]
    v_perm_b32 v42, v117, v113, s38
    v_perm_b32 v43, v125, v121, s38
    v_accvgpr_read_b32 v20, a118
    v_accvgpr_read_b32 v21, a119
    v_accvgpr_read_b32 v22, a124
    v_accvgpr_read_b32 v23, a125
    v_accvgpr_read_b32 v24, a126
    v_mfma_f32_16x16x32_bf16 a[140:143], v[36:39], a[100:103], a[140:143]
    v_perm_b32 v44, v101, v97, s39
    v_perm_b32 v45, v109, v105, s39
    v_accvgpr_read_b32 v25, a127
    v_fma_f32 v10, v10, s96, -v26
    v_fma_f32 v11, v11, s96, -v26
    v_fma_f32 v12, v12, s96, -v26
    v_fma_f32 v13, v13, s96, -v26
    v_mfma_f32_16x16x32_bf16 a[144:147], v[40:43], a[96:99], a[144:147]
    v_perm_b32 v46, v117, v113, s39
    v_perm_b32 v47, v125, v121, s39
    v_fma_f32 v14, v14, s96, -v26
    v_fma_f32 v15, v15, s96, -v26
    v_fma_f32 v16, v16, s96, -v26
    v_fma_f32 v17, v17, s96, -v26
    v_fma_f32 v18, v18, s96, -v27
    v_mfma_f32_16x16x32_bf16 a[148:151], v[40:43], a[100:103], a[148:151]
    s_xor_b32 s97, s99, 0x10000
    buffer_load_dwordx4 v[160:163], v0, s[56:59], s97 offen nt
    v_perm_b32 v48, v102, v98, s38
    v_perm_b32 v49, v110, v106, s38
    v_fma_f32 v19, v19, s96, -v27
    v_fma_f32 v20, v20, s96, -v27
    v_fma_f32 v21, v21, s96, -v27
    v_fma_f32 v22, v22, s96, -v27
    v_fma_f32 v23, v23, s96, -v27
    v_mfma_f32_16x16x32_bf16 a[152:155], v[44:47], a[96:99], a[152:155]
    v_perm_b32 v50, v118, v114, s38
    v_perm_b32 v51, v126, v122, s38
    v_fma_f32 v24, v24, s96, -v27
    v_fma_f32 v25, v25, s96, -v27
    v_exp_f32 v10, v10
    v_exp_f32 v11, v11
    v_exp_f32 v12, v12
    v_mfma_f32_16x16x32_bf16 a[156:159], v[44:47], a[100:103], a[156:159]
    v_perm_b32 v52, v102, v98, s39
    v_perm_b32 v53, v110, v106, s39
    v_exp_f32 v13, v13
    v_exp_f32 v14, v14
    v_exp_f32 v15, v15
    v_exp_f32 v16, v16
    v_exp_f32 v17, v17
    v_mfma_f32_16x16x32_bf16 a[160:163], v[48:51], a[96:99], a[160:163]
    v_perm_b32 v54, v118, v114, s39
    v_perm_b32 v55, v126, v122, s39
    v_exp_f32 v18, v18
    v_exp_f32 v19, v19
    v_exp_f32 v20, v20
    v_exp_f32 v21, v21
    v_exp_f32 v22, v22
    v_mfma_f32_16x16x32_bf16 a[164:167], v[48:51], a[100:103], a[164:167]
    v_perm_b32 v56, v103, v99, s38
    v_perm_b32 v57, v111, v107, s38
    v_exp_f32 v23, v23
    s_xor_b32 s97, s99, 0x10400
    buffer_load_dwordx4 v[164:167], v0, s[56:59], s97 offen nt
    v_exp_f32 v24, v24
    v_exp_f32 v25, v25
    v_add_f32 v28, v28, v10
    v_add_f32 v28, v28, v11
    v_mfma_f32_16x16x32_bf16 a[168:171], v[52:55], a[96:99], a[168:171]
    v_perm_b32 v58, v119, v115, s38
    v_perm_b32 v59, v127, v123, s38
    v_add_f32 v28, v28, v12
    v_add_f32 v28, v28, v13
    v_add_f32 v28, v28, v14
    v_add_f32 v28, v28, v15
    v_add_f32 v28, v28, v16
    v_mfma_f32_16x16x32_bf16 a[172:175], v[52:55], a[100:103], a[172:175]
    v_perm_b32 v60, v103, v99, s39
    v_perm_b32 v61, v111, v107, s39
    v_add_f32 v28, v28, v17
    v_add_f32 v29, v29, v18
    v_add_f32 v29, v29, v19
    v_add_f32 v29, v29, v20
    v_add_f32 v29, v29, v21
    v_mfma_f32_16x16x32_bf16 a[176:179], v[56:59], a[96:99], a[176:179]
    v_perm_b32 v62, v119, v115, s39
    v_perm_b32 v63, v127, v123, s39
    v_add_f32 v29, v29, v22
    v_add_f32 v29, v29, v23
    v_add_f32 v29, v29, v24
    v_add_f32 v29, v29, v25
    v_cvt_pk_bf16_f32 v10, v10, v11
    v_mfma_f32_16x16x32_bf16 a[180:183], v[56:59], a[100:103], a[180:183]
    v_cvt_pk_bf16_f32 v12, v12, v13
    v_cvt_pk_bf16_f32 v14, v14, v15
    v_cvt_pk_bf16_f32 v16, v16, v17
    v_cvt_pk_bf16_f32 v18, v18, v19
    v_cvt_pk_bf16_f32 v20, v20, v21
    v_mfma_f32_16x16x32_bf16 a[184:187], v[60:63], a[96:99], a[184:187]
    v_cvt_pk_bf16_f32 v22, v22, v23
    v_cvt_pk_bf16_f32 v24, v24, v25
    v_accvgpr_write_b32 a112, v10
    v_accvgpr_write_b32 a113, v12
    v_accvgpr_write_b32 a114, v14
    v_mfma_f32_16x16x32_bf16 a[188:191], v[60:63], a[100:103], a[188:191]
    v_accvgpr_write_b32 a115, v16
    v_accvgpr_write_b32 a116, v18
    v_accvgpr_write_b32 a117, v20
    v_accvgpr_write_b32 a118, v22
    v_accvgpr_write_b32 a119, v24
    s_xor_b32 s97, s99, 0x10800
    buffer_load_dwordx4 v[168:171], v0, s[56:59], s97 offen nt
    s_xor_b32 s97, s99, 0x10c00
    buffer_load_dwordx4 v[172:175], v0, s[56:59], s97 offen nt
    s_xor_b32 s97, s99, 0x11000
    buffer_load_dwordx4 v[176:179], v0, s[56:59], s97 offen nt
    s_xor_b32 s97, s99, 0x11400
    buffer_load_dwordx4 v[180:183], v0, s[56:59], s97 offen nt
    s_xor_b32 s97, s99, 0x11800
    buffer_load_dwordx4 v[184:187], v0, s[56:59], s97 offen nt
    s_xor_b32 s97, s99, 0x11c00
    buffer_load_dwordx4 v[188:191], v0, s[56:59], s97 offen nt
    s_waitcnt vmcnt(16)
    v_perm_b32 v32, v132, v128, s38
    v_perm_b32 v33, v140, v136, s38
    v_perm_b32 v34, v148, v144, s38
    v_perm_b32 v35, v156, v152, s38
    v_perm_b32 v36, v132, v128, s39
    v_perm_b32 v37, v140, v136, s39
    v_mfma_f32_16x16x32_bf16 a[128:131], v[32:35], a[112:115], a[128:131]
    v_perm_b32 v38, v148, v144, s39
    v_perm_b32 v39, v156, v152, s39
    v_mfma_f32_16x16x32_bf16 a[132:135], v[32:35], a[116:119], a[132:135]
    v_perm_b32 v40, v133, v129, s38
    v_perm_b32 v41, v141, v137, s38
    v_mfma_f32_16x16x32_bf16 a[136:139], v[36:39], a[112:115], a[136:139]
    v_perm_b32 v42, v149, v145, s38
    v_perm_b32 v43, v157, v153, s38
    v_mfma_f32_16x16x32_bf16 a[140:143], v[36:39], a[116:119], a[140:143]
    v_perm_b32 v44, v133, v129, s39
    v_perm_b32 v45, v141, v137, s39
    v_mfma_f32_16x16x32_bf16 a[144:147], v[40:43], a[112:115], a[144:147]
    v_perm_b32 v46, v149, v145, s39
    v_perm_b32 v47, v157, v153, s39
    v_mfma_f32_16x16x32_bf16 a[148:151], v[40:43], a[116:119], a[148:151]
    v_perm_b32 v48, v134, v130, s38
    v_perm_b32 v49, v142, v138, s38
    v_mfma_f32_16x16x32_bf16 a[152:155], v[44:47], a[112:115], a[152:155]
    v_perm_b32 v50, v150, v146, s38
    v_perm_b32 v51, v158, v154, s38
    v_mfma_f32_16x16x32_bf16 a[156:159], v[44:47], a[116:119], a[156:159]
    v_perm_b32 v52, v134, v130, s39
    v_perm_b32 v53, v142, v138, s39
    v_mfma_f32_16x16x32_bf16 a[160:163], v[48:51], a[112:115], a[160:163]
    v_perm_b32 v54, v150, v146, s39
    v_perm_b32 v55, v158, v154, s39
    v_mfma_f32_16x16x32_bf16 a[164:167], v[48:51], a[116:119], a[164:167]
    v_perm_b32 v56, v135, v131, s38
    v_perm_b32 v57, v143, v139, s38
    v_mfma_f32_16x16x32_bf16 a[168:171], v[52:55], a[112:115], a[168:171]
    s_xor_b32 s97, s99, 0x12000
    buffer_load_dwordx4 v[192:195], v0, s[56:59], s97 offen nt
    v_perm_b32 v58, v151, v147, s38
    v_perm_b32 v59, v159, v155, s38
    v_mfma_f32_16x16x32_bf16 a[172:175], v[52:55], a[116:119], a[172:175]
    v_perm_b32 v60, v135, v131, s39
    v_perm_b32 v61, v143, v139, s39
    v_mfma_f32_16x16x32_bf16 a[176:179], v[56:59], a[112:115], a[176:179]
    v_perm_b32 v62, v151, v147, s39
    v_perm_b32 v63, v159, v155, s39
    v_mfma_f32_16x16x32_bf16 a[180:183], v[56:59], a[116:119], a[180:183]
    s_nop 0
    v_mfma_f32_16x16x32_bf16 a[184:187], v[60:63], a[112:115], a[184:187]
    v_mfma_f32_16x16x32_bf16 a[188:191], v[60:63], a[116:119], a[188:191]
    v_accvgpr_write_b32 a224, v26
    v_accvgpr_write_b32 a225, v27
    ds_read_b128 v[224:227], v2
    ds_read_b128 v[228:231], v2 offset:16
    ds_read_b128 v[232:235], v2 offset:32
    ds_read_b128 v[236:239], v2 offset:48
    ds_read_b128 v[240:243], v2 offset:4160
    ds_read_b128 v[244:247], v2 offset:4176
    ds_read_b128 v[248:251], v2 offset:4192
    ds_read_b128 v[252:255], v2 offset:4208
    s_waitcnt lgkmcnt(0)
    s_xor_b32 s97, s99, 0x12400
    buffer_load_dwordx4 v[196:199], v0, s[56:59], s97 offen nt
    v_mfma_f32_16x16x32_bf16 a[0:3], v[224:227], a[192:195], 0
    v_mfma_f32_16x16x32_bf16 a[4:7], v[224:227], a[196:199], 0
    v_mfma_f32_16x16x32_bf16 a[8:11], v[240:243], a[192:195], 0
    v_mfma_f32_16x16x32_bf16 a[12:15], v[240:243], a[196:199], 0
    v_mfma_f32_16x16x32_bf16 a[0:3], v[228:231], a[200:203], a[0:3]
    v_mfma_f32_16x16x32_bf16 a[4:7], v[228:231], a[204:207], a[4:7]
    v_mfma_f32_16x16x32_bf16 a[8:11], v[244:247], a[200:203], a[8:11]
    v_mfma_f32_16x16x32_bf16 a[12:15], v[244:247], a[204:207], a[12:15]
    v_mfma_f32_16x16x32_bf16 a[0:3], v[232:235], a[208:211], a[0:3]
    v_mfma_f32_16x16x32_bf16 a[4:7], v[232:235], a[212:215], a[4:7]
    v_mfma_f32_16x16x32_bf16 a[8:11], v[248:251], a[208:211], a[8:11]
    v_mfma_f32_16x16x32_bf16 a[12:15], v[248:251], a[212:215], a[12:15]
    v_mfma_f32_16x16x32_bf16 a[0:3], v[236:239], a[216:219], a[0:3]
    s_xor_b32 s97, s99, 0x12800
    buffer_load_dwordx4 v[200:203], v0, s[56:59], s97 offen nt
    v_mfma_f32_16x16x32_bf16 a[4:7], v[236:239], a[220:223], a[4:7]
    v_mfma_f32_16x16x32_bf16 a[8:11], v[252:255], a[216:219], a[8:11]
    v_mfma_f32_16x16x32_bf16 a[12:15], v[252:255], a[220:223], a[12:15]
    ds_read_b128 v[32:35], v2 offset:8320
    ds_read_b128 v[36:39], v2 offset:8336
    ds_read_b128 v[40:43], v2 offset:8352
    ds_read_b128 v[44:47], v2 offset:8368
    ds_read_b128 v[48:51], v2 offset:12480
    ds_read_b128 v[52:55], v2 offset:12496
    ds_read_b128 v[56:59], v2 offset:12512
    ds_read_b128 v[60:63], v2 offset:12528
    s_waitcnt lgkmcnt(0)
    v_mfma_f32_16x16x32_bf16 a[16:19], v[32:35], a[192:195], 0
    v_mfma_f32_16x16x32_bf16 a[20:23], v[32:35], a[196:199], 0
    s_xor_b32 s97, s99, 0x12c00
    buffer_load_dwordx4 v[204:207], v0, s[56:59], s97 offen nt
    v_mfma_f32_16x16x32_bf16 a[24:27], v[48:51], a[192:195], 0
    v_mfma_f32_16x16x32_bf16 a[28:31], v[48:51], a[196:199], 0
    v_accvgpr_read_b32 v10, a0
    v_accvgpr_read_b32 v11, a1
    v_mfma_f32_16x16x32_bf16 a[16:19], v[36:39], a[200:203], a[16:19]
    v_accvgpr_read_b32 v12, a2
    v_accvgpr_read_b32 v13, a3
    v_mfma_f32_16x16x32_bf16 a[20:23], v[36:39], a[204:207], a[20:23]
    v_accvgpr_read_b32 v14, a8
    v_accvgpr_read_b32 v15, a9
    v_mfma_f32_16x16x32_bf16 a[24:27], v[52:55], a[200:203], a[24:27]
    v_accvgpr_read_b32 v16, a10
    v_accvgpr_read_b32 v17, a11
    v_mfma_f32_16x16x32_bf16 a[28:31], v[52:55], a[204:207], a[28:31]
    v_accvgpr_read_b32 v18, a4
    v_accvgpr_read_b32 v19, a5
    v_mfma_f32_16x16x32_bf16 a[16:19], v[40:43], a[208:211], a[16:19]
    v_accvgpr_read_b32 v20, a6
    v_accvgpr_read_b32 v21, a7
    v_mfma_f32_16x16x32_bf16 a[20:23], v[40:43], a[212:215], a[20:23]
    v_accvgpr_read_b32 v22, a12
    v_accvgpr_read_b32 v23, a13
    v_mfma_f32_16x16x32_bf16 a[24:27], v[56:59], a[208:211], a[24:27]
    v_accvgpr_read_b32 v24, a14
    v_accvgpr_read_b32 v25, a15
    v_mfma_f32_16x16x32_bf16 a[28:31], v[56:59], a[212:215], a[28:31]
    v_max3_f32 v26, v10, v11, v12
    v_max3_f32 v26, v26, v13, v14
    v_mfma_f32_16x16x32_bf16 a[16:19], v[44:47], a[216:219], a[16:19]
    v_max3_f32 v26, v26, v15, v16
    v_max_f32 v26, v26, v17
    v_mfma_f32_16x16x32_bf16 a[20:23], v[44:47], a[220:223], a[20:23]
    v_max3_f32 v27, v18, v19, v20
    v_max3_f32 v27, v27, v21, v22
    s_xor_b32 s97, s99, 0x13000
    buffer_load_dwordx4 v[208:211], v0, s[56:59], s97 offen nt
    v_mfma_f32_16x16x32_bf16 a[24:27], v[60:63], a[216:219], a[24:27]
    v_max3_f32 v27, v27, v23, v24
    v_max_f32 v27, v27, v25
    v_mfma_f32_16x16x32_bf16 a[28:31], v[60:63], a[220:223], a[28:31]
    ds_read_b128 v[224:227], v2 offset:16640
    ds_read_b128 v[228:231], v2 offset:16656
    ds_read_b128 v[232:235], v2 offset:16672
    ds_read_b128 v[236:239], v2 offset:16688
    ds_read_b128 v[240:243], v2 offset:20800
    ds_read_b128 v[244:247], v2 offset:20816
    ds_read_b128 v[248:251], v2 offset:20832
    ds_read_b128 v[252:255], v2 offset:20848
    s_waitcnt lgkmcnt(0)
    v_mfma_f32_16x16x32_bf16 a[32:35], v[224:227], a[192:195], 0
    v_mfma_f32_16x16x32_bf16 a[36:39], v[224:227], a[196:199], 0
    v_mfma_f32_16x16x32_bf16 a[40:43], v[240:243], a[192:195], 0
    s_xor_b32 s97, s99, 0x13400
    buffer_load_dwordx4 v[212:215], v0, s[56:59], s97 offen nt
    v_mfma_f32_16x16x32_bf16 a[44:47], v[240:243], a[196:199], 0
    v_accvgpr_read_b32 v10, a16
    v_accvgpr_read_b32 v11, a17
    v_mfma_f32_16x16x32_bf16 a[32:35], v[228:231], a[200:203], a[32:35]
    v_accvgpr_read_b32 v12, a18
    v_accvgpr_read_b32 v13, a19
    v_mfma_f32_16x16x32_bf16 a[36:39], v[228:231], a[204:207], a[36:39]
    v_accvgpr_read_b32 v14, a24
    v_accvgpr_read_b32 v15, a25
    v_mfma_f32_16x16x32_bf16 a[40:43], v[244:247], a[200:203], a[40:43]
    v_accvgpr_read_b32 v16, a26
    v_accvgpr_read_b32 v17, a27
    v_mfma_f32_16x16x32_bf16 a[44:47], v[244:247], a[204:207], a[44:47]
    v_accvgpr_read_b32 v18, a20
    v_accvgpr_read_b32 v19, a21
    v_mfma_f32_16x16x32_bf16 a[32:35], v[232:235], a[208:211], a[32:35]
    v_accvgpr_read_b32 v20, a22
    v_accvgpr_read_b32 v21, a23
    v_mfma_f32_16x16x32_bf16 a[36:39], v[232:235], a[212:215], a[36:39]
    v_accvgpr_read_b32 v22, a28
    v_accvgpr_read_b32 v23, a29
    v_mfma_f32_16x16x32_bf16 a[40:43], v[248:251], a[208:211], a[40:43]
    v_accvgpr_read_b32 v24, a30
    v_accvgpr_read_b32 v25, a31
    v_mfma_f32_16x16x32_bf16 a[44:47], v[248:251], a[212:215], a[44:47]
    v_max3_f32 v26, v26, v10, v11
    v_max3_f32 v26, v26, v12, v13
    v_mfma_f32_16x16x32_bf16 a[32:35], v[236:239], a[216:219], a[32:35]
    v_max3_f32 v26, v26, v14, v15
    v_max3_f32 v26, v26, v16, v17
    v_mfma_f32_16x16x32_bf16 a[36:39], v[236:239], a[220:223], a[36:39]
    v_max3_f32 v27, v27, v18, v19
    v_max3_f32 v27, v27, v20, v21
    v_mfma_f32_16x16x32_bf16 a[40:43], v[252:255], a[216:219], a[40:43]
    v_max3_f32 v27, v27, v22, v23
    v_max3_f32 v27, v27, v24, v25
    s_xor_b32 s97, s99, 0x13800
    buffer_load_dwordx4 v[216:219], v0, s[56:59], s97 offen nt
    v_mfma_f32_16x16x32_bf16 a[44:47], v[252:255], a[220:223], a[44:47]
    s_xor_b32 s97, s99, 0x13c00
    buffer_load_dwordx4 v[220:223], v0, s[56:59], s97 offen nt
    s_waitcnt vmcnt(16)
    ds_read_b128 v[32:35], v2 offset:24960
    ds_read_b128 v[36:39], v2 offset:24976
    ds_read_b128 v[40:43], v2 offset:24992
    ds_read_b128 v[44:47], v2 offset:25008
    ds_read_b128 v[48:51], v2 offset:29120
    ds_read_b128 v[52:55], v2 offset:29136
    ds_read_b128 v[56:59], v2 offset:29152
    ds_read_b128 v[60:63], v2 offset:29168
    s_waitcnt lgkmcnt(0)
    v_mfma_f32_16x16x32_bf16 a[48:51], v[32:35], a[192:195], 0
    v_mfma_f32_16x16x32_bf16 a[52:55], v[32:35], a[196:199], 0
    v_mfma_f32_16x16x32_bf16 a[56:59], v[48:51], a[192:195], 0
    v_mfma_f32_16x16x32_bf16 a[60:63], v[48:51], a[196:199], 0
    s_add_u32 m0, s98, 0x0
    s_xor_b32 s97, s99, 0x18000
    buffer_load_dwordx4 v1, s[52:55], s97 offen nt lds
    v_accvgpr_read_b32 v10, a32
    v_accvgpr_read_b32 v11, a33
    v_mfma_f32_16x16x32_bf16 a[48:51], v[36:39], a[200:203], a[48:51]
    v_accvgpr_read_b32 v12, a34
    v_accvgpr_read_b32 v13, a35
    v_mfma_f32_16x16x32_bf16 a[52:55], v[36:39], a[204:207], a[52:55]
    v_accvgpr_read_b32 v14, a40
    v_accvgpr_read_b32 v15, a41
    v_mfma_f32_16x16x32_bf16 a[56:59], v[52:55], a[200:203], a[56:59]
    v_accvgpr_read_b32 v16, a42
    v_accvgpr_read_b32 v17, a43
    v_mfma_f32_16x16x32_bf16 a[60:63], v[52:55], a[204:207], a[60:63]
    v_accvgpr_read_b32 v18, a36
    v_accvgpr_read_b32 v19, a37
    v_mfma_f32_16x16x32_bf16 a[48:51], v[40:43], a[208:211], a[48:51]
    v_accvgpr_read_b32 v20, a38
    v_accvgpr_read_b32 v21, a39
    v_mfma_f32_16x16x32_bf16 a[52:55], v[40:43], a[212:215], a[52:55]
    v_accvgpr_read_b32 v22, a44
    v_accvgpr_read_b32 v23, a45
    v_mfma_f32_16x16x32_bf16 a[56:59], v[56:59], a[208:211], a[56:59]
    v_accvgpr_read_b32 v24, a46
    v_accvgpr_read_b32 v25, a47
    v_mfma_f32_16x16x32_bf16 a[60:63], v[56:59], a[212:215], a[60:63]
    v_max3_f32 v26, v26, v10, v11
    v_max3_f32 v26, v26, v12, v13
    v_mfma_f32_16x16x32_bf16 a[48:51], v[44:47], a[216:219], a[48:51]
    v_max3_f32 v26, v26, v14, v15
    v_max3_f32 v26, v26, v16, v17
    v_mfma_f32_16x16x32_bf16 a[52:55], v[44:47], a[220:223], a[52:55]
    v_max3_f32 v27, v27, v18, v19
    v_max3_f32 v27, v27, v20, v21
    v_mfma_f32_16x16x32_bf16 a[56:59], v[60:63], a[216:219], a[56:59]
    v_max3_f32 v27, v27, v22, v23
    v_max3_f32 v27, v27, v24, v25
    v_mfma_f32_16x16x32_bf16 a[60:63], v[60:63], a[220:223], a[60:63]
    s_add_u32 m0, s98, 0x310
    s_xor_b32 s97, s99, 0x18000
    buffer_load_dwordx4 v1, s[52:55], s97 offen offset:256 nt lds
    s_add_u32 m0, s98, 0x620
    s_xor_b32 s97, s99, 0x18000
    buffer_load_dwordx4 v1, s[52:55], s97 offen offset:512 nt lds
    s_add_u32 m0, s98, 0x930
    s_xor_b32 s97, s99, 0x18000
    buffer_load_dwordx4 v1, s[52:55], s97 offen offset:768 nt lds
    s_add_u32 m0, s98, 0x1040
    s_xor_b32 s97, s99, 0x19000
    buffer_load_dwordx4 v1, s[52:55], s97 offen nt lds
    s_add_u32 m0, s98, 0x1350
    s_xor_b32 s97, s99, 0x19000
    buffer_load_dwordx4 v1, s[52:55], s97 offen offset:256 nt lds
    s_add_u32 m0, s98, 0x1660
    s_xor_b32 s97, s99, 0x19000
    buffer_load_dwordx4 v1, s[52:55], s97 offen offset:512 nt lds
    s_add_u32 m0, s98, 0x1970
    s_xor_b32 s97, s99, 0x19000
    buffer_load_dwordx4 v1, s[52:55], s97 offen offset:768 nt lds
    s_add_u32 m0, s98, 0x2080
    s_xor_b32 s97, s99, 0x1a000
    buffer_load_dwordx4 v1, s[52:55], s97 offen nt lds
    s_add_u32 m0, s98, 0x2390
    s_xor_b32 s97, s99, 0x1a000
    buffer_load_dwordx4 v1, s[52:55], s97 offen offset:256 nt lds
    s_add_u32 m0, s98, 0x26a0
    s_xor_b32 s97, s99, 0x1a000
    buffer_load_dwordx4 v1, s[52:55], s97 offen offset:512 nt lds
    s_add_u32 m0, s98, 0x29b0
    s_xor_b32 s97, s99, 0x1a000
    buffer_load_dwordx4 v1, s[52:55], s97 offen offset:768 nt lds
    s_add_u32 m0, s98, 0x30c0
    s_xor_b32 s97, s99, 0x1b000
    buffer_load_dwordx4 v1, s[52:55], s97 offen nt lds
    s_add_u32 m0, s98, 0x33d0
    s_xor_b32 s97, s99, 0x1b000
    buffer_load_dwordx4 v1, s[52:55], s97 offen offset:256 nt lds
    s_add_u32 m0, s98, 0x36e0
    s_xor_b32 s97, s99, 0x1b000
    buffer_load_dwordx4 v1, s[52:55], s97 offen offset:512 nt lds
    s_add_u32 m0, s98, 0x39f0
    s_xor_b32 s97, s99, 0x1b000
    buffer_load_dwordx4 v1, s[52:55], s97 offen offset:768 nt lds
    s_add_u32 m0, s98, 0x4100
    s_xor_b32 s97, s99, 0x1c000
    buffer_load_dwordx4 v1, s[52:55], s97 offen nt lds
    s_add_u32 m0, s98, 0x4410
    s_xor_b32 s97, s99, 0x1c000
    buffer_load_dwordx4 v1, s[52:55], s97 offen offset:256 nt lds
    s_add_u32 m0, s98, 0x4720
    s_xor_b32 s97, s99, 0x1c000
    buffer_load_dwordx4 v1, s[52:55], s97 offen offset:512 nt lds
    s_add_u32 m0, s98, 0x4a30
    s_xor_b32 s97, s99, 0x1c000
    buffer_load_dwordx4 v1, s[52:55], s97 offen offset:768 nt lds
    s_add_u32 m0, s98, 0x5140
    s_xor_b32 s97, s99, 0x1d000
    buffer_load_dwordx4 v1, s[52:55], s97 offen nt lds
    s_add_u32 m0, s98, 0x5450
    s_xor_b32 s97, s99, 0x1d000
    buffer_load_dwordx4 v1, s[52:55], s97 offen offset:256 nt lds
    s_add_u32 m0, s98, 0x5760
    s_xor_b32 s97, s99, 0x1d000
    buffer_load_dwordx4 v1, s[52:55], s97 offen offset:512 nt lds
    s_add_u32 m0, s98, 0x5a70
    s_xor_b32 s97, s99, 0x1d000
    buffer_load_dwordx4 v1, s[52:55], s97 offen offset:768 nt lds
    s_waitcnt vmcnt(16)
    ds_read_b128 v[224:227], v2
    ds_read_b128 v[228:231], v2 offset:16
    ds_read_b128 v[232:235], v2 offset:32
    ds_read_b128 v[236:239], v2 offset:48
    ds_read_b128 v[240:243], v2 offset:4160
    ds_read_b128 v[244:247], v2 offset:4176
    ds_read_b128 v[248:251], v2 offset:4192
    ds_read_b128 v[252:255], v2 offset:4208
    s_waitcnt lgkmcnt(0)
    v_mfma_f32_16x16x32_bf16 a[64:67], v[224:227], a[192:195], 0
    v_mfma_f32_16x16x32_bf16 a[68:71], v[224:227], a[196:199], 0
    v_mfma_f32_16x16x32_bf16 a[72:75], v[240:243], a[192:195], 0
    v_mfma_f32_16x16x32_bf16 a[76:79], v[240:243], a[196:199], 0
    s_add_u32 m0, s98, 0x6180
    s_xor_b32 s97, s99, 0x1e000
    buffer_load_dwordx4 v1, s[52:55], s97 offen nt lds
    v_accvgpr_read_b32 v10, a48
    v_accvgpr_read_b32 v11, a49
    v_mfma_f32_16x16x32_bf16 a[64:67], v[228:231], a[200:203], a[64:67]
    v_accvgpr_read_b32 v12, a50
    v_accvgpr_read_b32 v13, a51
    v_mfma_f32_16x16x32_bf16 a[68:71], v[228:231], a[204:207], a[68:71]
    v_accvgpr_read_b32 v14, a56
    v_accvgpr_read_b32 v15, a57
    v_mfma_f32_16x16x32_bf16 a[72:75], v[244:247], a[200:203], a[72:75]
    v_accvgpr_read_b32 v16, a58
    v_accvgpr_read_b32 v17, a59
    v_mfma_f32_16x16x32_bf16 a[76:79], v[244:247], a[204:207], a[76:79]
    v_accvgpr_read_b32 v18, a52
    v_accvgpr_read_b32 v19, a53
    v_mfma_f32_16x16x32_bf16 a[64:67], v[232:235], a[208:211], a[64:67]
    v_accvgpr_read_b32 v20, a54
    v_accvgpr_read_b32 v21, a55
    v_mfma_f32_16x16x32_bf16 a[68:71], v[232:235], a[212:215], a[68:71]
    v_accvgpr_read_b32 v22, a60
    v_accvgpr_read_b32 v23, a61
    v_mfma_f32_16x16x32_bf16 a[72:75], v[248:251], a[208:211], a[72:75]
    v_accvgpr_read_b32 v24, a62
    v_accvgpr_read_b32 v25, a63
    v_mfma_f32_16x16x32_bf16 a[76:79], v[248:251], a[212:215], a[76:79]
    v_max3_f32 v26, v26, v10, v11
    v_max3_f32 v26, v26, v12, v13
    v_mfma_f32_16x16x32_bf16 a[64:67], v[236:239], a[216:219], a[64:67]
    v_max3_f32 v26, v26, v14, v15
    v_max3_f32 v26, v26, v16, v17
    v_mfma_f32_16x16x32_bf16 a[68:71], v[236:239], a[220:223], a[68:71]
    v_max3_f32 v27, v27, v18, v19
    v_max3_f32 v27, v27, v20, v21
    v_mfma_f32_16x16x32_bf16 a[72:75], v[252:255], a[216:219], a[72:75]
    v_max3_f32 v27, v27, v22, v23
    v_max3_f32 v27, v27, v24, v25
    v_mfma_f32_16x16x32_bf16 a[76:79], v[252:255], a[220:223], a[76:79]
    s_add_u32 m0, s98, 0x6490
    s_xor_b32 s97, s99, 0x1e000
    buffer_load_dwordx4 v1, s[52:55], s97 offen offset:256 nt lds
    s_add_u32 m0, s98, 0x67a0
    s_xor_b32 s97, s99, 0x1e000
    buffer_load_dwordx4 v1, s[52:55], s97 offen offset:512 nt lds
    s_add_u32 m0, s98, 0x6ab0
    s_xor_b32 s97, s99, 0x1e000
    buffer_load_dwordx4 v1, s[52:55], s97 offen offset:768 nt lds
    s_add_u32 m0, s98, 0x71c0
    s_xor_b32 s97, s99, 0x1f000
    buffer_load_dwordx4 v1, s[52:55], s97 offen nt lds
    s_add_u32 m0, s98, 0x74d0
    s_xor_b32 s97, s99, 0x1f000
    buffer_load_dwordx4 v1, s[52:55], s97 offen offset:256 nt lds
    s_add_u32 m0, s98, 0x77e0
    s_xor_b32 s97, s99, 0x1f000
    buffer_load_dwordx4 v1, s[52:55], s97 offen offset:512 nt lds
    s_add_u32 m0, s98, 0x7af0
    s_xor_b32 s97, s99, 0x1f000
    buffer_load_dwordx4 v1, s[52:55], s97 offen offset:768 nt lds
    s_waitcnt vmcnt(16)
    ds_read_b128 v[32:35], v2 offset:8320
    ds_read_b128 v[36:39], v2 offset:8336
    ds_read_b128 v[40:43], v2 offset:8352
    ds_read_b128 v[44:47], v2 offset:8368
    ds_read_b128 v[48:51], v2 offset:12480
    ds_read_b128 v[52:55], v2 offset:12496
    ds_read_b128 v[56:59], v2 offset:12512
    ds_read_b128 v[60:63], v2 offset:12528
    s_waitcnt lgkmcnt(0)
    v_mfma_f32_16x16x32_bf16 a[80:83], v[32:35], a[192:195], 0
    v_mfma_f32_16x16x32_bf16 a[84:87], v[32:35], a[196:199], 0
    v_mfma_f32_16x16x32_bf16 a[88:91], v[48:51], a[192:195], 0
    v_mfma_f32_16x16x32_bf16 a[92:95], v[48:51], a[196:199], 0
    s_xor_b32 s97, s99, 0x14000
    buffer_load_dwordx4 v[64:67], v0, s[56:59], s97 offen nt
    v_accvgpr_read_b32 v10, a64
    v_accvgpr_read_b32 v11, a65
    v_mfma_f32_16x16x32_bf16 a[80:83], v[36:39], a[200:203], a[80:83]
    v_accvgpr_read_b32 v12, a66
    v_accvgpr_read_b32 v13, a67
    v_mfma_f32_16x16x32_bf16 a[84:87], v[36:39], a[204:207], a[84:87]
    v_accvgpr_read_b32 v14, a72
    v_accvgpr_read_b32 v15, a73
    v_mfma_f32_16x16x32_bf16 a[88:91], v[52:55], a[200:203], a[88:91]
    v_accvgpr_read_b32 v16, a74
    v_accvgpr_read_b32 v17, a75
    v_mfma_f32_16x16x32_bf16 a[92:95], v[52:55], a[204:207], a[92:95]
    v_accvgpr_read_b32 v18, a68
    v_accvgpr_read_b32 v19, a69
    v_mfma_f32_16x16x32_bf16 a[80:83], v[40:43], a[208:211], a[80:83]
    v_accvgpr_read_b32 v20, a70
    v_accvgpr_read_b32 v21, a71
    v_mfma_f32_16x16x32_bf16 a[84:87], v[40:43], a[212:215], a[84:87]
    v_accvgpr_read_b32 v22, a76
    v_accvgpr_read_b32 v23, a77
    v_mfma_f32_16x16x32_bf16 a[88:91], v[56:59], a[208:211], a[88:91]
    v_accvgpr_read_b32 v24, a78
    v_accvgpr_read_b32 v25, a79
    v_mfma_f32_16x16x32_bf16 a[92:95], v[56:59], a[212:215], a[92:95]
    v_max3_f32 v26, v26, v10, v11
    v_max3_f32 v26, v26, v12, v13
    v_mfma_f32_16x16x32_bf16 a[80:83], v[44:47], a[216:219], a[80:83]
    v_max3_f32 v26, v26, v14, v15
    v_max3_f32 v26, v26, v16, v17
    v_mfma_f32_16x16x32_bf16 a[84:87], v[44:47], a[220:223], a[84:87]
    v_max3_f32 v27, v27, v18, v19
    v_max3_f32 v27, v27, v20, v21
    v_mfma_f32_16x16x32_bf16 a[88:91], v[60:63], a[216:219], a[88:91]
    v_max3_f32 v27, v27, v22, v23
    v_max3_f32 v27, v27, v24, v25
    v_mfma_f32_16x16x32_bf16 a[92:95], v[60:63], a[220:223], a[92:95]
    s_xor_b32 s97, s99, 0x14400
    buffer_load_dwordx4 v[68:71], v0, s[56:59], s97 offen nt
    s_xor_b32 s97, s99, 0x14800
    buffer_load_dwordx4 v[72:75], v0, s[56:59], s97 offen nt
    s_xor_b32 s97, s99, 0x14c00
    buffer_load_dwordx4 v[76:79], v0, s[56:59], s97 offen nt
    s_xor_b32 s97, s99, 0x15000
    buffer_load_dwordx4 v[80:83], v0, s[56:59], s97 offen nt
    s_xor_b32 s97, s99, 0x15400
    buffer_load_dwordx4 v[84:87], v0, s[56:59], s97 offen nt
    s_xor_b32 s97, s99, 0x15800
    buffer_load_dwordx4 v[88:91], v0, s[56:59], s97 offen nt
    s_xor_b32 s97, s99, 0x15c00
    buffer_load_dwordx4 v[92:95], v0, s[56:59], s97 offen nt
    s_waitcnt vmcnt(16)
    ds_read_b128 v[224:227], v2 offset:16640
    ds_read_b128 v[228:231], v2 offset:16656
    ds_read_b128 v[232:235], v2 offset:16672
    ds_read_b128 v[236:239], v2 offset:16688
    ds_read_b128 v[240:243], v2 offset:20800
    ds_read_b128 v[244:247], v2 offset:20816
    ds_read_b128 v[248:251], v2 offset:20832
    ds_read_b128 v[252:255], v2 offset:20848
    s_waitcnt lgkmcnt(0)
    v_mfma_f32_16x16x32_bf16 a[96:99], v[224:227], a[192:195], 0
    v_mfma_f32_16x16x32_bf16 a[100:103], v[224:227], a[196:199], 0
    v_mfma_f32_16x16x32_bf16 a[104:107], v[240:243], a[192:195], 0
    v_mfma_f32_16x16x32_bf16 a[108:111], v[240:243], a[196:199], 0
    s_xor_b32 s97, s99, 0x16000
    buffer_load_dwordx4 v[96:99], v0, s[56:59], s97 offen nt
    v_accvgpr_read_b32 v10, a80
    v_accvgpr_read_b32 v11, a81
    v_mfma_f32_16x16x32_bf16 a[96:99], v[228:231], a[200:203], a[96:99]
    v_accvgpr_read_b32 v12, a82
    v_accvgpr_read_b32 v13, a83
    v_mfma_f32_16x16x32_bf16 a[100:103], v[228:231], a[204:207], a[100:103]
    v_accvgpr_read_b32 v14, a88
    v_accvgpr_read_b32 v15, a89
    v_mfma_f32_16x16x32_bf16 a[104:107], v[244:247], a[200:203], a[104:107]
    v_accvgpr_read_b32 v16, a90
    v_accvgpr_read_b32 v17, a91
    v_mfma_f32_16x16x32_bf16 a[108:111], v[244:247], a[204:207], a[108:111]
    v_accvgpr_read_b32 v18, a84
    v_accvgpr_read_b32 v19, a85
    v_mfma_f32_16x16x32_bf16 a[96:99], v[232:235], a[208:211], a[96:99]
    v_accvgpr_read_b32 v20, a86
    v_accvgpr_read_b32 v21, a87
    v_mfma_f32_16x16x32_bf16 a[100:103], v[232:235], a[212:215], a[100:103]
    v_accvgpr_read_b32 v22, a92
    v_accvgpr_read_b32 v23, a93
    v_mfma_f32_16x16x32_bf16 a[104:107], v[248:251], a[208:211], a[104:107]
    v_accvgpr_read_b32 v24, a94
    v_accvgpr_read_b32 v25, a95
    v_mfma_f32_16x16x32_bf16 a[108:111], v[248:251], a[212:215], a[108:111]
    v_max3_f32 v26, v26, v10, v11
    v_max3_f32 v26, v26, v12, v13
    v_mfma_f32_16x16x32_bf16 a[96:99], v[236:239], a[216:219], a[96:99]
    v_max3_f32 v26, v26, v14, v15
    v_max3_f32 v26, v26, v16, v17
    v_mfma_f32_16x16x32_bf16 a[100:103], v[236:239], a[220:223], a[100:103]
    v_max3_f32 v27, v27, v18, v19
    v_max3_f32 v27, v27, v20, v21
    v_mfma_f32_16x16x32_bf16 a[104:107], v[252:255], a[216:219], a[104:107]
    v_max3_f32 v27, v27, v22, v23
    v_max3_f32 v27, v27, v24, v25
    v_mfma_f32_16x16x32_bf16 a[108:111], v[252:255], a[220:223], a[108:111]
    s_xor_b32 s97, s99, 0x16400
    buffer_load_dwordx4 v[100:103], v0, s[56:59], s97 offen nt
    s_xor_b32 s97, s99, 0x16800
    buffer_load_dwordx4 v[104:107], v0, s[56:59], s97 offen nt
    s_xor_b32 s97, s99, 0x16c00
    buffer_load_dwordx4 v[108:111], v0, s[56:59], s97 offen nt
    s_xor_b32 s97, s99, 0x17000
    buffer_load_dwordx4 v[112:115], v0, s[56:59], s97 offen nt
    s_xor_b32 s97, s99, 0x17400
    buffer_load_dwordx4 v[116:119], v0, s[56:59], s97 offen nt
    s_xor_b32 s97, s99, 0x17800
    buffer_load_dwordx4 v[120:123], v0, s[56:59], s97 offen nt
    s_xor_b32 s97, s99, 0x17c00
    buffer_load_dwordx4 v[124:127], v0, s[56:59], s97 offen nt
    s_waitcnt vmcnt(16)
    ds_read_b128 v[32:35], v2 offset:24960
    ds_read_b128 v[36:39], v2 offset:24976
    ds_read_b128 v[40:43], v2 offset:24992
    ds_read_b128 v[44:47], v2 offset:25008
    ds_read_b128 v[48:51], v2 offset:29120
    ds_read_b128 v[52:55], v2 offset:29136
    ds_read_b128 v[56:59], v2 offset:29152
    ds_read_b128 v[60:63], v2 offset:29168
    s_waitcnt lgkmcnt(0)
    v_mfma_f32_16x16x32_bf16 a[112:115], v[32:35], a[192:195], 0
    v_mfma_f32_16x16x32_bf16 a[116:119], v[32:35], a[196:199], 0
    v_mfma_f32_16x16x32_bf16 a[120:123], v[48:51], a[192:195], 0
    v_mfma_f32_16x16x32_bf16 a[124:127], v[48:51], a[196:199], 0
    s_xor_b32 s97, s99, 0x18000
    buffer_load_dwordx4 v[128:131], v0, s[56:59], s97 offen nt
    v_accvgpr_read_b32 v10, a96
    v_accvgpr_read_b32 v11, a97
    v_mfma_f32_16x16x32_bf16 a[112:115], v[36:39], a[200:203], a[112:115]
    v_accvgpr_read_b32 v12, a98
    v_accvgpr_read_b32 v13, a99
    v_mfma_f32_16x16x32_bf16 a[116:119], v[36:39], a[204:207], a[116:119]
    v_accvgpr_read_b32 v14, a104
    v_accvgpr_read_b32 v15, a105
    v_mfma_f32_16x16x32_bf16 a[120:123], v[52:55], a[200:203], a[120:123]
    v_accvgpr_read_b32 v16, a106
    v_accvgpr_read_b32 v17, a107
    v_mfma_f32_16x16x32_bf16 a[124:127], v[52:55], a[204:207], a[124:127]
    v_accvgpr_read_b32 v18, a100
    v_accvgpr_read_b32 v19, a101
    v_mfma_f32_16x16x32_bf16 a[112:115], v[40:43], a[208:211], a[112:115]
    v_accvgpr_read_b32 v20, a102
    v_accvgpr_read_b32 v21, a103
    v_mfma_f32_16x16x32_bf16 a[116:119], v[40:43], a[212:215], a[116:119]
    v_accvgpr_read_b32 v22, a108
    v_accvgpr_read_b32 v23, a109
    v_mfma_f32_16x16x32_bf16 a[120:123], v[56:59], a[208:211], a[120:123]
    v_accvgpr_read_b32 v24, a110
    v_accvgpr_read_b32 v25, a111
    v_mfma_f32_16x16x32_bf16 a[124:127], v[56:59], a[212:215], a[124:127]
    v_max3_f32 v26, v26, v10, v11
    v_max3_f32 v26, v26, v12, v13
    v_mfma_f32_16x16x32_bf16 a[112:115], v[44:47], a[216:219], a[112:115]
    v_max3_f32 v26, v26, v14, v15
    v_max3_f32 v26, v26, v16, v17
    v_mfma_f32_16x16x32_bf16 a[116:119], v[44:47], a[220:223], a[116:119]
    v_max3_f32 v27, v27, v18, v19
    v_max3_f32 v27, v27, v20, v21
    v_mfma_f32_16x16x32_bf16 a[120:123], v[60:63], a[216:219], a[120:123]
    v_max3_f32 v27, v27, v22, v23
    v_max3_f32 v27, v27, v24, v25
    v_mfma_f32_16x16x32_bf16 a[124:127], v[60:63], a[220:223], a[124:127]
    v_accvgpr_read_b32 v10, a112
    s_xor_b32 s97, s99, 0x18400
    buffer_load_dwordx4 v[132:135], v0, s[56:59], s97 offen nt
    v_accvgpr_read_b32 v11, a113
    v_accvgpr_read_b32 v12, a114
    v_accvgpr_read_b32 v13, a115
    v_accvgpr_read_b32 v14, a120
    v_accvgpr_read_b32 v15, a121
    v_accvgpr_read_b32 v16, a122
    v_accvgpr_read_b32 v17, a123
    v_accvgpr_read_b32 v18, a116
    v_accvgpr_read_b32 v19, a117
    v_accvgpr_read_b32 v20, a118
    v_accvgpr_read_b32 v21, a119
    v_accvgpr_read_b32 v22, a124
    v_accvgpr_read_b32 v23, a125
    v_accvgpr_read_b32 v24, a126
    v_accvgpr_read_b32 v25, a127
    v_max3_f32 v26, v26, v10, v11
    v_max3_f32 v26, v26, v12, v13
    v_max3_f32 v26, v26, v14, v15
    v_max3_f32 v26, v26, v16, v17
    v_max3_f32 v27, v27, v18, v19
    v_max3_f32 v27, v27, v20, v21
    v_max3_f32 v27, v27, v22, v23
    v_max3_f32 v27, v27, v24, v25
    v_mov_b32 v10, v26
    s_nop 1
    v_permlane32_swap_b32 v26, v10
    v_max_f32 v26, v26, v10
    v_mov_b32 v10, v26
    s_nop 1
    v_permlane16_swap_b32 v26, v10
    v_max_f32 v26, v26, v10
    v_mul_f32 v26, s96, v26
    v_accvgpr_read_b32 v12, a224
    v_max_f32 v26, v26, v12
    v_sub_f32 v14, v12, v26
    v_exp_f32 v14, v14
    v_mov_b32 v10, v27
    s_nop 1
    v_permlane32_swap_b32 v27, v10
    v_max_f32 v27, v27, v10
    v_mov_b32 v10, v27
    s_nop 1
    v_permlane16_swap_b32 v27, v10
    s_xor_b32 s97, s99, 0x18800
    buffer_load_dwordx4 v[136:139], v0, s[56:59], s97 offen nt
    v_max_f32 v27, v27, v10
    v_mul_f32 v27, s96, v27
    v_accvgpr_read_b32 v12, a225
    v_max_f32 v27, v27, v12
    v_sub_f32 v15, v12, v27
    v_exp_f32 v15, v15
    v_mul_f32 v28, v28, v14
    v_mul_f32 v29, v29, v15
    v_accvgpr_read_b32 v18, a128
    v_accvgpr_read_b32 v19, a129
    v_accvgpr_read_b32 v20, a130
    v_accvgpr_read_b32 v21, a131
    v_accvgpr_read_b32 v22, a132
    v_accvgpr_read_b32 v23, a133
    v_accvgpr_read_b32 v24, a134
    v_accvgpr_read_b32 v25, a135
    v_mul_f32 v18, v18, v14
    v_mul_f32 v19, v19, v14
    v_mul_f32 v20, v20, v14
    v_mul_f32 v21, v21, v14
    v_mul_f32 v22, v22, v15
    v_mul_f32 v23, v23, v15
    v_mul_f32 v24, v24, v15
    v_mul_f32 v25, v25, v15
    v_accvgpr_write_b32 a128, v18
    v_accvgpr_write_b32 a129, v19
    v_accvgpr_write_b32 a130, v20
    v_accvgpr_write_b32 a131, v21
    v_accvgpr_write_b32 a132, v22
    v_accvgpr_write_b32 a133, v23
    v_accvgpr_write_b32 a134, v24
    v_accvgpr_write_b32 a135, v25
    v_accvgpr_read_b32 v18, a136
    v_accvgpr_read_b32 v19, a137
    v_accvgpr_read_b32 v20, a138
    v_accvgpr_read_b32 v21, a139
    v_accvgpr_read_b32 v22, a140
    v_accvgpr_read_b32 v23, a141
    v_accvgpr_read_b32 v24, a142
    v_accvgpr_read_b32 v25, a143
    v_mul_f32 v18, v18, v14
    v_mul_f32 v19, v19, v14
    v_mul_f32 v20, v20, v14
    v_mul_f32 v21, v21, v14
    v_mul_f32 v22, v22, v15
    v_mul_f32 v23, v23, v15
    v_mul_f32 v24, v24, v15
    s_xor_b32 s97, s99, 0x18c00
    buffer_load_dwordx4 v[140:143], v0, s[56:59], s97 offen nt
    v_mul_f32 v25, v25, v15
    v_accvgpr_write_b32 a136, v18
    v_accvgpr_write_b32 a137, v19
    v_accvgpr_write_b32 a138, v20
    v_accvgpr_write_b32 a139, v21
    v_accvgpr_write_b32 a140, v22
    v_accvgpr_write_b32 a141, v23
    v_accvgpr_write_b32 a142, v24
    v_accvgpr_write_b32 a143, v25
    v_accvgpr_read_b32 v18, a144
    v_accvgpr_read_b32 v19, a145
    v_accvgpr_read_b32 v20, a146
    v_accvgpr_read_b32 v21, a147
    v_accvgpr_read_b32 v22, a148
    v_accvgpr_read_b32 v23, a149
    v_accvgpr_read_b32 v24, a150
    v_accvgpr_read_b32 v25, a151
    v_mul_f32 v18, v18, v14
    v_mul_f32 v19, v19, v14
    v_mul_f32 v20, v20, v14
    v_mul_f32 v21, v21, v14
    v_mul_f32 v22, v22, v15
    v_mul_f32 v23, v23, v15
    v_mul_f32 v24, v24, v15
    v_mul_f32 v25, v25, v15
    v_accvgpr_write_b32 a144, v18
    v_accvgpr_write_b32 a145, v19
    v_accvgpr_write_b32 a146, v20
    v_accvgpr_write_b32 a147, v21
    v_accvgpr_write_b32 a148, v22
    v_accvgpr_write_b32 a149, v23
    v_accvgpr_write_b32 a150, v24
    v_accvgpr_write_b32 a151, v25
    v_accvgpr_read_b32 v18, a152
    v_accvgpr_read_b32 v19, a153
    v_accvgpr_read_b32 v20, a154
    v_accvgpr_read_b32 v21, a155
    v_accvgpr_read_b32 v22, a156
    v_accvgpr_read_b32 v23, a157
    v_accvgpr_read_b32 v24, a158
    v_accvgpr_read_b32 v25, a159
    v_mul_f32 v18, v18, v14
    v_mul_f32 v19, v19, v14
    v_mul_f32 v20, v20, v14
    v_mul_f32 v21, v21, v14
    v_mul_f32 v22, v22, v15
    v_mul_f32 v23, v23, v15
    v_mul_f32 v24, v24, v15
    s_xor_b32 s97, s99, 0x19000
    buffer_load_dwordx4 v[144:147], v0, s[56:59], s97 offen nt
    v_mul_f32 v25, v25, v15
    v_accvgpr_write_b32 a152, v18
    v_accvgpr_write_b32 a153, v19
    v_accvgpr_write_b32 a154, v20
    v_accvgpr_write_b32 a155, v21
    v_accvgpr_write_b32 a156, v22
    v_accvgpr_write_b32 a157, v23
    v_accvgpr_write_b32 a158, v24
    v_accvgpr_write_b32 a159, v25
    v_accvgpr_read_b32 v18, a160
    v_accvgpr_read_b32 v19, a161
    v_accvgpr_read_b32 v20, a162
    v_accvgpr_read_b32 v21, a163
    v_accvgpr_read_b32 v22, a164
    v_accvgpr_read_b32 v23, a165
    v_accvgpr_read_b32 v24, a166
    v_accvgpr_read_b32 v25, a167
    v_mul_f32 v18, v18, v14
    v_mul_f32 v19, v19, v14
    v_mul_f32 v20, v20, v14
    v_mul_f32 v21, v21, v14
    v_mul_f32 v22, v22, v15
    v_mul_f32 v23, v23, v15
    v_mul_f32 v24, v24, v15
    v_mul_f32 v25, v25, v15
    v_accvgpr_write_b32 a160, v18
    v_accvgpr_write_b32 a161, v19
    v_accvgpr_write_b32 a162, v20
    v_accvgpr_write_b32 a163, v21
    v_accvgpr_write_b32 a164, v22
    v_accvgpr_write_b32 a165, v23
    v_accvgpr_write_b32 a166, v24
    v_accvgpr_write_b32 a167, v25
    v_accvgpr_read_b32 v18, a168
    v_accvgpr_read_b32 v19, a169
    v_accvgpr_read_b32 v20, a170
    v_accvgpr_read_b32 v21, a171
    v_accvgpr_read_b32 v22, a172
    v_accvgpr_read_b32 v23, a173
    v_accvgpr_read_b32 v24, a174
    v_accvgpr_read_b32 v25, a175
    v_mul_f32 v18, v18, v14
    v_mul_f32 v19, v19, v14
    v_mul_f32 v20, v20, v14
    v_mul_f32 v21, v21, v14
    v_mul_f32 v22, v22, v15
    v_mul_f32 v23, v23, v15
    v_mul_f32 v24, v24, v15
    s_xor_b32 s97, s99, 0x19400
    buffer_load_dwordx4 v[148:151], v0, s[56:59], s97 offen nt
    v_mul_f32 v25, v25, v15
    v_accvgpr_write_b32 a168, v18
    v_accvgpr_write_b32 a169, v19
    v_accvgpr_write_b32 a170, v20
    v_accvgpr_write_b32 a171, v21
    v_accvgpr_write_b32 a172, v22
    v_accvgpr_write_b32 a173, v23
    v_accvgpr_write_b32 a174, v24
    v_accvgpr_write_b32 a175, v25
    v_accvgpr_read_b32 v18, a176
    v_accvgpr_read_b32 v19, a177
    v_accvgpr_read_b32 v20, a178
    v_accvgpr_read_b32 v21, a179
    v_accvgpr_read_b32 v22, a180
    v_accvgpr_read_b32 v23, a181
    v_accvgpr_read_b32 v24, a182
    v_accvgpr_read_b32 v25, a183
    v_mul_f32 v18, v18, v14
    v_mul_f32 v19, v19, v14
    v_mul_f32 v20, v20, v14
    v_mul_f32 v21, v21, v14
    v_mul_f32 v22, v22, v15
    v_mul_f32 v23, v23, v15
    v_mul_f32 v24, v24, v15
    v_mul_f32 v25, v25, v15
    v_accvgpr_write_b32 a176, v18
    v_accvgpr_write_b32 a177, v19
    v_accvgpr_write_b32 a178, v20
    v_accvgpr_write_b32 a179, v21
    v_accvgpr_write_b32 a180, v22
    v_accvgpr_write_b32 a181, v23
    v_accvgpr_write_b32 a182, v24
    v_accvgpr_write_b32 a183, v25
    v_accvgpr_read_b32 v18, a184
    v_accvgpr_read_b32 v19, a185
    v_accvgpr_read_b32 v20, a186
    v_accvgpr_read_b32 v21, a187
    v_accvgpr_read_b32 v22, a188
    v_accvgpr_read_b32 v23, a189
    v_accvgpr_read_b32 v24, a190
    v_accvgpr_read_b32 v25, a191
    v_mul_f32 v18, v18, v14
    v_mul_f32 v19, v19, v14
    v_mul_f32 v20, v20, v14
    v_mul_f32 v21, v21, v14
    v_mul_f32 v22, v22, v15
    v_mul_f32 v23, v23, v15
    v_mul_f32 v24, v24, v15
    s_xor_b32 s97, s99, 0x19800
    buffer_load_dwordx4 v[152:155], v0, s[56:59], s97 offen nt
    v_mul_f32 v25, v25, v15
    v_accvgpr_write_b32 a184, v18
    v_accvgpr_write_b32 a185, v19
    v_accvgpr_write_b32 a186, v20
    v_accvgpr_write_b32 a187, v21
    v_accvgpr_write_b32 a188, v22
    v_accvgpr_write_b32 a189, v23
    v_accvgpr_write_b32 a190, v24
    v_accvgpr_write_b32 a191, v25
    buffer_load_dword v30, v9, s[72:75], 0 offen sc1
    v_accvgpr_read_b32 v10, a0
    v_accvgpr_read_b32 v11, a1
    v_accvgpr_read_b32 v12, a2
    v_accvgpr_read_b32 v13, a3
    v_accvgpr_read_b32 v14, a8
    v_accvgpr_read_b32 v15, a9
    v_accvgpr_read_b32 v16, a10
    v_accvgpr_read_b32 v17, a11
    v_accvgpr_read_b32 v18, a4
    v_accvgpr_read_b32 v19, a5
    v_accvgpr_read_b32 v20, a6
    v_accvgpr_read_b32 v21, a7
    v_accvgpr_read_b32 v22, a12
    v_accvgpr_read_b32 v23, a13
    v_accvgpr_read_b32 v24, a14
    v_accvgpr_read_b32 v25, a15
    v_fma_f32 v10, v10, s96, -v26
    v_fma_f32 v11, v11, s96, -v26
    v_fma_f32 v12, v12, s96, -v26
    v_fma_f32 v13, v13, s96, -v26
    v_fma_f32 v14, v14, s96, -v26
    v_fma_f32 v15, v15, s96, -v26
    v_fma_f32 v16, v16, s96, -v26
    v_fma_f32 v17, v17, s96, -v26
    v_fma_f32 v18, v18, s96, -v27
    v_fma_f32 v19, v19, s96, -v27
    v_fma_f32 v20, v20, s96, -v27
    v_fma_f32 v21, v21, s96, -v27
    v_fma_f32 v22, v22, s96, -v27
    v_fma_f32 v23, v23, s96, -v27
    v_fma_f32 v24, v24, s96, -v27
    v_fma_f32 v25, v25, s96, -v27
    v_exp_f32 v10, v10
    v_exp_f32 v11, v11
    v_exp_f32 v12, v12
    s_xor_b32 s97, s99, 0x19c00
    buffer_load_dwordx4 v[156:159], v0, s[56:59], s97 offen nt
    v_exp_f32 v13, v13
    v_exp_f32 v14, v14
    v_exp_f32 v15, v15
    v_exp_f32 v16, v16
    v_exp_f32 v17, v17
    v_exp_f32 v18, v18
    v_exp_f32 v19, v19
    v_exp_f32 v20, v20
    v_exp_f32 v21, v21
    v_exp_f32 v22, v22
    v_exp_f32 v23, v23
    v_exp_f32 v24, v24
    v_exp_f32 v25, v25
    v_add_f32 v28, v28, v10
    v_add_f32 v28, v28, v11
    v_add_f32 v28, v28, v12
    v_add_f32 v28, v28, v13
    v_add_f32 v28, v28, v14
    v_add_f32 v28, v28, v15
    v_add_f32 v28, v28, v16
    v_add_f32 v28, v28, v17
    v_add_f32 v29, v29, v18
    v_add_f32 v29, v29, v19
    v_add_f32 v29, v29, v20
    v_add_f32 v29, v29, v21
    v_add_f32 v29, v29, v22
    v_add_f32 v29, v29, v23
    v_add_f32 v29, v29, v24
    v_add_f32 v29, v29, v25
    v_cvt_pk_bf16_f32 v10, v10, v11
    v_cvt_pk_bf16_f32 v12, v12, v13
    v_cvt_pk_bf16_f32 v14, v14, v15
    v_cvt_pk_bf16_f32 v16, v16, v17
    v_cvt_pk_bf16_f32 v18, v18, v19
    v_cvt_pk_bf16_f32 v20, v20, v21
    v_cvt_pk_bf16_f32 v22, v22, v23
    v_cvt_pk_bf16_f32 v24, v24, v25
    v_accvgpr_write_b32 a0, v10
    v_accvgpr_write_b32 a1, v12
    v_accvgpr_write_b32 a2, v14
    v_accvgpr_write_b32 a3, v16
    v_accvgpr_write_b32 a4, v18
    v_accvgpr_write_b32 a5, v20
    v_accvgpr_write_b32 a6, v22
    v_accvgpr_write_b32 a7, v24
    v_perm_b32 v32, v164, v160, s38
    v_perm_b32 v33, v172, v168, s38
    v_perm_b32 v34, v180, v176, s38
    v_perm_b32 v35, v188, v184, s38
    v_perm_b32 v36, v164, v160, s39
    v_perm_b32 v37, v172, v168, s39
    v_mfma_f32_16x16x32_bf16 a[128:131], v[32:35], a[0:3], a[128:131]
    v_perm_b32 v38, v180, v176, s39
    v_perm_b32 v39, v188, v184, s39
    v_accvgpr_read_b32 v10, a16
    v_accvgpr_read_b32 v11, a17
    v_accvgpr_read_b32 v12, a18
    v_accvgpr_read_b32 v13, a19
    v_accvgpr_read_b32 v14, a24
    v_mfma_f32_16x16x32_bf16 a[132:135], v[32:35], a[4:7], a[132:135]
    v_perm_b32 v40, v165, v161, s38
    v_perm_b32 v41, v173, v169, s38
    v_accvgpr_read_b32 v15, a25
    v_accvgpr_read_b32 v16, a26
    v_accvgpr_read_b32 v17, a27
    v_accvgpr_read_b32 v18, a20
    v_accvgpr_read_b32 v19, a21
    v_mfma_f32_16x16x32_bf16 a[136:139], v[36:39], a[0:3], a[136:139]
    v_perm_b32 v42, v181, v177, s38
    v_perm_b32 v43, v189, v185, s38
    v_accvgpr_read_b32 v20, a22
    v_accvgpr_read_b32 v21, a23
    v_accvgpr_read_b32 v22, a28
    v_accvgpr_read_b32 v23, a29
    v_accvgpr_read_b32 v24, a30
    v_mfma_f32_16x16x32_bf16 a[140:143], v[36:39], a[4:7], a[140:143]
    v_perm_b32 v44, v165, v161, s39
    v_perm_b32 v45, v173, v169, s39
    v_accvgpr_read_b32 v25, a31
    v_fma_f32 v10, v10, s96, -v26
    v_fma_f32 v11, v11, s96, -v26
    v_fma_f32 v12, v12, s96, -v26
    v_fma_f32 v13, v13, s96, -v26
    v_mfma_f32_16x16x32_bf16 a[144:147], v[40:43], a[0:3], a[144:147]
    v_perm_b32 v46, v181, v177, s39
    v_perm_b32 v47, v189, v185, s39
    v_fma_f32 v14, v14, s96, -v26
    v_fma_f32 v15, v15, s96, -v26
    v_fma_f32 v16, v16, s96, -v26
    v_fma_f32 v17, v17, s96, -v26
    v_fma_f32 v18, v18, s96, -v27
    v_mfma_f32_16x16x32_bf16 a[148:151], v[40:43], a[4:7], a[148:151]
    v_perm_b32 v48, v166, v162, s38
    v_perm_b32 v49, v174, v170, s38
    v_fma_f32 v19, v19, s96, -v27
    v_fma_f32 v20, v20, s96, -v27
    v_fma_f32 v21, v21, s96, -v27
    v_fma_f32 v22, v22, s96, -v27
    v_fma_f32 v23, v23, s96, -v27
    v_mfma_f32_16x16x32_bf16 a[152:155], v[44:47], a[0:3], a[152:155]
    v_perm_b32 v50, v182, v178, s38
    v_perm_b32 v51, v190, v186, s38
    v_fma_f32 v24, v24, s96, -v27
    v_fma_f32 v25, v25, s96, -v27
    v_exp_f32 v10, v10
    v_exp_f32 v11, v11
    v_exp_f32 v12, v12
    v_mfma_f32_16x16x32_bf16 a[156:159], v[44:47], a[4:7], a[156:159]
    v_perm_b32 v52, v166, v162, s39
    v_perm_b32 v53, v174, v170, s39
    v_exp_f32 v13, v13
    v_exp_f32 v14, v14
    v_exp_f32 v15, v15
    v_exp_f32 v16, v16
    v_exp_f32 v17, v17
    v_mfma_f32_16x16x32_bf16 a[160:163], v[48:51], a[0:3], a[160:163]
    v_perm_b32 v54, v182, v178, s39
    v_perm_b32 v55, v190, v186, s39
    v_exp_f32 v18, v18
    v_exp_f32 v19, v19
    v_exp_f32 v20, v20
    v_exp_f32 v21, v21
    v_exp_f32 v22, v22
    v_mfma_f32_16x16x32_bf16 a[164:167], v[48:51], a[4:7], a[164:167]
    v_perm_b32 v56, v167, v163, s38
    v_perm_b32 v57, v175, v171, s38
    v_exp_f32 v23, v23
    v_exp_f32 v24, v24
    v_exp_f32 v25, v25
    v_add_f32 v28, v28, v10
    v_add_f32 v28, v28, v11
    v_mfma_f32_16x16x32_bf16 a[168:171], v[52:55], a[0:3], a[168:171]
    v_perm_b32 v58, v183, v179, s38
    v_perm_b32 v59, v191, v187, s38
    v_add_f32 v28, v28, v12
    v_add_f32 v28, v28, v13
    v_add_f32 v28, v28, v14
    v_add_f32 v28, v28, v15
    v_add_f32 v28, v28, v16
    v_mfma_f32_16x16x32_bf16 a[172:175], v[52:55], a[4:7], a[172:175]
    v_perm_b32 v60, v167, v163, s39
    v_perm_b32 v61, v175, v171, s39
    v_add_f32 v28, v28, v17
    v_add_f32 v29, v29, v18
    v_add_f32 v29, v29, v19
    v_add_f32 v29, v29, v20
    v_add_f32 v29, v29, v21
    v_mfma_f32_16x16x32_bf16 a[176:179], v[56:59], a[0:3], a[176:179]
    v_perm_b32 v62, v183, v179, s39
    v_perm_b32 v63, v191, v187, s39
    v_add_f32 v29, v29, v22
    s_xor_b32 s97, s99, 0x1a000
    buffer_load_dwordx4 v[160:163], v0, s[56:59], s97 offen nt
    v_add_f32 v29, v29, v23
    v_add_f32 v29, v29, v24
    v_add_f32 v29, v29, v25
    v_cvt_pk_bf16_f32 v10, v10, v11
    v_mfma_f32_16x16x32_bf16 a[180:183], v[56:59], a[4:7], a[180:183]
    v_cvt_pk_bf16_f32 v12, v12, v13
    v_cvt_pk_bf16_f32 v14, v14, v15
    v_cvt_pk_bf16_f32 v16, v16, v17
    v_cvt_pk_bf16_f32 v18, v18, v19
    v_cvt_pk_bf16_f32 v20, v20, v21
    v_mfma_f32_16x16x32_bf16 a[184:187], v[60:63], a[0:3], a[184:187]
    v_cvt_pk_bf16_f32 v22, v22, v23
    v_cvt_pk_bf16_f32 v24, v24, v25
    v_accvgpr_write_b32 a16, v10
    v_accvgpr_write_b32 a17, v12
    v_accvgpr_write_b32 a18, v14
    v_mfma_f32_16x16x32_bf16 a[188:191], v[60:63], a[4:7], a[188:191]
    v_accvgpr_write_b32 a19, v16
    v_accvgpr_write_b32 a20, v18
    v_accvgpr_write_b32 a21, v20
    v_accvgpr_write_b32 a22, v22
    v_accvgpr_write_b32 a23, v24
    v_perm_b32 v32, v196, v192, s38
    v_perm_b32 v33, v204, v200, s38
    v_perm_b32 v34, v212, v208, s38
    v_perm_b32 v35, v220, v216, s38
    v_perm_b32 v36, v196, v192, s39
    v_perm_b32 v37, v204, v200, s39
    v_mfma_f32_16x16x32_bf16 a[128:131], v[32:35], a[16:19], a[128:131]
    v_perm_b32 v38, v212, v208, s39
    v_perm_b32 v39, v220, v216, s39
    v_accvgpr_read_b32 v10, a32
    v_accvgpr_read_b32 v11, a33
    v_accvgpr_read_b32 v12, a34
    v_accvgpr_read_b32 v13, a35
    v_accvgpr_read_b32 v14, a40
    v_mfma_f32_16x16x32_bf16 a[132:135], v[32:35], a[20:23], a[132:135]
    v_perm_b32 v40, v197, v193, s38
    v_perm_b32 v41, v205, v201, s38
    v_accvgpr_read_b32 v15, a41
    v_accvgpr_read_b32 v16, a42
    v_accvgpr_read_b32 v17, a43
    v_accvgpr_read_b32 v18, a36
    v_accvgpr_read_b32 v19, a37
    v_mfma_f32_16x16x32_bf16 a[136:139], v[36:39], a[16:19], a[136:139]
    v_perm_b32 v42, v213, v209, s38
    v_perm_b32 v43, v221, v217, s38
    v_accvgpr_read_b32 v20, a38
    s_xor_b32 s97, s99, 0x1a400
    buffer_load_dwordx4 v[164:167], v0, s[56:59], s97 offen nt
    v_accvgpr_read_b32 v21, a39
    v_accvgpr_read_b32 v22, a44
    v_accvgpr_read_b32 v23, a45
    v_accvgpr_read_b32 v24, a46
    v_mfma_f32_16x16x32_bf16 a[140:143], v[36:39], a[20:23], a[140:143]
    v_perm_b32 v44, v197, v193, s39
    v_perm_b32 v45, v205, v201, s39
    v_accvgpr_read_b32 v25, a47
    v_fma_f32 v10, v10, s96, -v26
    v_fma_f32 v11, v11, s96, -v26
    v_fma_f32 v12, v12, s96, -v26
    v_fma_f32 v13, v13, s96, -v26
    v_mfma_f32_16x16x32_bf16 a[144:147], v[40:43], a[16:19], a[144:147]
    v_perm_b32 v46, v213, v209, s39
    v_perm_b32 v47, v221, v217, s39
    v_fma_f32 v14, v14, s96, -v26
    v_fma_f32 v15, v15, s96, -v26
    v_fma_f32 v16, v16, s96, -v26
    v_fma_f32 v17, v17, s96, -v26
    v_fma_f32 v18, v18, s96, -v27
    v_mfma_f32_16x16x32_bf16 a[148:151], v[40:43], a[20:23], a[148:151]
    v_perm_b32 v48, v198, v194, s38
    v_perm_b32 v49, v206, v202, s38
    v_fma_f32 v19, v19, s96, -v27
    v_fma_f32 v20, v20, s96, -v27
    v_fma_f32 v21, v21, s96, -v27
    v_fma_f32 v22, v22, s96, -v27
    v_fma_f32 v23, v23, s96, -v27
    v_mfma_f32_16x16x32_bf16 a[152:155], v[44:47], a[16:19], a[152:155]
    v_perm_b32 v50, v214, v210, s38
    v_perm_b32 v51, v222, v218, s38
    v_fma_f32 v24, v24, s96, -v27
    v_fma_f32 v25, v25, s96, -v27
    v_exp_f32 v10, v10
    v_exp_f32 v11, v11
    v_exp_f32 v12, v12
    v_mfma_f32_16x16x32_bf16 a[156:159], v[44:47], a[20:23], a[156:159]
    v_perm_b32 v52, v198, v194, s39
    v_perm_b32 v53, v206, v202, s39
    v_exp_f32 v13, v13
    v_exp_f32 v14, v14
    v_exp_f32 v15, v15
    s_xor_b32 s97, s99, 0x1a800
    buffer_load_dwordx4 v[168:171], v0, s[56:59], s97 offen nt
    v_exp_f32 v16, v16
    v_exp_f32 v17, v17
    v_mfma_f32_16x16x32_bf16 a[160:163], v[48:51], a[16:19], a[160:163]
    v_perm_b32 v54, v214, v210, s39
    v_perm_b32 v55, v222, v218, s39
    v_exp_f32 v18, v18
    v_exp_f32 v19, v19
    v_exp_f32 v20, v20
    v_exp_f32 v21, v21
    v_exp_f32 v22, v22
    v_mfma_f32_16x16x32_bf16 a[164:167], v[48:51], a[20:23], a[164:167]
    v_perm_b32 v56, v199, v195, s38
    v_perm_b32 v57, v207, v203, s38
    v_exp_f32 v23, v23
    v_exp_f32 v24, v24
    v_exp_f32 v25, v25
    v_add_f32 v28, v28, v10
    v_add_f32 v28, v28, v11
    v_mfma_f32_16x16x32_bf16 a[168:171], v[52:55], a[16:19], a[168:171]
    v_perm_b32 v58, v215, v211, s38
    v_perm_b32 v59, v223, v219, s38
    v_add_f32 v28, v28, v12
    v_add_f32 v28, v28, v13
    v_add_f32 v28, v28, v14
    v_add_f32 v28, v28, v15
    v_add_f32 v28, v28, v16
    v_mfma_f32_16x16x32_bf16 a[172:175], v[52:55], a[20:23], a[172:175]
    v_perm_b32 v60, v199, v195, s39
    v_perm_b32 v61, v207, v203, s39
    v_add_f32 v28, v28, v17
    v_add_f32 v29, v29, v18
    v_add_f32 v29, v29, v19
    v_add_f32 v29, v29, v20
    v_add_f32 v29, v29, v21
    v_mfma_f32_16x16x32_bf16 a[176:179], v[56:59], a[16:19], a[176:179]
    v_perm_b32 v62, v215, v211, s39
    v_perm_b32 v63, v223, v219, s39
    v_add_f32 v29, v29, v22
    s_xor_b32 s97, s99, 0x1ac00
    buffer_load_dwordx4 v[172:175], v0, s[56:59], s97 offen nt
    v_add_f32 v29, v29, v23
    v_add_f32 v29, v29, v24
    v_add_f32 v29, v29, v25
    v_cvt_pk_bf16_f32 v10, v10, v11
    v_mfma_f32_16x16x32_bf16 a[180:183], v[56:59], a[20:23], a[180:183]
    v_cvt_pk_bf16_f32 v12, v12, v13
    v_cvt_pk_bf16_f32 v14, v14, v15
    v_cvt_pk_bf16_f32 v16, v16, v17
    v_cvt_pk_bf16_f32 v18, v18, v19
    v_cvt_pk_bf16_f32 v20, v20, v21
    v_mfma_f32_16x16x32_bf16 a[184:187], v[60:63], a[16:19], a[184:187]
    v_cvt_pk_bf16_f32 v22, v22, v23
    v_cvt_pk_bf16_f32 v24, v24, v25
    v_accvgpr_write_b32 a32, v10
    v_accvgpr_write_b32 a33, v12
    v_accvgpr_write_b32 a34, v14
    v_mfma_f32_16x16x32_bf16 a[188:191], v[60:63], a[20:23], a[188:191]
    v_accvgpr_write_b32 a35, v16
    v_accvgpr_write_b32 a36, v18
    v_accvgpr_write_b32 a37, v20
    v_accvgpr_write_b32 a38, v22
    v_accvgpr_write_b32 a39, v24
    s_waitcnt vmcnt(21)
    v_perm_b32 v32, v68, v64, s38
    v_perm_b32 v33, v76, v72, s38
    v_perm_b32 v34, v84, v80, s38
    v_perm_b32 v35, v92, v88, s38
    v_perm_b32 v36, v68, v64, s39
    v_perm_b32 v37, v76, v72, s39
    v_mfma_f32_16x16x32_bf16 a[128:131], v[32:35], a[32:35], a[128:131]
    v_perm_b32 v38, v84, v80, s39
    v_perm_b32 v39, v92, v88, s39
    v_accvgpr_read_b32 v10, a48
    v_accvgpr_read_b32 v11, a49
    v_accvgpr_read_b32 v12, a50
    v_accvgpr_read_b32 v13, a51
    v_accvgpr_read_b32 v14, a56
    v_mfma_f32_16x16x32_bf16 a[132:135], v[32:35], a[36:39], a[132:135]
    v_perm_b32 v40, v69, v65, s38
    v_perm_b32 v41, v77, v73, s38
    v_accvgpr_read_b32 v15, a57
    v_accvgpr_read_b32 v16, a58
    v_accvgpr_read_b32 v17, a59
    v_accvgpr_read_b32 v18, a52
    v_accvgpr_read_b32 v19, a53
    v_mfma_f32_16x16x32_bf16 a[136:139], v[36:39], a[32:35], a[136:139]
    v_perm_b32 v42, v85, v81, s38
    v_perm_b32 v43, v93, v89, s38
    s_xor_b32 s97, s99, 0x1b000
    buffer_load_dwordx4 v[176:179], v0, s[56:59], s97 offen nt
    v_accvgpr_read_b32 v20, a54
    v_accvgpr_read_b32 v21, a55
    v_accvgpr_read_b32 v22, a60
    v_accvgpr_read_b32 v23, a61
    v_accvgpr_read_b32 v24, a62
    v_mfma_f32_16x16x32_bf16 a[140:143], v[36:39], a[36:39], a[140:143]
    v_perm_b32 v44, v69, v65, s39
    v_perm_b32 v45, v77, v73, s39
    v_accvgpr_read_b32 v25, a63
    v_fma_f32 v10, v10, s96, -v26
    v_fma_f32 v11, v11, s96, -v26
    v_fma_f32 v12, v12, s96, -v26
    v_fma_f32 v13, v13, s96, -v26
    v_mfma_f32_16x16x32_bf16 a[144:147], v[40:43], a[32:35], a[144:147]
    v_perm_b32 v46, v85, v81, s39
    v_perm_b32 v47, v93, v89, s39
    v_fma_f32 v14, v14, s96, -v26
    v_fma_f32 v15, v15, s96, -v26
    v_fma_f32 v16, v16, s96, -v26
    v_fma_f32 v17, v17, s96, -v26
    v_fma_f32 v18, v18, s96, -v27
    v_mfma_f32_16x16x32_bf16 a[148:151], v[40:43], a[36:39], a[148:151]
    v_perm_b32 v48, v70, v66, s38
    v_perm_b32 v49, v78, v74, s38
    v_fma_f32 v19, v19, s96, -v27
    v_fma_f32 v20, v20, s96, -v27
    v_fma_f32 v21, v21, s96, -v27
    v_fma_f32 v22, v22, s96, -v27
    v_fma_f32 v23, v23, s96, -v27
    v_mfma_f32_16x16x32_bf16 a[152:155], v[44:47], a[32:35], a[152:155]
    v_perm_b32 v50, v86, v82, s38
    v_perm_b32 v51, v94, v90, s38
    v_fma_f32 v24, v24, s96, -v27
    v_fma_f32 v25, v25, s96, -v27
    v_exp_f32 v10, v10
    v_exp_f32 v11, v11
    v_exp_f32 v12, v12
    v_mfma_f32_16x16x32_bf16 a[156:159], v[44:47], a[36:39], a[156:159]
    v_perm_b32 v52, v70, v66, s39
    v_perm_b32 v53, v78, v74, s39
    v_exp_f32 v13, v13
    v_exp_f32 v14, v14
    v_exp_f32 v15, v15
    s_xor_b32 s97, s99, 0x1b400
    buffer_load_dwordx4 v[180:183], v0, s[56:59], s97 offen nt
    v_exp_f32 v16, v16
    v_exp_f32 v17, v17
    v_mfma_f32_16x16x32_bf16 a[160:163], v[48:51], a[32:35], a[160:163]
    v_perm_b32 v54, v86, v82, s39
    v_perm_b32 v55, v94, v90, s39
    v_exp_f32 v18, v18
    v_exp_f32 v19, v19
    v_exp_f32 v20, v20
    v_exp_f32 v21, v21
    v_exp_f32 v22, v22
    v_mfma_f32_16x16x32_bf16 a[164:167], v[48:51], a[36:39], a[164:167]
    v_perm_b32 v56, v71, v67, s38
    v_perm_b32 v57, v79, v75, s38
    v_exp_f32 v23, v23
    v_exp_f32 v24, v24
    v_exp_f32 v25, v25
    v_add_f32 v28, v28, v10
    v_add_f32 v28, v28, v11
    v_mfma_f32_16x16x32_bf16 a[168:171], v[52:55], a[32:35], a[168:171]
    v_perm_b32 v58, v87, v83, s38
    v_perm_b32 v59, v95, v91, s38
    v_add_f32 v28, v28, v12
    v_add_f32 v28, v28, v13
    v_add_f32 v28, v28, v14
    v_add_f32 v28, v28, v15
    v_add_f32 v28, v28, v16
    v_mfma_f32_16x16x32_bf16 a[172:175], v[52:55], a[36:39], a[172:175]
    v_perm_b32 v60, v71, v67, s39
    v_perm_b32 v61, v79, v75, s39
    v_add_f32 v28, v28, v17
    v_add_f32 v29, v29, v18
    v_add_f32 v29, v29, v19
    v_add_f32 v29, v29, v20
    v_add_f32 v29, v29, v21
    v_mfma_f32_16x16x32_bf16 a[176:179], v[56:59], a[32:35], a[176:179]
    v_perm_b32 v62, v87, v83, s39
    v_perm_b32 v63, v95, v91, s39
    v_add_f32 v29, v29, v22
    s_xor_b32 s97, s99, 0x1b800
    buffer_load_dwordx4 v[184:187], v0, s[56:59], s97 offen nt
    v_add_f32 v29, v29, v23
    v_add_f32 v29, v29, v24
    v_add_f32 v29, v29, v25
    v_cvt_pk_bf16_f32 v10, v10, v11
    v_mfma_f32_16x16x32_bf16 a[180:183], v[56:59], a[36:39], a[180:183]
    v_cvt_pk_bf16_f32 v12, v12, v13
    v_cvt_pk_bf16_f32 v14, v14, v15
    v_cvt_pk_bf16_f32 v16, v16, v17
    v_cvt_pk_bf16_f32 v18, v18, v19
    v_cvt_pk_bf16_f32 v20, v20, v21
    v_mfma_f32_16x16x32_bf16 a[184:187], v[60:63], a[32:35], a[184:187]
    v_cvt_pk_bf16_f32 v22, v22, v23
    v_cvt_pk_bf16_f32 v24, v24, v25
    v_accvgpr_write_b32 a48, v10
    v_accvgpr_write_b32 a49, v12
    v_accvgpr_write_b32 a50, v14
    v_mfma_f32_16x16x32_bf16 a[188:191], v[60:63], a[36:39], a[188:191]
    v_accvgpr_write_b32 a51, v16
    v_accvgpr_write_b32 a52, v18
    v_accvgpr_write_b32 a53, v20
    v_accvgpr_write_b32 a54, v22
    v_accvgpr_write_b32 a55, v24
    s_waitcnt vmcnt(16)
    v_perm_b32 v32, v100, v96, s38
    v_perm_b32 v33, v108, v104, s38
    v_perm_b32 v34, v116, v112, s38
    v_perm_b32 v35, v124, v120, s38
    v_perm_b32 v36, v100, v96, s39
    v_perm_b32 v37, v108, v104, s39
    v_mfma_f32_16x16x32_bf16 a[128:131], v[32:35], a[48:51], a[128:131]
    v_perm_b32 v38, v116, v112, s39
    v_perm_b32 v39, v124, v120, s39
    v_accvgpr_read_b32 v10, a64
    v_accvgpr_read_b32 v11, a65
    v_accvgpr_read_b32 v12, a66
    v_accvgpr_read_b32 v13, a67
    v_accvgpr_read_b32 v14, a72
    v_mfma_f32_16x16x32_bf16 a[132:135], v[32:35], a[52:55], a[132:135]
    v_perm_b32 v40, v101, v97, s38
    v_perm_b32 v41, v109, v105, s38
    v_accvgpr_read_b32 v15, a73
    v_accvgpr_read_b32 v16, a74
    v_accvgpr_read_b32 v17, a75
    v_accvgpr_read_b32 v18, a68
    v_accvgpr_read_b32 v19, a69
    v_mfma_f32_16x16x32_bf16 a[136:139], v[36:39], a[48:51], a[136:139]
    v_perm_b32 v42, v117, v113, s38
    v_perm_b32 v43, v125, v121, s38
    s_xor_b32 s97, s99, 0x1bc00
    buffer_load_dwordx4 v[188:191], v0, s[56:59], s97 offen nt
    v_accvgpr_read_b32 v20, a70
    v_accvgpr_read_b32 v21, a71
    v_accvgpr_read_b32 v22, a76
    v_accvgpr_read_b32 v23, a77
    v_accvgpr_read_b32 v24, a78
    v_mfma_f32_16x16x32_bf16 a[140:143], v[36:39], a[52:55], a[140:143]
    v_perm_b32 v44, v101, v97, s39
    v_perm_b32 v45, v109, v105, s39
    v_accvgpr_read_b32 v25, a79
    v_fma_f32 v10, v10, s96, -v26
    v_fma_f32 v11, v11, s96, -v26
    v_fma_f32 v12, v12, s96, -v26
    v_fma_f32 v13, v13, s96, -v26
    v_mfma_f32_16x16x32_bf16 a[144:147], v[40:43], a[48:51], a[144:147]
    v_perm_b32 v46, v117, v113, s39
    v_perm_b32 v47, v125, v121, s39
    v_fma_f32 v14, v14, s96, -v26
    v_fma_f32 v15, v15, s96, -v26
    v_fma_f32 v16, v16, s96, -v26
    v_fma_f32 v17, v17, s96, -v26
    v_fma_f32 v18, v18, s96, -v27
    v_mfma_f32_16x16x32_bf16 a[148:151], v[40:43], a[52:55], a[148:151]
    v_perm_b32 v48, v102, v98, s38
    v_perm_b32 v49, v110, v106, s38
    v_fma_f32 v19, v19, s96, -v27
    v_fma_f32 v20, v20, s96, -v27
    v_fma_f32 v21, v21, s96, -v27
    v_fma_f32 v22, v22, s96, -v27
    v_fma_f32 v23, v23, s96, -v27
    v_mfma_f32_16x16x32_bf16 a[152:155], v[44:47], a[48:51], a[152:155]
    v_perm_b32 v50, v118, v114, s38
    v_perm_b32 v51, v126, v122, s38
    v_fma_f32 v24, v24, s96, -v27
    v_fma_f32 v25, v25, s96, -v27
    v_exp_f32 v10, v10
    v_exp_f32 v11, v11
    v_exp_f32 v12, v12
    v_mfma_f32_16x16x32_bf16 a[156:159], v[44:47], a[52:55], a[156:159]
    v_perm_b32 v52, v102, v98, s39
    v_perm_b32 v53, v110, v106, s39
    v_exp_f32 v13, v13
    v_exp_f32 v14, v14
    v_exp_f32 v15, v15
    s_xor_b32 s97, s99, 0x1c000
    buffer_load_dwordx4 v[192:195], v0, s[56:59], s97 offen nt
    v_exp_f32 v16, v16
    v_exp_f32 v17, v17
    v_mfma_f32_16x16x32_bf16 a[160:163], v[48:51], a[48:51], a[160:163]
    v_perm_b32 v54, v118, v114, s39
    v_perm_b32 v55, v126, v122, s39
    v_exp_f32 v18, v18
    v_exp_f32 v19, v19
    v_exp_f32 v20, v20
    v_exp_f32 v21, v21
    v_exp_f32 v22, v22
    v_mfma_f32_16x16x32_bf16 a[164:167], v[48:51], a[52:55], a[164:167]
    v_perm_b32 v56, v103, v99, s38
    v_perm_b32 v57, v111, v107, s38
    v_exp_f32 v23, v23
    v_exp_f32 v24, v24
    v_exp_f32 v25, v25
    v_add_f32 v28, v28, v10
    v_add_f32 v28, v28, v11
    v_mfma_f32_16x16x32_bf16 a[168:171], v[52:55], a[48:51], a[168:171]
    v_perm_b32 v58, v119, v115, s38
    v_perm_b32 v59, v127, v123, s38
    v_add_f32 v28, v28, v12
    v_add_f32 v28, v28, v13
    v_add_f32 v28, v28, v14
    v_add_f32 v28, v28, v15
    v_add_f32 v28, v28, v16
    v_mfma_f32_16x16x32_bf16 a[172:175], v[52:55], a[52:55], a[172:175]
    v_perm_b32 v60, v103, v99, s39
    v_perm_b32 v61, v111, v107, s39
    v_add_f32 v28, v28, v17
    v_add_f32 v29, v29, v18
    v_add_f32 v29, v29, v19
    v_add_f32 v29, v29, v20
    v_add_f32 v29, v29, v21
    v_mfma_f32_16x16x32_bf16 a[176:179], v[56:59], a[48:51], a[176:179]
    v_perm_b32 v62, v119, v115, s39
    v_perm_b32 v63, v127, v123, s39
    v_add_f32 v29, v29, v22
    s_xor_b32 s97, s99, 0x1c400
    buffer_load_dwordx4 v[196:199], v0, s[56:59], s97 offen nt
    v_add_f32 v29, v29, v23
    v_add_f32 v29, v29, v24
    v_add_f32 v29, v29, v25
    v_cvt_pk_bf16_f32 v10, v10, v11
    v_mfma_f32_16x16x32_bf16 a[180:183], v[56:59], a[52:55], a[180:183]
    v_cvt_pk_bf16_f32 v12, v12, v13
    v_cvt_pk_bf16_f32 v14, v14, v15
    v_cvt_pk_bf16_f32 v16, v16, v17
    v_cvt_pk_bf16_f32 v18, v18, v19
    v_cvt_pk_bf16_f32 v20, v20, v21
    v_mfma_f32_16x16x32_bf16 a[184:187], v[60:63], a[48:51], a[184:187]
    v_cvt_pk_bf16_f32 v22, v22, v23
    v_cvt_pk_bf16_f32 v24, v24, v25
    v_accvgpr_write_b32 a64, v10
    v_accvgpr_write_b32 a65, v12
    v_accvgpr_write_b32 a66, v14
    v_mfma_f32_16x16x32_bf16 a[188:191], v[60:63], a[52:55], a[188:191]
    v_accvgpr_write_b32 a67, v16
    v_accvgpr_write_b32 a68, v18
    v_accvgpr_write_b32 a69, v20
    v_accvgpr_write_b32 a70, v22
    v_accvgpr_write_b32 a71, v24
    s_xor_b32 s97, s99, 0x1c800
    buffer_load_dwordx4 v[200:203], v0, s[56:59], s97 offen nt
    s_xor_b32 s97, s99, 0x1cc00
    buffer_load_dwordx4 v[204:207], v0, s[56:59], s97 offen nt
    s_xor_b32 s97, s99, 0x1d000
    buffer_load_dwordx4 v[208:211], v0, s[56:59], s97 offen nt
    s_xor_b32 s97, s99, 0x1d400
    buffer_load_dwordx4 v[212:215], v0, s[56:59], s97 offen nt
    s_xor_b32 s97, s99, 0x1d800
    buffer_load_dwordx4 v[216:219], v0, s[56:59], s97 offen nt
    s_xor_b32 s97, s99, 0x1dc00
    buffer_load_dwordx4 v[220:223], v0, s[56:59], s97 offen nt
    s_waitcnt vmcnt(16)
    v_perm_b32 v32, v132, v128, s38
    v_perm_b32 v33, v140, v136, s38
    v_perm_b32 v34, v148, v144, s38
    v_perm_b32 v35, v156, v152, s38
    v_perm_b32 v36, v132, v128, s39
    v_perm_b32 v37, v140, v136, s39
    v_mfma_f32_16x16x32_bf16 a[128:131], v[32:35], a[64:67], a[128:131]
    v_perm_b32 v38, v148, v144, s39
    v_perm_b32 v39, v156, v152, s39
    v_accvgpr_read_b32 v10, a80
    v_accvgpr_read_b32 v11, a81
    v_accvgpr_read_b32 v12, a82
    v_accvgpr_read_b32 v13, a83
    v_accvgpr_read_b32 v14, a88
    v_mfma_f32_16x16x32_bf16 a[132:135], v[32:35], a[68:71], a[132:135]
    v_perm_b32 v40, v133, v129, s38
    v_perm_b32 v41, v141, v137, s38
    v_accvgpr_read_b32 v15, a89
    v_accvgpr_read_b32 v16, a90
    v_accvgpr_read_b32 v17, a91
    v_accvgpr_read_b32 v18, a84
    v_accvgpr_read_b32 v19, a85
    v_mfma_f32_16x16x32_bf16 a[136:139], v[36:39], a[64:67], a[136:139]
    v_perm_b32 v42, v149, v145, s38
    v_perm_b32 v43, v157, v153, s38
    v_accvgpr_read_b32 v20, a86
    v_accvgpr_read_b32 v21, a87
    v_accvgpr_read_b32 v22, a92
    v_accvgpr_read_b32 v23, a93
    v_accvgpr_read_b32 v24, a94
    v_mfma_f32_16x16x32_bf16 a[140:143], v[36:39], a[68:71], a[140:143]
    v_perm_b32 v44, v133, v129, s39
    v_perm_b32 v45, v141, v137, s39
    v_accvgpr_read_b32 v25, a95
    v_fma_f32 v10, v10, s96, -v26
    v_fma_f32 v11, v11, s96, -v26
    v_fma_f32 v12, v12, s96, -v26
    v_fma_f32 v13, v13, s96, -v26
    v_mfma_f32_16x16x32_bf16 a[144:147], v[40:43], a[64:67], a[144:147]
    v_perm_b32 v46, v149, v145, s39
    v_perm_b32 v47, v157, v153, s39
    v_fma_f32 v14, v14, s96, -v26
    v_fma_f32 v15, v15, s96, -v26
    v_fma_f32 v16, v16, s96, -v26
    v_fma_f32 v17, v17, s96, -v26
    v_fma_f32 v18, v18, s96, -v27
    v_mfma_f32_16x16x32_bf16 a[148:151], v[40:43], a[68:71], a[148:151]
    s_xor_b32 s97, s99, 0x1e000
    buffer_load_dwordx4 v[64:67], v0, s[56:59], s97 offen nt
    v_perm_b32 v48, v134, v130, s38
    v_perm_b32 v49, v142, v138, s38
    v_fma_f32 v19, v19, s96, -v27
    v_fma_f32 v20, v20, s96, -v27
    v_fma_f32 v21, v21, s96, -v27
    v_fma_f32 v22, v22, s96, -v27
    v_fma_f32 v23, v23, s96, -v27
    v_mfma_f32_16x16x32_bf16 a[152:155], v[44:47], a[64:67], a[152:155]
    v_perm_b32 v50, v150, v146, s38
    v_perm_b32 v51, v158, v154, s38
    v_fma_f32 v24, v24, s96, -v27
    v_fma_f32 v25, v25, s96, -v27
    v_exp_f32 v10, v10
    v_exp_f32 v11, v11
    v_exp_f32 v12, v12
    v_mfma_f32_16x16x32_bf16 a[156:159], v[44:47], a[68:71], a[156:159]
    v_perm_b32 v52, v134, v130, s39
    v_perm_b32 v53, v142, v138, s39
    v_exp_f32 v13, v13
    v_exp_f32 v14, v14
    v_exp_f32 v15, v15
    v_exp_f32 v16, v16
    v_exp_f32 v17, v17
    v_mfma_f32_16x16x32_bf16 a[160:163], v[48:51], a[64:67], a[160:163]
    v_perm_b32 v54, v150, v146, s39
    v_perm_b32 v55, v158, v154, s39
    v_exp_f32 v18, v18
    v_exp_f32 v19, v19
    v_exp_f32 v20, v20
    v_exp_f32 v21, v21
    v_exp_f32 v22, v22
    v_mfma_f32_16x16x32_bf16 a[164:167], v[48:51], a[68:71], a[164:167]
    v_perm_b32 v56, v135, v131, s38
    v_perm_b32 v57, v143, v139, s38
    v_exp_f32 v23, v23
    s_xor_b32 s97, s99, 0x1e400
    buffer_load_dwordx4 v[68:71], v0, s[56:59], s97 offen nt
    v_exp_f32 v24, v24
    v_exp_f32 v25, v25
    v_add_f32 v28, v28, v10
    v_add_f32 v28, v28, v11
    v_mfma_f32_16x16x32_bf16 a[168:171], v[52:55], a[64:67], a[168:171]
    v_perm_b32 v58, v151, v147, s38
    v_perm_b32 v59, v159, v155, s38
    v_add_f32 v28, v28, v12
    v_add_f32 v28, v28, v13
    v_add_f32 v28, v28, v14
    v_add_f32 v28, v28, v15
    v_add_f32 v28, v28, v16
    v_mfma_f32_16x16x32_bf16 a[172:175], v[52:55], a[68:71], a[172:175]
    v_perm_b32 v60, v135, v131, s39
    v_perm_b32 v61, v143, v139, s39
    v_add_f32 v28, v28, v17
    v_add_f32 v29, v29, v18
    v_add_f32 v29, v29, v19
    v_add_f32 v29, v29, v20
    v_add_f32 v29, v29, v21
    v_mfma_f32_16x16x32_bf16 a[176:179], v[56:59], a[64:67], a[176:179]
    v_perm_b32 v62, v151, v147, s39
    v_perm_b32 v63, v159, v155, s39
    v_add_f32 v29, v29, v22
    v_add_f32 v29, v29, v23
    v_add_f32 v29, v29, v24
    v_add_f32 v29, v29, v25
    v_cvt_pk_bf16_f32 v10, v10, v11
    v_mfma_f32_16x16x32_bf16 a[180:183], v[56:59], a[68:71], a[180:183]
    v_cvt_pk_bf16_f32 v12, v12, v13
    v_cvt_pk_bf16_f32 v14, v14, v15
    v_cvt_pk_bf16_f32 v16, v16, v17
    v_cvt_pk_bf16_f32 v18, v18, v19
    v_cvt_pk_bf16_f32 v20, v20, v21
    v_mfma_f32_16x16x32_bf16 a[184:187], v[60:63], a[64:67], a[184:187]
    v_cvt_pk_bf16_f32 v22, v22, v23
    v_cvt_pk_bf16_f32 v24, v24, v25
    v_accvgpr_write_b32 a80, v10
    v_accvgpr_write_b32 a81, v12
    v_accvgpr_write_b32 a82, v14
    v_mfma_f32_16x16x32_bf16 a[188:191], v[60:63], a[68:71], a[188:191]
    v_accvgpr_write_b32 a83, v16
    v_accvgpr_write_b32 a84, v18
    v_accvgpr_write_b32 a85, v20
    v_accvgpr_write_b32 a86, v22
    v_accvgpr_write_b32 a87, v24
    s_xor_b32 s97, s99, 0x1e800
    buffer_load_dwordx4 v[72:75], v0, s[56:59], s97 offen nt
    s_xor_b32 s97, s99, 0x1ec00
    buffer_load_dwordx4 v[76:79], v0, s[56:59], s97 offen nt
    s_xor_b32 s97, s99, 0x1f000
    buffer_load_dwordx4 v[80:83], v0, s[56:59], s97 offen nt
    s_xor_b32 s97, s99, 0x1f400
    buffer_load_dwordx4 v[84:87], v0, s[56:59], s97 offen nt
    s_xor_b32 s97, s99, 0x1f800
    buffer_load_dwordx4 v[88:91], v0, s[56:59], s97 offen nt
    s_xor_b32 s97, s99, 0x1fc00
    buffer_load_dwordx4 v[92:95], v0, s[56:59], s97 offen nt
    s_waitcnt vmcnt(16)
    v_perm_b32 v32, v164, v160, s38
    v_perm_b32 v33, v172, v168, s38
    v_perm_b32 v34, v180, v176, s38
    v_perm_b32 v35, v188, v184, s38
    v_perm_b32 v36, v164, v160, s39
    v_perm_b32 v37, v172, v168, s39
    v_mfma_f32_16x16x32_bf16 a[128:131], v[32:35], a[80:83], a[128:131]
    v_perm_b32 v38, v180, v176, s39
    v_perm_b32 v39, v188, v184, s39
    v_accvgpr_read_b32 v10, a96
    v_accvgpr_read_b32 v11, a97
    v_accvgpr_read_b32 v12, a98
    v_accvgpr_read_b32 v13, a99
    v_accvgpr_read_b32 v14, a104
    v_mfma_f32_16x16x32_bf16 a[132:135], v[32:35], a[84:87], a[132:135]
    v_perm_b32 v40, v165, v161, s38
    v_perm_b32 v41, v173, v169, s38
    v_accvgpr_read_b32 v15, a105
    v_accvgpr_read_b32 v16, a106
    v_accvgpr_read_b32 v17, a107
    v_accvgpr_read_b32 v18, a100
    v_accvgpr_read_b32 v19, a101
    v_mfma_f32_16x16x32_bf16 a[136:139], v[36:39], a[80:83], a[136:139]
    v_perm_b32 v42, v181, v177, s38
    v_perm_b32 v43, v189, v185, s38
    v_accvgpr_read_b32 v20, a102
    v_accvgpr_read_b32 v21, a103
    v_accvgpr_read_b32 v22, a108
    v_accvgpr_read_b32 v23, a109
    v_accvgpr_read_b32 v24, a110
    v_mfma_f32_16x16x32_bf16 a[140:143], v[36:39], a[84:87], a[140:143]
    v_perm_b32 v44, v165, v161, s39
    v_perm_b32 v45, v173, v169, s39
    v_accvgpr_read_b32 v25, a111
    v_fma_f32 v10, v10, s96, -v26
    v_fma_f32 v11, v11, s96, -v26
    v_fma_f32 v12, v12, s96, -v26
    v_fma_f32 v13, v13, s96, -v26
    v_mfma_f32_16x16x32_bf16 a[144:147], v[40:43], a[80:83], a[144:147]
    v_perm_b32 v46, v181, v177, s39
    v_perm_b32 v47, v189, v185, s39
    v_fma_f32 v14, v14, s96, -v26
    v_fma_f32 v15, v15, s96, -v26
    v_fma_f32 v16, v16, s96, -v26
    v_fma_f32 v17, v17, s96, -v26
    v_fma_f32 v18, v18, s96, -v27
    v_mfma_f32_16x16x32_bf16 a[148:151], v[40:43], a[84:87], a[148:151]
    v_perm_b32 v48, v166, v162, s38
    v_perm_b32 v49, v174, v170, s38
    v_fma_f32 v19, v19, s96, -v27
    v_fma_f32 v20, v20, s96, -v27
    v_fma_f32 v21, v21, s96, -v27
    v_fma_f32 v22, v22, s96, -v27
    v_fma_f32 v23, v23, s96, -v27
    v_mfma_f32_16x16x32_bf16 a[152:155], v[44:47], a[80:83], a[152:155]
    v_perm_b32 v50, v182, v178, s38
    v_perm_b32 v51, v190, v186, s38
    v_fma_f32 v24, v24, s96, -v27
    v_fma_f32 v25, v25, s96, -v27
    v_exp_f32 v10, v10
    v_exp_f32 v11, v11
    v_exp_f32 v12, v12
    v_mfma_f32_16x16x32_bf16 a[156:159], v[44:47], a[84:87], a[156:159]
    v_perm_b32 v52, v166, v162, s39
    v_perm_b32 v53, v174, v170, s39
    v_exp_f32 v13, v13
    v_exp_f32 v14, v14
    v_exp_f32 v15, v15
    v_exp_f32 v16, v16
    v_exp_f32 v17, v17
    v_mfma_f32_16x16x32_bf16 a[160:163], v[48:51], a[80:83], a[160:163]
    v_perm_b32 v54, v182, v178, s39
    v_perm_b32 v55, v190, v186, s39
    v_exp_f32 v18, v18
    v_exp_f32 v19, v19
    v_exp_f32 v20, v20
    v_exp_f32 v21, v21
    v_exp_f32 v22, v22
    v_mfma_f32_16x16x32_bf16 a[164:167], v[48:51], a[84:87], a[164:167]
    v_perm_b32 v56, v167, v163, s38
    v_perm_b32 v57, v175, v171, s38
    v_exp_f32 v23, v23
    v_exp_f32 v24, v24
    v_exp_f32 v25, v25
    v_add_f32 v28, v28, v10
    v_add_f32 v28, v28, v11
    v_mfma_f32_16x16x32_bf16 a[168:171], v[52:55], a[80:83], a[168:171]
    v_perm_b32 v58, v183, v179, s38
    v_perm_b32 v59, v191, v187, s38
    v_add_f32 v28, v28, v12
    v_add_f32 v28, v28, v13
    v_add_f32 v28, v28, v14
    v_add_f32 v28, v28, v15
    v_add_f32 v28, v28, v16
    v_mfma_f32_16x16x32_bf16 a[172:175], v[52:55], a[84:87], a[172:175]
    v_perm_b32 v60, v167, v163, s39
    v_perm_b32 v61, v175, v171, s39
    v_add_f32 v28, v28, v17
    v_add_f32 v29, v29, v18
    v_add_f32 v29, v29, v19
    v_add_f32 v29, v29, v20
    v_add_f32 v29, v29, v21
    v_mfma_f32_16x16x32_bf16 a[176:179], v[56:59], a[80:83], a[176:179]
    v_perm_b32 v62, v183, v179, s39
    v_perm_b32 v63, v191, v187, s39
    v_add_f32 v29, v29, v22
    v_add_f32 v29, v29, v23
    v_add_f32 v29, v29, v24
    v_add_f32 v29, v29, v25
    v_cvt_pk_bf16_f32 v10, v10, v11
    v_mfma_f32_16x16x32_bf16 a[180:183], v[56:59], a[84:87], a[180:183]
    v_cvt_pk_bf16_f32 v12, v12, v13
    v_cvt_pk_bf16_f32 v14, v14, v15
    v_cvt_pk_bf16_f32 v16, v16, v17
    v_cvt_pk_bf16_f32 v18, v18, v19
    v_cvt_pk_bf16_f32 v20, v20, v21
    v_mfma_f32_16x16x32_bf16 a[184:187], v[60:63], a[80:83], a[184:187]
    v_cvt_pk_bf16_f32 v22, v22, v23
    v_cvt_pk_bf16_f32 v24, v24, v25
    v_accvgpr_write_b32 a96, v10
    v_accvgpr_write_b32 a97, v12
    v_accvgpr_write_b32 a98, v14
    v_mfma_f32_16x16x32_bf16 a[188:191], v[60:63], a[84:87], a[188:191]
    v_accvgpr_write_b32 a99, v16
    v_accvgpr_write_b32 a100, v18
    v_accvgpr_write_b32 a101, v20
    v_accvgpr_write_b32 a102, v22
    v_accvgpr_write_b32 a103, v24
    s_waitcnt vmcnt(8)
    v_perm_b32 v32, v196, v192, s38
    v_perm_b32 v33, v204, v200, s38
    v_perm_b32 v34, v212, v208, s38
    v_perm_b32 v35, v220, v216, s38
    v_perm_b32 v36, v196, v192, s39
    v_perm_b32 v37, v204, v200, s39
    v_mfma_f32_16x16x32_bf16 a[128:131], v[32:35], a[96:99], a[128:131]
    v_perm_b32 v38, v212, v208, s39
    v_perm_b32 v39, v220, v216, s39
    v_accvgpr_read_b32 v10, a112
    v_accvgpr_read_b32 v11, a113
    v_accvgpr_read_b32 v12, a114
    v_accvgpr_read_b32 v13, a115
    v_accvgpr_read_b32 v14, a120
    v_mfma_f32_16x16x32_bf16 a[132:135], v[32:35], a[100:103], a[132:135]
    v_perm_b32 v40, v197, v193, s38
    v_perm_b32 v41, v205, v201, s38
    v_accvgpr_read_b32 v15, a121
    v_accvgpr_read_b32 v16, a122
    v_accvgpr_read_b32 v17, a123
    v_accvgpr_read_b32 v18, a116
    v_accvgpr_read_b32 v19, a117
    v_mfma_f32_16x16x32_bf16 a[136:139], v[36:39], a[96:99], a[136:139]
    v_perm_b32 v42, v213, v209, s38
    v_perm_b32 v43, v221, v217, s38
    v_accvgpr_read_b32 v20, a118
    v_accvgpr_read_b32 v21, a119
    v_accvgpr_read_b32 v22, a124
    v_accvgpr_read_b32 v23, a125
    v_accvgpr_read_b32 v24, a126
    v_mfma_f32_16x16x32_bf16 a[140:143], v[36:39], a[100:103], a[140:143]
    v_perm_b32 v44, v197, v193, s39
    v_perm_b32 v45, v205, v201, s39
    v_accvgpr_read_b32 v25, a127
    v_fma_f32 v10, v10, s96, -v26
    v_fma_f32 v11, v11, s96, -v26
    v_fma_f32 v12, v12, s96, -v26
    v_fma_f32 v13, v13, s96, -v26
    v_mfma_f32_16x16x32_bf16 a[144:147], v[40:43], a[96:99], a[144:147]
    v_perm_b32 v46, v213, v209, s39
    v_perm_b32 v47, v221, v217, s39
    v_fma_f32 v14, v14, s96, -v26
    v_fma_f32 v15, v15, s96, -v26
    v_fma_f32 v16, v16, s96, -v26
    v_fma_f32 v17, v17, s96, -v26
    v_fma_f32 v18, v18, s96, -v27
    v_mfma_f32_16x16x32_bf16 a[148:151], v[40:43], a[100:103], a[148:151]
    v_perm_b32 v48, v198, v194, s38
    v_perm_b32 v49, v206, v202, s38
    v_fma_f32 v19, v19, s96, -v27
    v_fma_f32 v20, v20, s96, -v27
    v_fma_f32 v21, v21, s96, -v27
    v_fma_f32 v22, v22, s96, -v27
    v_fma_f32 v23, v23, s96, -v27
    v_mfma_f32_16x16x32_bf16 a[152:155], v[44:47], a[96:99], a[152:155]
    v_perm_b32 v50, v214, v210, s38
    v_perm_b32 v51, v222, v218, s38
    v_fma_f32 v24, v24, s96, -v27
    v_fma_f32 v25, v25, s96, -v27
    v_exp_f32 v10, v10
    v_exp_f32 v11, v11
    v_exp_f32 v12, v12
    v_mfma_f32_16x16x32_bf16 a[156:159], v[44:47], a[100:103], a[156:159]
    v_perm_b32 v52, v198, v194, s39
    v_perm_b32 v53, v206, v202, s39
    v_exp_f32 v13, v13
    v_exp_f32 v14, v14
    v_exp_f32 v15, v15
    v_exp_f32 v16, v16
    v_exp_f32 v17, v17
    v_mfma_f32_16x16x32_bf16 a[160:163], v[48:51], a[96:99], a[160:163]
    v_perm_b32 v54, v214, v210, s39
    v_perm_b32 v55, v222, v218, s39
    v_exp_f32 v18, v18
    v_exp_f32 v19, v19
    v_exp_f32 v20, v20
    v_exp_f32 v21, v21
    v_exp_f32 v22, v22
    v_mfma_f32_16x16x32_bf16 a[164:167], v[48:51], a[100:103], a[164:167]
    v_perm_b32 v56, v199, v195, s38
    v_perm_b32 v57, v207, v203, s38
    v_exp_f32 v23, v23
    v_exp_f32 v24, v24
    v_exp_f32 v25, v25
    v_add_f32 v28, v28, v10
    v_add_f32 v28, v28, v11
    v_mfma_f32_16x16x32_bf16 a[168:171], v[52:55], a[96:99], a[168:171]
    v_perm_b32 v58, v215, v211, s38
    v_perm_b32 v59, v223, v219, s38
    v_add_f32 v28, v28, v12
    v_add_f32 v28, v28, v13
    v_add_f32 v28, v28, v14
    v_add_f32 v28, v28, v15
    v_add_f32 v28, v28, v16
    v_mfma_f32_16x16x32_bf16 a[172:175], v[52:55], a[100:103], a[172:175]
    v_perm_b32 v60, v199, v195, s39
    v_perm_b32 v61, v207, v203, s39
    v_add_f32 v28, v28, v17
    v_add_f32 v29, v29, v18
    v_add_f32 v29, v29, v19
    v_add_f32 v29, v29, v20
    v_add_f32 v29, v29, v21
    v_mfma_f32_16x16x32_bf16 a[176:179], v[56:59], a[96:99], a[176:179]
    v_perm_b32 v62, v215, v211, s39
    v_perm_b32 v63, v223, v219, s39
    v_add_f32 v29, v29, v22
    v_add_f32 v29, v29, v23
    v_add_f32 v29, v29, v24
    v_add_f32 v29, v29, v25
    v_cvt_pk_bf16_f32 v10, v10, v11
    v_mfma_f32_16x16x32_bf16 a[180:183], v[56:59], a[100:103], a[180:183]
    v_cvt_pk_bf16_f32 v12, v12, v13
    v_cvt_pk_bf16_f32 v14, v14, v15
    v_cvt_pk_bf16_f32 v16, v16, v17
    v_cvt_pk_bf16_f32 v18, v18, v19
    v_cvt_pk_bf16_f32 v20, v20, v21
    v_mfma_f32_16x16x32_bf16 a[184:187], v[60:63], a[96:99], a[184:187]
    v_cvt_pk_bf16_f32 v22, v22, v23
    v_cvt_pk_bf16_f32 v24, v24, v25
    v_accvgpr_write_b32 a112, v10
    v_accvgpr_write_b32 a113, v12
    v_accvgpr_write_b32 a114, v14
    v_mfma_f32_16x16x32_bf16 a[188:191], v[60:63], a[100:103], a[188:191]
    v_accvgpr_write_b32 a115, v16
    v_accvgpr_write_b32 a116, v18
    v_accvgpr_write_b32 a117, v20
    v_accvgpr_write_b32 a118, v22
    v_accvgpr_write_b32 a119, v24
    s_waitcnt vmcnt(0)
    v_perm_b32 v32, v68, v64, s38
    v_perm_b32 v33, v76, v72, s38
    v_perm_b32 v34, v84, v80, s38
    v_perm_b32 v35, v92, v88, s38
    v_perm_b32 v36, v68, v64, s39
    v_perm_b32 v37, v76, v72, s39
    v_mfma_f32_16x16x32_bf16 a[128:131], v[32:35], a[112:115], a[128:131]
    v_perm_b32 v38, v84, v80, s39
    v_perm_b32 v39, v92, v88, s39
    v_mfma_f32_16x16x32_bf16 a[132:135], v[32:35], a[116:119], a[132:135]
    v_perm_b32 v40, v69, v65, s38
    v_perm_b32 v41, v77, v73, s38
    v_mfma_f32_16x16x32_bf16 a[136:139], v[36:39], a[112:115], a[136:139]
    v_perm_b32 v42, v85, v81, s38
    v_perm_b32 v43, v93, v89, s38
    v_mfma_f32_16x16x32_bf16 a[140:143], v[36:39], a[116:119], a[140:143]
    v_perm_b32 v44, v69, v65, s39
    v_perm_b32 v45, v77, v73, s39
    v_mfma_f32_16x16x32_bf16 a[144:147], v[40:43], a[112:115], a[144:147]
    v_perm_b32 v46, v85, v81, s39
    v_perm_b32 v47, v93, v89, s39
    v_mfma_f32_16x16x32_bf16 a[148:151], v[40:43], a[116:119], a[148:151]
    v_perm_b32 v48, v70, v66, s38
    v_perm_b32 v49, v78, v74, s38
    v_mfma_f32_16x16x32_bf16 a[152:155], v[44:47], a[112:115], a[152:155]
    v_perm_b32 v50, v86, v82, s38
    v_perm_b32 v51, v94, v90, s38
    v_mfma_f32_16x16x32_bf16 a[156:159], v[44:47], a[116:119], a[156:159]
    v_perm_b32 v52, v70, v66, s39
    v_perm_b32 v53, v78, v74, s39
    v_mfma_f32_16x16x32_bf16 a[160:163], v[48:51], a[112:115], a[160:163]
    v_perm_b32 v54, v86, v82, s39
    v_perm_b32 v55, v94, v90, s39
    v_mfma_f32_16x16x32_bf16 a[164:167], v[48:51], a[116:119], a[164:167]
    v_perm_b32 v56, v71, v67, s38
    v_perm_b32 v57, v79, v75, s38
    v_mfma_f32_16x16x32_bf16 a[168:171], v[52:55], a[112:115], a[168:171]
    v_perm_b32 v58, v87, v83, s38
    v_perm_b32 v59, v95, v91, s38
    v_mfma_f32_16x16x32_bf16 a[172:175], v[52:55], a[116:119], a[172:175]
    v_perm_b32 v60, v71, v67, s39
    v_perm_b32 v61, v79, v75, s39
    v_mfma_f32_16x16x32_bf16 a[176:179], v[56:59], a[112:115], a[176:179]
    v_perm_b32 v62, v87, v83, s39
    v_perm_b32 v63, v95, v91, s39
    v_mfma_f32_16x16x32_bf16 a[180:183], v[56:59], a[116:119], a[180:183]
    s_nop 0
    v_mfma_f32_16x16x32_bf16 a[184:187], v[60:63], a[112:115], a[184:187]
    v_mfma_f32_16x16x32_bf16 a[188:191], v[60:63], a[116:119], a[188:191]
    v_mov_b32 v10, v28
    s_nop 1
    v_permlane32_swap_b32 v28, v10
    v_add_f32 v28, v28, v10
    v_mov_b32 v10, v28
    s_nop 1
    v_permlane16_swap_b32 v28, v10
    v_add_f32 v28, v28, v10
    v_rcp_f32 v28, v28
    v_mov_b32 v10, v29
    s_nop 1
    v_permlane32_swap_b32 v29, v10
    v_add_f32 v29, v29, v10
    v_mov_b32 v10, v29
    s_nop 1
    v_permlane16_swap_b32 v29, v10
    v_add_f32 v29, v29, v10
    v_rcp_f32 v29, v29
    v_accvgpr_read_b32 v64, a128
    v_accvgpr_read_b32 v65, a136
    v_accvgpr_read_b32 v66, a144
    v_accvgpr_read_b32 v67, a152
    v_accvgpr_read_b32 v68, a160
    v_accvgpr_read_b32 v69, a168
    v_accvgpr_read_b32 v70, a176
    v_accvgpr_read_b32 v71, a184
    v_mul_f32 v64, v64, v28
    v_mul_f32 v65, v65, v28
    v_mul_f32 v66, v66, v28
    v_mul_f32 v67, v67, v28
    v_mul_f32 v68, v68, v28
    v_mul_f32 v69, v69, v28
    v_mul_f32 v70, v70, v28
    v_mul_f32 v71, v71, v28
    v_cvt_pk_bf16_f32 v64, v64, v65
    v_cvt_pk_bf16_f32 v65, v66, v67
    v_cvt_pk_bf16_f32 v66, v68, v69
    v_cvt_pk_bf16_f32 v67, v70, v71
    s_mov_b32 s7, 0x0
    buffer_store_dwordx4 v[64:67], v0, s[64:67], s7 offen sc1
    v_accvgpr_read_b32 v72, a129
    v_accvgpr_read_b32 v73, a137
    v_accvgpr_read_b32 v74, a145
    v_accvgpr_read_b32 v75, a153
    v_accvgpr_read_b32 v76, a161
    v_accvgpr_read_b32 v77, a169
    v_accvgpr_read_b32 v78, a177
    v_accvgpr_read_b32 v79, a185
    v_mul_f32 v72, v72, v28
    v_mul_f32 v73, v73, v28
    v_mul_f32 v74, v74, v28
    v_mul_f32 v75, v75, v28
    v_mul_f32 v76, v76, v28
    v_mul_f32 v77, v77, v28
    v_mul_f32 v78, v78, v28
    v_mul_f32 v79, v79, v28
    v_cvt_pk_bf16_f32 v72, v72, v73
    v_cvt_pk_bf16_f32 v73, v74, v75
    v_cvt_pk_bf16_f32 v74, v76, v77
    v_cvt_pk_bf16_f32 v75, v78, v79
    s_mov_b32 s7, 0x800
    buffer_store_dwordx4 v[72:75], v0, s[64:67], s7 offen sc1
    v_accvgpr_read_b32 v80, a130
    v_accvgpr_read_b32 v81, a138
    v_accvgpr_read_b32 v82, a146
    v_accvgpr_read_b32 v83, a154
    v_accvgpr_read_b32 v84, a162
    v_accvgpr_read_b32 v85, a170
    v_accvgpr_read_b32 v86, a178
    v_accvgpr_read_b32 v87, a186
    v_mul_f32 v80, v80, v28
    v_mul_f32 v81, v81, v28
    v_mul_f32 v82, v82, v28
    v_mul_f32 v83, v83, v28
    v_mul_f32 v84, v84, v28
    v_mul_f32 v85, v85, v28
    v_mul_f32 v86, v86, v28
    v_mul_f32 v87, v87, v28
    v_cvt_pk_bf16_f32 v80, v80, v81
    v_cvt_pk_bf16_f32 v81, v82, v83
    v_cvt_pk_bf16_f32 v82, v84, v85
    v_cvt_pk_bf16_f32 v83, v86, v87
    s_mov_b32 s7, 0x1000
    buffer_store_dwordx4 v[80:83], v0, s[64:67], s7 offen sc1
    v_accvgpr_read_b32 v88, a131
    v_accvgpr_read_b32 v89, a139
    v_accvgpr_read_b32 v90, a147
    v_accvgpr_read_b32 v91, a155
    v_accvgpr_read_b32 v92, a163
    v_accvgpr_read_b32 v93, a171
    v_accvgpr_read_b32 v94, a179
    v_accvgpr_read_b32 v95, a187
    v_mul_f32 v88, v88, v28
    v_mul_f32 v89, v89, v28
    v_mul_f32 v90, v90, v28
    v_mul_f32 v91, v91, v28
    v_mul_f32 v92, v92, v28
    v_mul_f32 v93, v93, v28
    v_mul_f32 v94, v94, v28
    v_mul_f32 v95, v95, v28
    v_cvt_pk_bf16_f32 v88, v88, v89
    v_cvt_pk_bf16_f32 v89, v90, v91
    v_cvt_pk_bf16_f32 v90, v92, v93
    v_cvt_pk_bf16_f32 v91, v94, v95
    s_mov_b32 s7, 0x1800
    buffer_store_dwordx4 v[88:91], v0, s[64:67], s7 offen sc1
    v_accvgpr_read_b32 v96, a132
    v_accvgpr_read_b32 v97, a140
    v_accvgpr_read_b32 v98, a148
    v_accvgpr_read_b32 v99, a156
    v_accvgpr_read_b32 v100, a164
    v_accvgpr_read_b32 v101, a172
    v_accvgpr_read_b32 v102, a180
    v_accvgpr_read_b32 v103, a188
    v_mul_f32 v96, v96, v29
    v_mul_f32 v97, v97, v29
    v_mul_f32 v98, v98, v29
    v_mul_f32 v99, v99, v29
    v_mul_f32 v100, v100, v29
    v_mul_f32 v101, v101, v29
    v_mul_f32 v102, v102, v29
    v_mul_f32 v103, v103, v29
    v_cvt_pk_bf16_f32 v96, v96, v97
    v_cvt_pk_bf16_f32 v97, v98, v99
    v_cvt_pk_bf16_f32 v98, v100, v101
    v_cvt_pk_bf16_f32 v99, v102, v103
    s_mov_b32 s7, 0x400
    buffer_store_dwordx4 v[96:99], v0, s[64:67], s7 offen sc1
    v_accvgpr_read_b32 v104, a133
    v_accvgpr_read_b32 v105, a141
    v_accvgpr_read_b32 v106, a149
    v_accvgpr_read_b32 v107, a157
    v_accvgpr_read_b32 v108, a165
    v_accvgpr_read_b32 v109, a173
    v_accvgpr_read_b32 v110, a181
    v_accvgpr_read_b32 v111, a189
    v_mul_f32 v104, v104, v29
    v_mul_f32 v105, v105, v29
    v_mul_f32 v106, v106, v29
    v_mul_f32 v107, v107, v29
    v_mul_f32 v108, v108, v29
    v_mul_f32 v109, v109, v29
    v_mul_f32 v110, v110, v29
    v_mul_f32 v111, v111, v29
    v_cvt_pk_bf16_f32 v104, v104, v105
    v_cvt_pk_bf16_f32 v105, v106, v107
    v_cvt_pk_bf16_f32 v106, v108, v109
    v_cvt_pk_bf16_f32 v107, v110, v111
    s_mov_b32 s7, 0xc00
    buffer_store_dwordx4 v[104:107], v0, s[64:67], s7 offen sc1
    v_accvgpr_read_b32 v112, a134
    v_accvgpr_read_b32 v113, a142
    v_accvgpr_read_b32 v114, a150
    v_accvgpr_read_b32 v115, a158
    v_accvgpr_read_b32 v116, a166
    v_accvgpr_read_b32 v117, a174
    v_accvgpr_read_b32 v118, a182
    v_accvgpr_read_b32 v119, a190
    v_mul_f32 v112, v112, v29
    v_mul_f32 v113, v113, v29
    v_mul_f32 v114, v114, v29
    v_mul_f32 v115, v115, v29
    v_mul_f32 v116, v116, v29
    v_mul_f32 v117, v117, v29
    v_mul_f32 v118, v118, v29
    v_mul_f32 v119, v119, v29
    v_cvt_pk_bf16_f32 v112, v112, v113
    v_cvt_pk_bf16_f32 v113, v114, v115
    v_cvt_pk_bf16_f32 v114, v116, v117
    v_cvt_pk_bf16_f32 v115, v118, v119
    s_mov_b32 s7, 0x1400
    buffer_store_dwordx4 v[112:115], v0, s[64:67], s7 offen sc1
    v_accvgpr_read_b32 v120, a135
    v_accvgpr_read_b32 v121, a143
    v_accvgpr_read_b32 v122, a151
    v_accvgpr_read_b32 v123, a159
    v_accvgpr_read_b32 v124, a167
    v_accvgpr_read_b32 v125, a175
    v_accvgpr_read_b32 v126, a183
    v_accvgpr_read_b32 v127, a191
    v_mul_f32 v120, v120, v29
    v_mul_f32 v121, v121, v29
    v_mul_f32 v122, v122, v29
    v_mul_f32 v123, v123, v29
    v_mul_f32 v124, v124, v29
    v_mul_f32 v125, v125, v29
    v_mul_f32 v126, v126, v29
    v_mul_f32 v127, v127, v29
    v_cvt_pk_bf16_f32 v120, v120, v121
    v_cvt_pk_bf16_f32 v121, v122, v123
    v_cvt_pk_bf16_f32 v122, v124, v125
    v_cvt_pk_bf16_f32 v123, v126, v127
    s_mov_b32 s7, 0x1c00
    buffer_store_dwordx4 v[120:123], v0, s[64:67], s7 offen sc1
    s_lshl_b32 s6, s4, 2
    s_add_u32 s6, s6, s3
    s_lshl_b32 s6, s6, 17
    s_lshl_b32 s7, s37, 8
    s_add_u32 s6, s6, s7
    s_sub_u32 s7, 0x400000, s6
    s_add_u32 s40, s26, s6
    s_addc_u32 s41, s27, 0
    s_and_b32 s41, s41, 0xffff
    s_mov_b32 s42, s7
    s_mov_b32 s43, 0x20000
    s_waitcnt vmcnt(0)
    v_mov_b32 v10, 1
    s_mov_b64 exec, 1
    buffer_store_dword v10, v8, s[68:71], s80 offen sc1
    s_mov_b64 exec, -1
    s_mov_b32 s97, 0x0
    buffer_load_dwordx4 v[128:131], v4, s[40:43], s97 offen
    s_mov_b32 s97, 0x400
    buffer_load_dwordx4 v[132:135], v4, s[40:43], s97 offen
    s_mov_b32 s97, 0x800
    buffer_load_dwordx4 v[136:139], v4, s[40:43], s97 offen
    s_mov_b32 s97, 0xc00
    buffer_load_dwordx4 v[140:143], v4, s[40:43], s97 offen
    s_mov_b32 s97, 0x1000
    buffer_load_dwordx4 v[144:147], v4, s[40:43], s97 offen
    s_mov_b32 s97, 0x1400
    buffer_load_dwordx4 v[148:151], v4, s[40:43], s97 offen
    s_mov_b32 s97, 0x1800
    buffer_load_dwordx4 v[152:155], v4, s[40:43], s97 offen
    s_mov_b32 s97, 0x1c00
    buffer_load_dwordx4 v[156:159], v4, s[40:43], s97 offen
    s_mov_b32 s97, 0x2000
    buffer_load_dwordx4 v[160:163], v4, s[40:43], s97 offen
    s_mov_b32 s97, 0x2400
    buffer_load_dwordx4 v[164:167], v4, s[40:43], s97 offen
    s_mov_b32 s97, 0x2800
    buffer_load_dwordx4 v[168:171], v4, s[40:43], s97 offen
    s_mov_b32 s97, 0x2c00
    buffer_load_dwordx4 v[172:175], v4, s[40:43], s97 offen
    s_mov_b32 s97, 0x3000
    buffer_load_dwordx4 v[176:179], v4, s[40:43], s97 offen
    s_mov_b32 s97, 0x3400
    buffer_load_dwordx4 v[180:183], v4, s[40:43], s97 offen
    s_mov_b32 s97, 0x3800
    buffer_load_dwordx4 v[184:187], v4, s[40:43], s97 offen
    s_mov_b32 s97, 0x3c00
    buffer_load_dwordx4 v[188:191], v4, s[40:43], s97 offen
    s_mov_b32 s97, 0x4000
    buffer_load_dwordx4 v[192:195], v4, s[40:43], s97 offen
    s_mov_b32 s97, 0x4400
    buffer_load_dwordx4 v[196:199], v4, s[40:43], s97 offen
    s_mov_b32 s97, 0x4800
    buffer_load_dwordx4 v[200:203], v4, s[40:43], s97 offen
    s_mov_b32 s97, 0x4c00
    buffer_load_dwordx4 v[204:207], v4, s[40:43], s97 offen
    s_mov_b32 s97, 0x5000
    buffer_load_dwordx4 v[208:211], v4, s[40:43], s97 offen
    s_mov_b32 s97, 0x5400
    buffer_load_dwordx4 v[212:215], v4, s[40:43], s97 offen
    s_mov_b32 s97, 0x5800
    buffer_load_dwordx4 v[216:219], v4, s[40:43], s97 offen
    s_mov_b32 s97, 0x5c00
    buffer_load_dwordx4 v[220:223], v4, s[40:43], s97 offen
    s_mov_b32 s97, 0x6000
    buffer_load_dwordx4 v[32:35], v4, s[40:43], s97 offen
    s_mov_b32 s97, 0x6400
    buffer_load_dwordx4 v[36:39], v4, s[40:43], s97 offen
    s_mov_b32 s97, 0x6800
    buffer_load_dwordx4 v[40:43], v4, s[40:43], s97 offen
    s_mov_b32 s97, 0x6c00
    buffer_load_dwordx4 v[44:47], v4, s[40:43], s97 offen
    s_mov_b32 s97, 0x7000
    buffer_load_dwordx4 v[48:51], v4, s[40:43], s97 offen
    s_mov_b32 s97, 0x7400
    buffer_load_dwordx4 v[52:55], v4, s[40:43], s97 offen
    s_mov_b32 s97, 0x7800
    buffer_load_dwordx4 v[56:59], v4, s[40:43], s97 offen
    s_mov_b32 s97, 0x7c00
    buffer_load_dwordx4 v[60:63], v4, s[40:43], s97 offen
    s_mov_b32 s100, 0x01010101
    v_cmp_ne_u32 vcc, s100, v30
    s_nop 4
    s_cmp_eq_u64 vcc, 0
    s_cbranch_scc1 CERT_OKB
    s_mov_b32 s100, 0x1010101
    s_mov_b32 s101, 20000
    s_nop 4
PG1:
    buffer_load_dword v10, v9, s[72:75], 0 offen sc1
    s_waitcnt vmcnt(0)
    v_cmp_ne_u32 vcc, s100, v10
    s_nop 4
    s_cmp_eq_u64 vcc, 0
    s_cbranch_scc1 PG1_done
    s_sleep 1
    s_sub_u32 s101, s101, 1
    s_cbranch_scc0 PG1
PG1_done:
CERT_OKB:
    s_waitcnt vmcnt(24)
    v_perm_b32 v224, v132, v128, s38
    v_perm_b32 v225, v140, v136, s38
    v_perm_b32 v226, v148, v144, s38
    v_perm_b32 v227, v156, v152, s38
    ds_write_b128 v5, v[224:227]
    v_perm_b32 v228, v132, v128, s39
    v_perm_b32 v229, v140, v136, s39
    v_perm_b32 v230, v148, v144, s39
    v_perm_b32 v231, v156, v152, s39
    ds_write_b128 v5, v[228:231] offset:1024
    v_perm_b32 v232, v133, v129, s38
    v_perm_b32 v233, v141, v137, s38
    v_perm_b32 v234, v149, v145, s38
    v_perm_b32 v235, v157, v153, s38
    ds_write_b128 v5, v[232:235] offset:2048
    v_perm_b32 v236, v133, v129, s39
    v_perm_b32 v237, v141, v137, s39
    v_perm_b32 v238, v149, v145, s39
    v_perm_b32 v239, v157, v153, s39
    ds_write_b128 v5, v[236:239] offset:3072
    v_perm_b32 v240, v134, v130, s38
    v_perm_b32 v241, v142, v138, s38
    v_perm_b32 v242, v150, v146, s38
    v_perm_b32 v243, v158, v154, s38
    ds_write_b128 v5, v[240:243] offset:4096
    v_perm_b32 v244, v134, v130, s39
    v_perm_b32 v245, v142, v138, s39
    v_perm_b32 v246, v150, v146, s39
    v_perm_b32 v247, v158, v154, s39
    ds_write_b128 v5, v[244:247] offset:5120
    v_perm_b32 v248, v135, v131, s38
    v_perm_b32 v249, v143, v139, s38
    v_perm_b32 v250, v151, v147, s38
    v_perm_b32 v251, v159, v155, s38
    ds_write_b128 v5, v[248:251] offset:6144
    v_perm_b32 v252, v135, v131, s39
    v_perm_b32 v253, v143, v139, s39
    v_perm_b32 v254, v151, v147, s39
    v_perm_b32 v255, v159, v155, s39
    ds_write_b128 v5, v[252:255] offset:7168
    s_waitcnt vmcnt(16)
    v_perm_b32 v64, v164, v160, s38
    v_perm_b32 v65, v172, v168, s38
    v_perm_b32 v66, v180, v176, s38
    v_perm_b32 v67, v188, v184, s38
    ds_write_b128 v5, v[64:67] offset:8192
    v_perm_b32 v68, v164, v160, s39
    v_perm_b32 v69, v172, v168, s39
    v_perm_b32 v70, v180, v176, s39
    v_perm_b32 v71, v188, v184, s39
    ds_write_b128 v5, v[68:71] offset:9216
    v_perm_b32 v72, v165, v161, s38
    v_perm_b32 v73, v173, v169, s38
    v_perm_b32 v74, v181, v177, s38
    v_perm_b32 v75, v189, v185, s38
    ds_write_b128 v5, v[72:75] offset:10240
    v_perm_b32 v76, v165, v161, s39
    v_perm_b32 v77, v173, v169, s39
    v_perm_b32 v78, v181, v177, s39
    v_perm_b32 v79, v189, v185, s39
    ds_write_b128 v5, v[76:79] offset:11264
    v_perm_b32 v80, v166, v162, s38
    v_perm_b32 v81, v174, v170, s38
    v_perm_b32 v82, v182, v178, s38
    v_perm_b32 v83, v190, v186, s38
    ds_write_b128 v5, v[80:83] offset:12288
    v_perm_b32 v84, v166, v162, s39
    v_perm_b32 v85, v174, v170, s39
    v_perm_b32 v86, v182, v178, s39
    v_perm_b32 v87, v190, v186, s39
    ds_write_b128 v5, v[84:87] offset:13312
    v_perm_b32 v88, v167, v163, s38
    v_perm_b32 v89, v175, v171, s38
    v_perm_b32 v90, v183, v179, s38
    v_perm_b32 v91, v191, v187, s38
    ds_write_b128 v5, v[88:91] offset:14336
    v_perm_b32 v92, v167, v163, s39
    v_perm_b32 v93, v175, v171, s39
    v_perm_b32 v94, v183, v179, s39
    v_perm_b32 v95, v191, v187, s39
    ds_write_b128 v5, v[92:95] offset:15360
    s_waitcnt vmcnt(8)
    s_waitcnt lgkmcnt(8)
    v_perm_b32 v224, v196, v192, s38
    v_perm_b32 v225, v204, v200, s38
    v_perm_b32 v226, v212, v208, s38
    v_perm_b32 v227, v220, v216, s38
    ds_write_b128 v5, v[224:227] offset:16384
    v_perm_b32 v228, v196, v192, s39
    v_perm_b32 v229, v204, v200, s39
    v_perm_b32 v230, v212, v208, s39
    v_perm_b32 v231, v220, v216, s39
    ds_write_b128 v5, v[228:231] offset:17408
    v_perm_b32 v232, v197, v193, s38
    v_perm_b32 v233, v205, v201, s38
    v_perm_b32 v234, v213, v209, s38
    v_perm_b32 v235, v221, v217, s38
    ds_write_b128 v5, v[232:235] offset:18432
    v_perm_b32 v236, v197, v193, s39
    v_perm_b32 v237, v205, v201, s39
    v_perm_b32 v238, v213, v209, s39
    v_perm_b32 v239, v221, v217, s39
    ds_write_b128 v5, v[236:239] offset:19456
    v_perm_b32 v240, v198, v194, s38
    v_perm_b32 v241, v206, v202, s38
    v_perm_b32 v242, v214, v210, s38
    v_perm_b32 v243, v222, v218, s38
    ds_write_b128 v5, v[240:243] offset:20480
    v_perm_b32 v244, v198, v194, s39
    v_perm_b32 v245, v206, v202, s39
    v_perm_b32 v246, v214, v210, s39
    v_perm_b32 v247, v222, v218, s39
    ds_write_b128 v5, v[244:247] offset:21504
    v_perm_b32 v248, v199, v195, s38
    v_perm_b32 v249, v207, v203, s38
    v_perm_b32 v250, v215, v211, s38
    v_perm_b32 v251, v223, v219, s38
    ds_write_b128 v5, v[248:251] offset:22528
    v_perm_b32 v252, v199, v195, s39
    v_perm_b32 v253, v207, v203, s39
    v_perm_b32 v254, v215, v211, s39
    v_perm_b32 v255, v223, v219, s39
    ds_write_b128 v5, v[252:255] offset:23552
    s_waitcnt vmcnt(0)
    s_waitcnt lgkmcnt(8)
    v_perm_b32 v64, v36, v32, s38
    v_perm_b32 v65, v44, v40, s38
    v_perm_b32 v66, v52, v48, s38
    v_perm_b32 v67, v60, v56, s38
    ds_write_b128 v5, v[64:67] offset:24576
    v_perm_b32 v68, v36, v32, s39
    v_perm_b32 v69, v44, v40, s39
    v_perm_b32 v70, v52, v48, s39
    v_perm_b32 v71, v60, v56, s39
    ds_write_b128 v5, v[68:71] offset:25600
    v_perm_b32 v72, v37, v33, s38
    v_perm_b32 v73, v45, v41, s38
    v_perm_b32 v74, v53, v49, s38
    v_perm_b32 v75, v61, v57, s38
    ds_write_b128 v5, v[72:75] offset:26624
    v_perm_b32 v76, v37, v33, s39
    v_perm_b32 v77, v45, v41, s39
    v_perm_b32 v78, v53, v49, s39
    v_perm_b32 v79, v61, v57, s39
    ds_write_b128 v5, v[76:79] offset:27648
    v_perm_b32 v80, v38, v34, s38
    v_perm_b32 v81, v46, v42, s38
    v_perm_b32 v82, v54, v50, s38
    v_perm_b32 v83, v62, v58, s38
    ds_write_b128 v5, v[80:83] offset:28672
    v_perm_b32 v84, v38, v34, s39
    v_perm_b32 v85, v46, v42, s39
    v_perm_b32 v86, v54, v50, s39
    v_perm_b32 v87, v62, v58, s39
    ds_write_b128 v5, v[84:87] offset:29696
    v_perm_b32 v88, v39, v35, s38
    v_perm_b32 v89, v47, v43, s38
    v_perm_b32 v90, v55, v51, s38
    v_perm_b32 v91, v63, v59, s38
    ds_write_b128 v5, v[88:91] offset:30720
    v_perm_b32 v92, v39, v35, s39
    v_perm_b32 v93, v47, v43, s39
    v_perm_b32 v94, v55, v51, s39
    v_perm_b32 v95, v63, v59, s39
    ds_write_b128 v5, v[92:95] offset:31744
    s_waitcnt vmcnt(0) lgkmcnt(0)
    s_branch OPROJ
A_PATH:
    s_mov_b32 s35, s5
    s_lshl_b32 s7, s4, 2
    s_add_u32 s36, s3, s7
    s_lshl_b32 s82, s37, 20
    s_xor_b32 s6, s3, s37
    s_lshl_b32 s6, s6, 8
    s_lshl_b32 s7, s35, 15
    s_sub_u32 s90, 0x8000, s6
    s_add_u32 s6, s6, s7
    s_add_u32 s44, s8, s6
    s_addc_u32 s45, s9, 0
    s_and_b32 s45, s45, 0xffff
    s_mov_b32 s46, s90
    s_mov_b32 s47, 0x20000
    s_lshl_b32 s6, s36, 8
    s_sub_u32 s7, 0x400000, s6
    s_add_u32 s40, s14, s6
    s_addc_u32 s41, s15, 0
    s_and_b32 s41, s41, 0xffff
    s_mov_b32 s42, s7
    s_mov_b32 s43, 0x20000
    s_add_u32 m0, s98, 0x6180
    s_mov_b32 s97, 0x0
    buffer_load_dwordx4 v1, s[44:47], s97 offen lds
    s_add_u32 m0, s98, 0x6590
    s_mov_b32 s97, 0x1000
    buffer_load_dwordx4 v1, s[44:47], s97 offen lds
    s_add_u32 m0, s98, 0x69a0
    s_mov_b32 s97, 0x2000
    buffer_load_dwordx4 v1, s[44:47], s97 offen lds
    s_add_u32 m0, s98, 0x6db0
    s_mov_b32 s97, 0x3000
    buffer_load_dwordx4 v1, s[44:47], s97 offen lds
    s_add_u32 m0, s98, 0x71c0
    s_mov_b32 s97, 0x4000
    buffer_load_dwordx4 v1, s[44:47], s97 offen lds
    s_add_u32 m0, s98, 0x75d0
    s_mov_b32 s97, 0x5000
    buffer_load_dwordx4 v1, s[44:47], s97 offen lds
    s_add_u32 m0, s98, 0x79e0
    s_mov_b32 s97, 0x6000
    buffer_load_dwordx4 v1, s[44:47], s97 offen lds
    s_add_u32 m0, s98, 0x7df0
    s_mov_b32 s97, 0x7000
    buffer_load_dwordx4 v1, s[44:47], s97 offen lds
    s_xor_b32 s97, s82, 0x0
    buffer_load_dwordx4 v[64:67], v3, s[40:43], s97 offen
    s_xor_b32 s97, s82, 0x2000
    buffer_load_dwordx4 v[68:71], v3, s[40:43], s97 offen
    s_xor_b32 s97, s82, 0x4000
    buffer_load_dwordx4 v[72:75], v3, s[40:43], s97 offen
    s_xor_b32 s97, s82, 0x6000
    buffer_load_dwordx4 v[76:79], v3, s[40:43], s97 offen
    s_xor_b32 s97, s82, 0x8000
    buffer_load_dwordx4 v[80:83], v3, s[40:43], s97 offen
    s_xor_b32 s97, s82, 0xa000
    buffer_load_dwordx4 v[84:87], v3, s[40:43], s97 offen
    s_xor_b32 s97, s82, 0xc000
    buffer_load_dwordx4 v[88:91], v3, s[40:43], s97 offen
    s_xor_b32 s97, s82, 0xe000
    buffer_load_dwordx4 v[92:95], v3, s[40:43], s97 offen
    s_xor_b32 s97, s82, 0x10000
    buffer_load_dwordx4 v[96:99], v3, s[40:43], s97 offen
    s_xor_b32 s97, s82, 0x12000
    buffer_load_dwordx4 v[100:103], v3, s[40:43], s97 offen
    s_xor_b32 s97, s82, 0x14000
    buffer_load_dwordx4 v[104:107], v3, s[40:43], s97 offen
    s_xor_b32 s97, s82, 0x16000
    buffer_load_dwordx4 v[108:111], v3, s[40:43], s97 offen
    s_xor_b32 s97, s82, 0x18000
    buffer_load_dwordx4 v[112:115], v3, s[40:43], s97 offen
    s_xor_b32 s97, s82, 0x1a000
    buffer_load_dwordx4 v[116:119], v3, s[40:43], s97 offen
    s_xor_b32 s97, s82, 0x1c000
    buffer_load_dwordx4 v[120:123], v3, s[40:43], s97 offen
    s_xor_b32 s97, s82, 0x1e000
    buffer_load_dwordx4 v[124:127], v3, s[40:43], s97 offen
    s_add_u32 s6, s35, 0
    s_lshl_b32 s6, s6, 5
    s_add_u32 s6, s6, s36
    s_lshr_b32 s7, s6, 2
    s_lshl_b32 s7, s7, 7
    s_and_b32 s80, s36, 3
    s_lshl_b32 s80, s80, 2
    s_add_u32 s80, s80, s7
    s_lshl_b32 s6, s6, 13
    s_add_u32 s6, s6, 0x800000
    s_add_u32 s64, s32, s6
    s_addc_u32 s65, s33, 0
    s_and_b32 s65, s65, 0xffff
    s_mov_b32 s66, 8192
    s_mov_b32 s67, 0x20000
    s_add_u32 s6, s34, 0
    s_lshl_b32 s6, s6, 2
    s_add_u32 s6, s6, s37
    s_lshl_b32 s6, s6, 5
    s_add_u32 s6, s6, s4
    s_lshl_b32 s6, s6, 2
    s_add_u32 s81, s6, 32768
    s_mov_b32 s6, 0x2800000
    s_add_u32 s68, s32, s6
    s_addc_u32 s69, s33, 0
    s_and_b32 s69, s69, 0xffff
    s_mov_b32 s70, 49152
    s_mov_b32 s71, 0x20000
    s_mov_b64 exec, 1
    buffer_store_dword v8, v8, s[68:71], s80 offen sc1
    s_mov_b64 exec, -1
    s_mov_b64 exec, 1
    buffer_store_dword v8, v8, s[68:71], s81 offen sc1
    s_mov_b64 exec, -1
    s_mov_b32 s6, 0
    s_add_u32 s72, s30, s6
    s_addc_u32 s73, s31, 0
    s_and_b32 s73, s73, 0xffff
    s_mov_b32 s74, 256
    s_mov_b32 s75, 0x20000
    s_lshl_b32 s90, s35, 20
    s_lshl_b32 s7, s4, 17
    s_add_u32 s90, s90, s7
    s_add_u32 s52, s10, s90
    s_addc_u32 s53, s11, 0
    s_and_b32 s53, s53, 0xffff
    s_mov_b32 s54, 131072
    s_mov_b32 s55, 0x20000
    s_add_u32 s56, s12, s90
    s_addc_u32 s57, s13, 0
    s_and_b32 s57, s57, 0xffff
    s_mov_b32 s58, 131072
    s_mov_b32 s59, 0x20000
    s_mul_i32 s7, s4, 3
    s_mul_i32 s91, s35, 5
    s_add_u32 s7, s7, s91
    s_and_b32 s7, s7, 31
    s_lshl_b32 s6, s3, 1
    s_xor_b32 s7, s7, s6
    s_lshl_b32 s99, s7, 12
    s_lshl_b32 s6, s4, 2
    s_add_u32 s6, s6, s37
    s_mul_i32 s7, s6, 3
    s_mul_i32 s91, s34, 5
    s_add_u32 s7, s7, s91
    s_and_b32 s7, s7, 30
    s_lshl_b32 s83, s7, 12
    s_lshl_b32 s6, s6, 17
    s_lshl_b32 s7, s34, 22
    s_add_u32 s6, s6, s7
    s_add_u32 s76, s20, s6
    s_addc_u32 s77, s21, 0
    s_and_b32 s77, s77, 0xffff
    s_mov_b32 s78, 131072
    s_mov_b32 s79, 0x20000
    s_add_u32 s48, s22, s6
    s_addc_u32 s49, s23, 0
    s_and_b32 s49, s49, 0xffff
    s_mov_b32 s50, 131072
    s_mov_b32 s51, 0x20000
    v_lshlrev_b32 v24, 3, v0
    s_add_u32 m0, s98, 0x0
    s_xor_b32 s97, s99, 0x0
    buffer_load_dwordx4 v1, s[52:55], s97 offen nt lds
    s_add_u32 m0, s98, 0x310
    s_xor_b32 s97, s99, 0x0
    buffer_load_dwordx4 v1, s[52:55], s97 offen offset:256 nt lds
    s_add_u32 m0, s98, 0x620
    s_xor_b32 s97, s99, 0x0
    buffer_load_dwordx4 v1, s[52:55], s97 offen offset:512 nt lds
    s_add_u32 m0, s98, 0x930
    s_xor_b32 s97, s99, 0x0
    buffer_load_dwordx4 v1, s[52:55], s97 offen offset:768 nt lds
    s_add_u32 m0, s98, 0x1040
    s_xor_b32 s97, s99, 0x1000
    buffer_load_dwordx4 v1, s[52:55], s97 offen nt lds
    s_add_u32 m0, s98, 0x1350
    s_xor_b32 s97, s99, 0x1000
    buffer_load_dwordx4 v1, s[52:55], s97 offen offset:256 nt lds
    s_add_u32 m0, s98, 0x1660
    s_xor_b32 s97, s99, 0x1000
    buffer_load_dwordx4 v1, s[52:55], s97 offen offset:512 nt lds
    s_add_u32 m0, s98, 0x1970
    s_xor_b32 s97, s99, 0x1000
    buffer_load_dwordx4 v1, s[52:55], s97 offen offset:768 nt lds
    s_xor_b32 s97, s82, 0x20000
    buffer_load_dwordx4 v[128:131], v3, s[40:43], s97 offen
    s_xor_b32 s97, s82, 0x22000
    buffer_load_dwordx4 v[132:135], v3, s[40:43], s97 offen
    s_xor_b32 s97, s82, 0x24000
    buffer_load_dwordx4 v[136:139], v3, s[40:43], s97 offen
    s_xor_b32 s97, s82, 0x26000
    buffer_load_dwordx4 v[140:143], v3, s[40:43], s97 offen
    s_xor_b32 s97, s82, 0x28000
    buffer_load_dwordx4 v[144:147], v3, s[40:43], s97 offen
    s_xor_b32 s97, s82, 0x2a000
    buffer_load_dwordx4 v[148:151], v3, s[40:43], s97 offen
    s_xor_b32 s97, s82, 0x2c000
    buffer_load_dwordx4 v[152:155], v3, s[40:43], s97 offen
    s_xor_b32 s97, s82, 0x2e000
    buffer_load_dwordx4 v[156:159], v3, s[40:43], s97 offen
    s_xor_b32 s97, s82, 0x30000
    buffer_load_dwordx4 v[160:163], v3, s[40:43], s97 offen
    s_xor_b32 s97, s82, 0x32000
    buffer_load_dwordx4 v[164:167], v3, s[40:43], s97 offen
    s_xor_b32 s97, s82, 0x34000
    buffer_load_dwordx4 v[168:171], v3, s[40:43], s97 offen
    s_xor_b32 s97, s82, 0x36000
    buffer_load_dwordx4 v[172:175], v3, s[40:43], s97 offen
    s_xor_b32 s97, s82, 0x38000
    buffer_load_dwordx4 v[176:179], v3, s[40:43], s97 offen
    s_xor_b32 s97, s82, 0x3a000
    buffer_load_dwordx4 v[180:183], v3, s[40:43], s97 offen
    s_waitcnt vmcnt(40)
    s_waitcnt vmcnt(22)
    s_barrier
    v_mov_b32 v10, 1
    s_cmp_eq_u32 s3, 0
    s_cselect_b64 exec, 1, 0
    s_cbranch_scc0 NOCERTA
    buffer_store_byte v10, v8, s[72:75], s2 offen sc1
NOCERTA:
    s_mov_b64 exec, -1
    s_sub_u32 s6, 0, s98
    v_add_u32 v25, s6, v2
    ds_read_b128 a[0:3], v25 offset:24960
    ds_read_b128 a[4:7], v25 offset:24976
    ds_read_b128 a[8:11], v25 offset:24992
    ds_read_b128 a[12:15], v25 offset:25008
    ds_read_b128 a[16:19], v25 offset:29120
    ds_read_b128 a[20:23], v25 offset:29136
    ds_read_b128 a[24:27], v25 offset:29152
    ds_read_b128 a[28:31], v25 offset:29168
    s_sub_u32 s6, 33280, s98
    v_add_u32 v25, s6, v2
    ds_read_b128 a[32:35], v25 offset:24960
    ds_read_b128 a[36:39], v25 offset:24976
    ds_read_b128 a[40:43], v25 offset:24992
    ds_read_b128 a[44:47], v25 offset:25008
    ds_read_b128 a[48:51], v25 offset:29120
    ds_read_b128 a[52:55], v25 offset:29136
    ds_read_b128 a[56:59], v25 offset:29152
    ds_read_b128 a[60:63], v25 offset:29168
    s_sub_u32 s6, 66560, s98
    v_add_u32 v25, s6, v2
    ds_read_b128 a[64:67], v25 offset:24960
    ds_read_b128 a[68:71], v25 offset:24976
    ds_read_b128 a[72:75], v25 offset:24992
    ds_read_b128 a[76:79], v25 offset:25008
    ds_read_b128 a[80:83], v25 offset:29120
    ds_read_b128 a[84:87], v25 offset:29136
    ds_read_b128 a[88:91], v25 offset:29152
    ds_read_b128 a[92:95], v25 offset:29168
    s_sub_u32 s6, 99840, s98
    v_add_u32 v25, s6, v2
    ds_read_b128 a[96:99], v25 offset:24960
    ds_read_b128 a[100:103], v25 offset:24976
    ds_read_b128 a[104:107], v25 offset:24992
    ds_read_b128 a[108:111], v25 offset:25008
    ds_read_b128 a[112:115], v25 offset:29120
    ds_read_b128 a[116:119], v25 offset:29136
    ds_read_b128 a[120:123], v25 offset:29152
    ds_read_b128 a[124:127], v25 offset:29168
    s_waitcnt lgkmcnt(0)
    s_barrier
    s_xor_b32 s97, s82, 0x3c000
    buffer_load_dwordx4 v[184:187], v3, s[40:43], s97 offen
    s_xor_b32 s97, s82, 0x3e000
    buffer_load_dwordx4 v[188:191], v3, s[40:43], s97 offen
    s_add_u32 m0, s98, 0x2080
    s_xor_b32 s97, s99, 0x8000
    buffer_load_dwordx4 v1, s[52:55], s97 offen nt lds
    s_add_u32 m0, s98, 0x2390
    s_xor_b32 s97, s99, 0x8000
    buffer_load_dwordx4 v1, s[52:55], s97 offen offset:256 nt lds
    s_add_u32 m0, s98, 0x26a0
    s_xor_b32 s97, s99, 0x8000
    buffer_load_dwordx4 v1, s[52:55], s97 offen offset:512 nt lds
    s_add_u32 m0, s98, 0x29b0
    s_xor_b32 s97, s99, 0x8000
    buffer_load_dwordx4 v1, s[52:55], s97 offen offset:768 nt lds
    s_add_u32 m0, s98, 0x30c0
    s_xor_b32 s97, s99, 0x9000
    buffer_load_dwordx4 v1, s[52:55], s97 offen nt lds
    s_add_u32 m0, s98, 0x33d0
    s_xor_b32 s97, s99, 0x9000
    buffer_load_dwordx4 v1, s[52:55], s97 offen offset:256 nt lds
    s_add_u32 m0, s98, 0x36e0
    s_xor_b32 s97, s99, 0x9000
    buffer_load_dwordx4 v1, s[52:55], s97 offen offset:512 nt lds
    s_add_u32 m0, s98, 0x39f0
    s_xor_b32 s97, s99, 0x9000
    buffer_load_dwordx4 v1, s[52:55], s97 offen offset:768 nt lds
    v_perm_b32 v32, v68, v64, s38
    v_perm_b32 v33, v76, v72, s38
    v_perm_b32 v34, v84, v80, s38
    v_perm_b32 v35, v92, v88, s38
    v_perm_b32 v36, v68, v64, s39
    v_perm_b32 v37, v76, v72, s39
    v_mfma_f32_16x16x32_bf16 a[128:131], v[32:35], a[0:3], 0
    v_perm_b32 v38, v84, v80, s39
    v_perm_b32 v39, v92, v88, s39
    v_mfma_f32_16x16x32_bf16 a[132:135], v[32:35], a[16:19], 0
    s_xor_b32 s97, s82, 0x100000
    buffer_load_dwordx4 v[192:195], v3, s[40:43], s97 offen
    v_perm_b32 v40, v69, v65, s38
    v_perm_b32 v41, v77, v73, s38
    v_mfma_f32_16x16x32_bf16 a[136:139], v[36:39], a[0:3], 0
    v_perm_b32 v42, v85, v81, s38
    v_perm_b32 v43, v93, v89, s38
    v_mfma_f32_16x16x32_bf16 a[140:143], v[36:39], a[16:19], 0
    v_perm_b32 v44, v69, v65, s39
    v_perm_b32 v45, v77, v73, s39
    v_mfma_f32_16x16x32_bf16 a[144:147], v[40:43], a[0:3], 0
    s_xor_b32 s97, s82, 0x102000
    buffer_load_dwordx4 v[196:199], v3, s[40:43], s97 offen
    v_perm_b32 v46, v85, v81, s39
    v_perm_b32 v47, v93, v89, s39
    v_mfma_f32_16x16x32_bf16 a[148:151], v[40:43], a[16:19], 0
    v_perm_b32 v48, v70, v66, s38
    v_perm_b32 v49, v78, v74, s38
    v_mfma_f32_16x16x32_bf16 a[152:155], v[44:47], a[0:3], 0
    v_perm_b32 v50, v86, v82, s38
    v_perm_b32 v51, v94, v90, s38
    v_mfma_f32_16x16x32_bf16 a[156:159], v[44:47], a[16:19], 0
    s_xor_b32 s97, s82, 0x104000
    buffer_load_dwordx4 v[200:203], v3, s[40:43], s97 offen
    v_perm_b32 v52, v70, v66, s39
    v_perm_b32 v53, v78, v74, s39
    v_mfma_f32_16x16x32_bf16 a[160:163], v[48:51], a[0:3], 0
    v_perm_b32 v54, v86, v82, s39
    v_perm_b32 v55, v94, v90, s39
    v_mfma_f32_16x16x32_bf16 a[164:167], v[48:51], a[16:19], 0
    v_perm_b32 v56, v71, v67, s38
    v_perm_b32 v57, v79, v75, s38
    v_mfma_f32_16x16x32_bf16 a[168:171], v[52:55], a[0:3], 0
    s_xor_b32 s97, s82, 0x106000
    buffer_load_dwordx4 v[204:207], v3, s[40:43], s97 offen
    v_perm_b32 v58, v87, v83, s38
    v_perm_b32 v59, v95, v91, s38
    v_mfma_f32_16x16x32_bf16 a[172:175], v[52:55], a[16:19], 0
    v_perm_b32 v60, v71, v67, s39
    v_perm_b32 v61, v79, v75, s39
    v_mfma_f32_16x16x32_bf16 a[176:179], v[56:59], a[0:3], 0
    v_perm_b32 v62, v87, v83, s39
    v_perm_b32 v63, v95, v91, s39
    v_mfma_f32_16x16x32_bf16 a[180:183], v[56:59], a[16:19], 0
    s_xor_b32 s97, s82, 0x108000
    buffer_load_dwordx4 v[208:211], v3, s[40:43], s97 offen
    v_mfma_f32_16x16x32_bf16 a[184:187], v[60:63], a[0:3], 0
    v_mfma_f32_16x16x32_bf16 a[188:191], v[60:63], a[16:19], 0
    v_perm_b32 v32, v100, v96, s38
    v_perm_b32 v33, v108, v104, s38
    v_perm_b32 v34, v116, v112, s38
    v_perm_b32 v35, v124, v120, s38
    s_xor_b32 s97, s82, 0x10a000
    buffer_load_dwordx4 v[212:215], v3, s[40:43], s97 offen
    v_perm_b32 v36, v100, v96, s39
    v_perm_b32 v37, v108, v104, s39
    v_mfma_f32_16x16x32_bf16 a[128:131], v[32:35], a[4:7], a[128:131]
    v_perm_b32 v38, v116, v112, s39
    v_perm_b32 v39, v124, v120, s39
    v_mfma_f32_16x16x32_bf16 a[132:135], v[32:35], a[20:23], a[132:135]
    v_perm_b32 v40, v101, v97, s38
    v_perm_b32 v41, v109, v105, s38
    v_mfma_f32_16x16x32_bf16 a[136:139], v[36:39], a[4:7], a[136:139]
    s_xor_b32 s97, s82, 0x10c000
    buffer_load_dwordx4 v[216:219], v3, s[40:43], s97 offen
    v_perm_b32 v42, v117, v113, s38
    v_perm_b32 v43, v125, v121, s38
    v_mfma_f32_16x16x32_bf16 a[140:143], v[36:39], a[20:23], a[140:143]
    v_perm_b32 v44, v101, v97, s39
    v_perm_b32 v45, v109, v105, s39
    v_mfma_f32_16x16x32_bf16 a[144:147], v[40:43], a[4:7], a[144:147]
    v_perm_b32 v46, v117, v113, s39
    v_perm_b32 v47, v125, v121, s39
    v_mfma_f32_16x16x32_bf16 a[148:151], v[40:43], a[20:23], a[148:151]
    s_xor_b32 s97, s82, 0x10e000
    buffer_load_dwordx4 v[220:223], v3, s[40:43], s97 offen
    v_perm_b32 v48, v102, v98, s38
    v_perm_b32 v49, v110, v106, s38
    v_mfma_f32_16x16x32_bf16 a[152:155], v[44:47], a[4:7], a[152:155]
    v_perm_b32 v50, v118, v114, s38
    v_perm_b32 v51, v126, v122, s38
    v_mfma_f32_16x16x32_bf16 a[156:159], v[44:47], a[20:23], a[156:159]
    v_perm_b32 v52, v102, v98, s39
    v_perm_b32 v53, v110, v106, s39
    v_mfma_f32_16x16x32_bf16 a[160:163], v[48:51], a[4:7], a[160:163]
    s_xor_b32 s97, s82, 0x110000
    buffer_load_dwordx4 v[224:227], v3, s[40:43], s97 offen
    v_perm_b32 v54, v118, v114, s39
    v_perm_b32 v55, v126, v122, s39
    v_mfma_f32_16x16x32_bf16 a[164:167], v[48:51], a[20:23], a[164:167]
    v_perm_b32 v56, v103, v99, s38
    v_perm_b32 v57, v111, v107, s38
    v_mfma_f32_16x16x32_bf16 a[168:171], v[52:55], a[4:7], a[168:171]
    v_perm_b32 v58, v119, v115, s38
    v_perm_b32 v59, v127, v123, s38
    v_mfma_f32_16x16x32_bf16 a[172:175], v[52:55], a[20:23], a[172:175]
    s_xor_b32 s97, s82, 0x112000
    buffer_load_dwordx4 v[228:231], v3, s[40:43], s97 offen
    v_perm_b32 v60, v103, v99, s39
    v_perm_b32 v61, v111, v107, s39
    v_mfma_f32_16x16x32_bf16 a[176:179], v[56:59], a[4:7], a[176:179]
    v_perm_b32 v62, v119, v115, s39
    v_perm_b32 v63, v127, v123, s39
    v_mfma_f32_16x16x32_bf16 a[180:183], v[56:59], a[20:23], a[180:183]
    s_nop 0
    v_mfma_f32_16x16x32_bf16 a[184:187], v[60:63], a[4:7], a[184:187]
    s_xor_b32 s97, s82, 0x114000
    buffer_load_dwordx4 v[232:235], v3, s[40:43], s97 offen
    v_mfma_f32_16x16x32_bf16 a[188:191], v[60:63], a[20:23], a[188:191]
    s_xor_b32 s97, s82, 0x116000
    buffer_load_dwordx4 v[236:239], v3, s[40:43], s97 offen
    s_xor_b32 s97, s82, 0x118000
    buffer_load_dwordx4 v[240:243], v3, s[40:43], s97 offen
    s_xor_b32 s97, s82, 0x11a000
    buffer_load_dwordx4 v[244:247], v3, s[40:43], s97 offen
    s_xor_b32 s97, s82, 0x11c000
    buffer_load_dwordx4 v[248:251], v3, s[40:43], s97 offen
    s_xor_b32 s97, s82, 0x11e000
    buffer_load_dwordx4 v[252:255], v3, s[40:43], s97 offen
    s_waitcnt vmcnt(32)
    v_perm_b32 v32, v132, v128, s38
    v_perm_b32 v33, v140, v136, s38
    v_perm_b32 v34, v148, v144, s38
    v_perm_b32 v35, v156, v152, s38
    v_perm_b32 v36, v132, v128, s39
    v_perm_b32 v37, v140, v136, s39
    v_mfma_f32_16x16x32_bf16 a[128:131], v[32:35], a[8:11], a[128:131]
    v_perm_b32 v38, v148, v144, s39
    v_perm_b32 v39, v156, v152, s39
    s_xor_b32 s97, s83, 0x0
    buffer_load_dword v30, v24, s[76:79], s97 offen
    v_mfma_f32_16x16x32_bf16 a[132:135], v[32:35], a[24:27], a[132:135]
    v_perm_b32 v40, v133, v129, s38
    v_perm_b32 v41, v141, v137, s38
    v_mfma_f32_16x16x32_bf16 a[136:139], v[36:39], a[8:11], a[136:139]
    v_perm_b32 v42, v149, v145, s38
    v_perm_b32 v43, v157, v153, s38
    v_mfma_f32_16x16x32_bf16 a[140:143], v[36:39], a[24:27], a[140:143]
    v_perm_b32 v44, v133, v129, s39
    s_xor_b32 s97, s82, 0x120000
    buffer_load_dwordx4 v[64:67], v3, s[40:43], s97 offen
    v_perm_b32 v45, v141, v137, s39
    v_mfma_f32_16x16x32_bf16 a[144:147], v[40:43], a[8:11], a[144:147]
    v_perm_b32 v46, v149, v145, s39
    v_perm_b32 v47, v157, v153, s39
    v_mfma_f32_16x16x32_bf16 a[148:151], v[40:43], a[24:27], a[148:151]
    v_perm_b32 v48, v134, v130, s38
    v_perm_b32 v49, v142, v138, s38
    v_mfma_f32_16x16x32_bf16 a[152:155], v[44:47], a[8:11], a[152:155]
    s_xor_b32 s97, s82, 0x122000
    buffer_load_dwordx4 v[68:71], v3, s[40:43], s97 offen
    v_perm_b32 v50, v150, v146, s38
    v_perm_b32 v51, v158, v154, s38
    v_mfma_f32_16x16x32_bf16 a[156:159], v[44:47], a[24:27], a[156:159]
    v_perm_b32 v52, v134, v130, s39
    v_perm_b32 v53, v142, v138, s39
    v_mfma_f32_16x16x32_bf16 a[160:163], v[48:51], a[8:11], a[160:163]
    v_perm_b32 v54, v150, v146, s39
    v_perm_b32 v55, v158, v154, s39
    v_mfma_f32_16x16x32_bf16 a[164:167], v[48:51], a[24:27], a[164:167]
    s_xor_b32 s97, s82, 0x124000
    buffer_load_dwordx4 v[72:75], v3, s[40:43], s97 offen
    v_perm_b32 v56, v135, v131, s38
    v_perm_b32 v57, v143, v139, s38
    v_mfma_f32_16x16x32_bf16 a[168:171], v[52:55], a[8:11], a[168:171]
    v_perm_b32 v58, v151, v147, s38
    v_perm_b32 v59, v159, v155, s38
    v_mfma_f32_16x16x32_bf16 a[172:175], v[52:55], a[24:27], a[172:175]
    v_perm_b32 v60, v135, v131, s39
    v_perm_b32 v61, v143, v139, s39
    v_mfma_f32_16x16x32_bf16 a[176:179], v[56:59], a[8:11], a[176:179]
    s_xor_b32 s97, s82, 0x126000
    buffer_load_dwordx4 v[76:79], v3, s[40:43], s97 offen
    v_perm_b32 v62, v151, v147, s39
    v_perm_b32 v63, v159, v155, s39
    v_mfma_f32_16x16x32_bf16 a[180:183], v[56:59], a[24:27], a[180:183]
    s_nop 0
    v_mfma_f32_16x16x32_bf16 a[184:187], v[60:63], a[8:11], a[184:187]
    v_mfma_f32_16x16x32_bf16 a[188:191], v[60:63], a[24:27], a[188:191]
    s_xor_b32 s97, s82, 0x128000
    buffer_load_dwordx4 v[80:83], v3, s[40:43], s97 offen
    s_xor_b32 s97, s82, 0x12a000
    buffer_load_dwordx4 v[84:87], v3, s[40:43], s97 offen
    s_xor_b32 s97, s82, 0x12c000
    buffer_load_dwordx4 v[88:91], v3, s[40:43], s97 offen
    s_waitcnt vmcnt(32)
    v_perm_b32 v32, v164, v160, s38
    v_perm_b32 v33, v172, v168, s38
    v_perm_b32 v34, v180, v176, s38
    v_perm_b32 v35, v188, v184, s38
    v_perm_b32 v36, v164, v160, s39
    v_perm_b32 v37, v172, v168, s39
    v_mfma_f32_16x16x32_bf16 a[128:131], v[32:35], a[12:15], a[128:131]
    v_perm_b32 v38, v180, v176, s39
    v_perm_b32 v39, v188, v184, s39
    s_xor_b32 s97, s82, 0x12e000
    buffer_load_dwordx4 v[92:95], v3, s[40:43], s97 offen
    v_mfma_f32_16x16x32_bf16 a[132:135], v[32:35], a[28:31], a[132:135]
    v_perm_b32 v40, v165, v161, s38
    v_perm_b32 v41, v173, v169, s38
    v_mfma_f32_16x16x32_bf16 a[136:139], v[36:39], a[12:15], a[136:139]
    v_perm_b32 v42, v181, v177, s38
    v_perm_b32 v43, v189, v185, s38
    v_mfma_f32_16x16x32_bf16 a[140:143], v[36:39], a[28:31], a[140:143]
    v_perm_b32 v44, v165, v161, s39
    s_xor_b32 s97, s83, 0x2000
    buffer_load_dword v30, v24, s[76:79], s97 offen
    v_perm_b32 v45, v173, v169, s39
    v_mfma_f32_16x16x32_bf16 a[144:147], v[40:43], a[12:15], a[144:147]
    v_perm_b32 v46, v181, v177, s39
    v_perm_b32 v47, v189, v185, s39
    v_mfma_f32_16x16x32_bf16 a[148:151], v[40:43], a[28:31], a[148:151]
    v_perm_b32 v48, v166, v162, s38
    v_perm_b32 v49, v174, v170, s38
    v_mfma_f32_16x16x32_bf16 a[152:155], v[44:47], a[12:15], a[152:155]
    s_xor_b32 s97, s82, 0x130000
    buffer_load_dwordx4 v[96:99], v3, s[40:43], s97 offen
    v_perm_b32 v50, v182, v178, s38
    v_perm_b32 v51, v190, v186, s38
    v_mfma_f32_16x16x32_bf16 a[156:159], v[44:47], a[28:31], a[156:159]
    v_perm_b32 v52, v166, v162, s39
    v_perm_b32 v53, v174, v170, s39
    v_mfma_f32_16x16x32_bf16 a[160:163], v[48:51], a[12:15], a[160:163]
    v_perm_b32 v54, v182, v178, s39
    v_perm_b32 v55, v190, v186, s39
    v_mfma_f32_16x16x32_bf16 a[164:167], v[48:51], a[28:31], a[164:167]
    s_xor_b32 s97, s82, 0x132000
    buffer_load_dwordx4 v[100:103], v3, s[40:43], s97 offen
    v_perm_b32 v56, v167, v163, s38
    v_perm_b32 v57, v175, v171, s38
    v_mfma_f32_16x16x32_bf16 a[168:171], v[52:55], a[12:15], a[168:171]
    v_perm_b32 v58, v183, v179, s38
    v_perm_b32 v59, v191, v187, s38
    v_mfma_f32_16x16x32_bf16 a[172:175], v[52:55], a[28:31], a[172:175]
    v_perm_b32 v60, v167, v163, s39
    v_perm_b32 v61, v175, v171, s39
    v_mfma_f32_16x16x32_bf16 a[176:179], v[56:59], a[12:15], a[176:179]
    s_xor_b32 s97, s82, 0x134000
    buffer_load_dwordx4 v[104:107], v3, s[40:43], s97 offen
    v_perm_b32 v62, v183, v179, s39
    v_perm_b32 v63, v191, v187, s39
    v_mfma_f32_16x16x32_bf16 a[180:183], v[56:59], a[28:31], a[180:183]
    s_nop 0
    v_mfma_f32_16x16x32_bf16 a[184:187], v[60:63], a[12:15], a[184:187]
    v_mfma_f32_16x16x32_bf16 a[188:191], v[60:63], a[28:31], a[188:191]
    s_xor_b32 s97, s82, 0x136000
    buffer_load_dwordx4 v[108:111], v3, s[40:43], s97 offen
    s_xor_b32 s97, s82, 0x138000
    buffer_load_dwordx4 v[112:115], v3, s[40:43], s97 offen
    s_xor_b32 s97, s82, 0x13a000
    buffer_load_dwordx4 v[116:119], v3, s[40:43], s97 offen
    s_xor_b32 s97, s82, 0x13c000
    buffer_load_dwordx4 v[120:123], v3, s[40:43], s97 offen
    s_xor_b32 s97, s82, 0x13e000
    buffer_load_dwordx4 v[124:127], v3, s[40:43], s97 offen
    s_xor_b32 s97, s83, 0x4000
    buffer_load_dword v30, v24, s[76:79], s97 offen
    s_xor_b32 s97, s82, 0x200000
    buffer_load_dwordx4 v[128:131], v3, s[40:43], s97 offen
    s_xor_b32 s97, s82, 0x202000
    buffer_load_dwordx4 v[132:135], v3, s[40:43], s97 offen
    s_xor_b32 s97, s82, 0x204000
    buffer_load_dwordx4 v[136:139], v3, s[40:43], s97 offen
    s_xor_b32 s97, s82, 0x206000
    buffer_load_dwordx4 v[140:143], v3, s[40:43], s97 offen
    s_xor_b32 s97, s82, 0x208000
    buffer_load_dwordx4 v[144:147], v3, s[40:43], s97 offen
    s_waitcnt vmcnt(32)
    v_perm_b32 v32, v196, v192, s38
    v_perm_b32 v33, v204, v200, s38
    v_perm_b32 v34, v212, v208, s38
    v_perm_b32 v35, v220, v216, s38
    v_perm_b32 v36, v196, v192, s39
    v_perm_b32 v37, v204, v200, s39
    v_mfma_f32_16x16x32_bf16 a[128:131], v[32:35], a[32:35], a[128:131]
    v_perm_b32 v38, v212, v208, s39
    v_perm_b32 v39, v220, v216, s39
    s_xor_b32 s97, s82, 0x20a000
    buffer_load_dwordx4 v[148:151], v3, s[40:43], s97 offen
    v_mfma_f32_16x16x32_bf16 a[132:135], v[32:35], a[48:51], a[132:135]
    v_perm_b32 v40, v197, v193, s38
    v_perm_b32 v41, v205, v201, s38
    v_mfma_f32_16x16x32_bf16 a[136:139], v[36:39], a[32:35], a[136:139]
    v_perm_b32 v42, v213, v209, s38
    v_perm_b32 v43, v221, v217, s38
    v_mfma_f32_16x16x32_bf16 a[140:143], v[36:39], a[48:51], a[140:143]
    v_perm_b32 v44, v197, v193, s39
    s_xor_b32 s97, s82, 0x20c000
    buffer_load_dwordx4 v[152:155], v3, s[40:43], s97 offen
    v_perm_b32 v45, v205, v201, s39
    v_mfma_f32_16x16x32_bf16 a[144:147], v[40:43], a[32:35], a[144:147]
    v_perm_b32 v46, v213, v209, s39
    v_perm_b32 v47, v221, v217, s39
    v_mfma_f32_16x16x32_bf16 a[148:151], v[40:43], a[48:51], a[148:151]
    v_perm_b32 v48, v198, v194, s38
    v_perm_b32 v49, v206, v202, s38
    v_mfma_f32_16x16x32_bf16 a[152:155], v[44:47], a[32:35], a[152:155]
    s_xor_b32 s97, s82, 0x20e000
    buffer_load_dwordx4 v[156:159], v3, s[40:43], s97 offen
    v_perm_b32 v50, v214, v210, s38
    v_perm_b32 v51, v222, v218, s38
    v_mfma_f32_16x16x32_bf16 a[156:159], v[44:47], a[48:51], a[156:159]
    v_perm_b32 v52, v198, v194, s39
    v_perm_b32 v53, v206, v202, s39
    v_mfma_f32_16x16x32_bf16 a[160:163], v[48:51], a[32:35], a[160:163]
    v_perm_b32 v54, v214, v210, s39
    v_perm_b32 v55, v222, v218, s39
    v_mfma_f32_16x16x32_bf16 a[164:167], v[48:51], a[48:51], a[164:167]
    s_xor_b32 s97, s83, 0x6000
    buffer_load_dword v30, v24, s[76:79], s97 offen
    v_perm_b32 v56, v199, v195, s38
    v_perm_b32 v57, v207, v203, s38
    v_mfma_f32_16x16x32_bf16 a[168:171], v[52:55], a[32:35], a[168:171]
    v_perm_b32 v58, v215, v211, s38
    v_perm_b32 v59, v223, v219, s38
    v_mfma_f32_16x16x32_bf16 a[172:175], v[52:55], a[48:51], a[172:175]
    v_perm_b32 v60, v199, v195, s39
    v_perm_b32 v61, v207, v203, s39
    v_mfma_f32_16x16x32_bf16 a[176:179], v[56:59], a[32:35], a[176:179]
    s_xor_b32 s97, s82, 0x210000
    buffer_load_dwordx4 v[160:163], v3, s[40:43], s97 offen
    v_perm_b32 v62, v215, v211, s39
    v_perm_b32 v63, v223, v219, s39
    v_mfma_f32_16x16x32_bf16 a[180:183], v[56:59], a[48:51], a[180:183]
    s_nop 0
    v_mfma_f32_16x16x32_bf16 a[184:187], v[60:63], a[32:35], a[184:187]
    v_mfma_f32_16x16x32_bf16 a[188:191], v[60:63], a[48:51], a[188:191]
    s_xor_b32 s97, s82, 0x212000
    buffer_load_dwordx4 v[164:167], v3, s[40:43], s97 offen
    s_xor_b32 s97, s82, 0x214000
    buffer_load_dwordx4 v[168:171], v3, s[40:43], s97 offen
    s_xor_b32 s97, s82, 0x216000
    buffer_load_dwordx4 v[172:175], v3, s[40:43], s97 offen
    s_waitcnt vmcnt(32)
    v_perm_b32 v32, v228, v224, s38
    v_perm_b32 v33, v236, v232, s38
    v_perm_b32 v34, v244, v240, s38
    v_perm_b32 v35, v252, v248, s38
    v_perm_b32 v36, v228, v224, s39
    v_perm_b32 v37, v236, v232, s39
    v_mfma_f32_16x16x32_bf16 a[128:131], v[32:35], a[36:39], a[128:131]
    v_perm_b32 v38, v244, v240, s39
    v_perm_b32 v39, v252, v248, s39
    s_xor_b32 s97, s82, 0x218000
    buffer_load_dwordx4 v[176:179], v3, s[40:43], s97 offen
    v_mfma_f32_16x16x32_bf16 a[132:135], v[32:35], a[52:55], a[132:135]
    v_perm_b32 v40, v229, v225, s38
    v_perm_b32 v41, v237, v233, s38
    v_mfma_f32_16x16x32_bf16 a[136:139], v[36:39], a[36:39], a[136:139]
    v_perm_b32 v42, v245, v241, s38
    v_perm_b32 v43, v253, v249, s38
    v_mfma_f32_16x16x32_bf16 a[140:143], v[36:39], a[52:55], a[140:143]
    v_perm_b32 v44, v229, v225, s39
    s_xor_b32 s97, s82, 0x21a000
    buffer_load_dwordx4 v[180:183], v3, s[40:43], s97 offen
    v_perm_b32 v45, v237, v233, s39
    v_mfma_f32_16x16x32_bf16 a[144:147], v[40:43], a[36:39], a[144:147]
    v_perm_b32 v46, v245, v241, s39
    v_perm_b32 v47, v253, v249, s39
    v_mfma_f32_16x16x32_bf16 a[148:151], v[40:43], a[52:55], a[148:151]
    v_perm_b32 v48, v230, v226, s38
    v_perm_b32 v49, v238, v234, s38
    v_mfma_f32_16x16x32_bf16 a[152:155], v[44:47], a[36:39], a[152:155]
    s_xor_b32 s97, s82, 0x21c000
    buffer_load_dwordx4 v[184:187], v3, s[40:43], s97 offen
    v_perm_b32 v50, v246, v242, s38
    v_perm_b32 v51, v254, v250, s38
    v_mfma_f32_16x16x32_bf16 a[156:159], v[44:47], a[52:55], a[156:159]
    v_perm_b32 v52, v230, v226, s39
    v_perm_b32 v53, v238, v234, s39
    v_mfma_f32_16x16x32_bf16 a[160:163], v[48:51], a[36:39], a[160:163]
    v_perm_b32 v54, v246, v242, s39
    v_perm_b32 v55, v254, v250, s39
    v_mfma_f32_16x16x32_bf16 a[164:167], v[48:51], a[52:55], a[164:167]
    s_xor_b32 s97, s82, 0x21e000
    buffer_load_dwordx4 v[188:191], v3, s[40:43], s97 offen
    v_perm_b32 v56, v231, v227, s38
    v_perm_b32 v57, v239, v235, s38
    v_mfma_f32_16x16x32_bf16 a[168:171], v[52:55], a[36:39], a[168:171]
    v_perm_b32 v58, v247, v243, s38
    v_perm_b32 v59, v255, v251, s38
    v_mfma_f32_16x16x32_bf16 a[172:175], v[52:55], a[52:55], a[172:175]
    v_perm_b32 v60, v231, v227, s39
    v_perm_b32 v61, v239, v235, s39
    v_mfma_f32_16x16x32_bf16 a[176:179], v[56:59], a[36:39], a[176:179]
    s_add_u32 m0, s98, 0x4100
    s_xor_b32 s97, s99, 0x10000
    buffer_load_dwordx4 v1, s[52:55], s97 offen nt lds
    v_perm_b32 v62, v247, v243, s39
    v_perm_b32 v63, v255, v251, s39
    v_mfma_f32_16x16x32_bf16 a[180:183], v[56:59], a[52:55], a[180:183]
    s_nop 0
    v_mfma_f32_16x16x32_bf16 a[184:187], v[60:63], a[36:39], a[184:187]
    v_mfma_f32_16x16x32_bf16 a[188:191], v[60:63], a[52:55], a[188:191]
    s_add_u32 m0, s98, 0x4410
    s_xor_b32 s97, s99, 0x10000
    buffer_load_dwordx4 v1, s[52:55], s97 offen offset:256 nt lds
    s_add_u32 m0, s98, 0x4720
    s_xor_b32 s97, s99, 0x10000
    buffer_load_dwordx4 v1, s[52:55], s97 offen offset:512 nt lds
    s_add_u32 m0, s98, 0x4a30
    s_xor_b32 s97, s99, 0x10000
    buffer_load_dwordx4 v1, s[52:55], s97 offen offset:768 nt lds
    s_add_u32 m0, s98, 0x5140
    s_xor_b32 s97, s99, 0x11000
    buffer_load_dwordx4 v1, s[52:55], s97 offen nt lds
    s_waitcnt vmcnt(32)
    v_perm_b32 v32, v68, v64, s38
    v_perm_b32 v33, v76, v72, s38
    v_perm_b32 v34, v84, v80, s38
    v_perm_b32 v35, v92, v88, s38
    v_perm_b32 v36, v68, v64, s39
    v_perm_b32 v37, v76, v72, s39
    v_mfma_f32_16x16x32_bf16 a[128:131], v[32:35], a[40:43], a[128:131]
    v_perm_b32 v38, v84, v80, s39
    v_perm_b32 v39, v92, v88, s39
    s_add_u32 m0, s98, 0x5450
    s_xor_b32 s97, s99, 0x11000
    buffer_load_dwordx4 v1, s[52:55], s97 offen offset:256 nt lds
    v_mfma_f32_16x16x32_bf16 a[132:135], v[32:35], a[56:59], a[132:135]
    v_perm_b32 v40, v69, v65, s38
    v_perm_b32 v41, v77, v73, s38
    v_mfma_f32_16x16x32_bf16 a[136:139], v[36:39], a[40:43], a[136:139]
    v_perm_b32 v42, v85, v81, s38
    v_perm_b32 v43, v93, v89, s38
    v_mfma_f32_16x16x32_bf16 a[140:143], v[36:39], a[56:59], a[140:143]
    v_perm_b32 v44, v69, v65, s39
    s_add_u32 m0, s98, 0x5760
    s_xor_b32 s97, s99, 0x11000
    buffer_load_dwordx4 v1, s[52:55], s97 offen offset:512 nt lds
    v_perm_b32 v45, v77, v73, s39
    v_mfma_f32_16x16x32_bf16 a[144:147], v[40:43], a[40:43], a[144:147]
    v_perm_b32 v46, v85, v81, s39
    v_perm_b32 v47, v93, v89, s39
    v_mfma_f32_16x16x32_bf16 a[148:151], v[40:43], a[56:59], a[148:151]
    v_perm_b32 v48, v70, v66, s38
    v_perm_b32 v49, v78, v74, s38
    v_mfma_f32_16x16x32_bf16 a[152:155], v[44:47], a[40:43], a[152:155]
    s_add_u32 m0, s98, 0x5a70
    s_xor_b32 s97, s99, 0x11000
    buffer_load_dwordx4 v1, s[52:55], s97 offen offset:768 nt lds
    v_perm_b32 v50, v86, v82, s38
    v_perm_b32 v51, v94, v90, s38
    v_mfma_f32_16x16x32_bf16 a[156:159], v[44:47], a[56:59], a[156:159]
    v_perm_b32 v52, v70, v66, s39
    v_perm_b32 v53, v78, v74, s39
    v_mfma_f32_16x16x32_bf16 a[160:163], v[48:51], a[40:43], a[160:163]
    v_perm_b32 v54, v86, v82, s39
    v_perm_b32 v55, v94, v90, s39
    v_mfma_f32_16x16x32_bf16 a[164:167], v[48:51], a[56:59], a[164:167]
    s_xor_b32 s97, s82, 0x220000
    buffer_load_dwordx4 v[192:195], v3, s[40:43], s97 offen
    v_perm_b32 v56, v71, v67, s38
    v_perm_b32 v57, v79, v75, s38
    v_mfma_f32_16x16x32_bf16 a[168:171], v[52:55], a[40:43], a[168:171]
    v_perm_b32 v58, v87, v83, s38
    v_perm_b32 v59, v95, v91, s38
    v_mfma_f32_16x16x32_bf16 a[172:175], v[52:55], a[56:59], a[172:175]
    v_perm_b32 v60, v71, v67, s39
    v_perm_b32 v61, v79, v75, s39
    v_mfma_f32_16x16x32_bf16 a[176:179], v[56:59], a[40:43], a[176:179]
    s_xor_b32 s97, s82, 0x222000
    buffer_load_dwordx4 v[196:199], v3, s[40:43], s97 offen
    v_perm_b32 v62, v87, v83, s39
    v_perm_b32 v63, v95, v91, s39
    v_mfma_f32_16x16x32_bf16 a[180:183], v[56:59], a[56:59], a[180:183]
    s_nop 0
    v_mfma_f32_16x16x32_bf16 a[184:187], v[60:63], a[40:43], a[184:187]
    v_mfma_f32_16x16x32_bf16 a[188:191], v[60:63], a[56:59], a[188:191]
    s_xor_b32 s97, s82, 0x224000
    buffer_load_dwordx4 v[200:203], v3, s[40:43], s97 offen
    s_xor_b32 s97, s82, 0x226000
    buffer_load_dwordx4 v[204:207], v3, s[40:43], s97 offen
    s_xor_b32 s97, s82, 0x228000
    buffer_load_dwordx4 v[208:211], v3, s[40:43], s97 offen
    s_xor_b32 s97, s82, 0x22a000
    buffer_load_dwordx4 v[212:215], v3, s[40:43], s97 offen
    s_waitcnt vmcnt(32)
    v_perm_b32 v32, v100, v96, s38
    v_perm_b32 v33, v108, v104, s38
    v_perm_b32 v34, v116, v112, s38
    v_perm_b32 v35, v124, v120, s38
    v_perm_b32 v36, v100, v96, s39
    v_perm_b32 v37, v108, v104, s39
    v_mfma_f32_16x16x32_bf16 a[128:131], v[32:35], a[44:47], a[128:131]
    v_perm_b32 v38, v116, v112, s39
    v_perm_b32 v39, v124, v120, s39
    s_xor_b32 s97, s82, 0x22c000
    buffer_load_dwordx4 v[216:219], v3, s[40:43], s97 offen
    v_mfma_f32_16x16x32_bf16 a[132:135], v[32:35], a[60:63], a[132:135]
    v_perm_b32 v40, v101, v97, s38
    v_perm_b32 v41, v109, v105, s38
    v_mfma_f32_16x16x32_bf16 a[136:139], v[36:39], a[44:47], a[136:139]
    v_perm_b32 v42, v117, v113, s38
    v_perm_b32 v43, v125, v121, s38
    v_mfma_f32_16x16x32_bf16 a[140:143], v[36:39], a[60:63], a[140:143]
    v_perm_b32 v44, v101, v97, s39
    s_xor_b32 s97, s82, 0x22e000
    buffer_load_dwordx4 v[220:223], v3, s[40:43], s97 offen
    v_perm_b32 v45, v109, v105, s39
    v_mfma_f32_16x16x32_bf16 a[144:147], v[40:43], a[44:47], a[144:147]
    v_perm_b32 v46, v117, v113, s39
    v_perm_b32 v47, v125, v121, s39
    v_mfma_f32_16x16x32_bf16 a[148:151], v[40:43], a[60:63], a[148:151]
    v_perm_b32 v48, v102, v98, s38
    v_perm_b32 v49, v110, v106, s38
    v_mfma_f32_16x16x32_bf16 a[152:155], v[44:47], a[44:47], a[152:155]
    s_xor_b32 s97, s82, 0x230000
    buffer_load_dwordx4 v[224:227], v3, s[40:43], s97 offen
    v_perm_b32 v50, v118, v114, s38
    v_perm_b32 v51, v126, v122, s38
    v_mfma_f32_16x16x32_bf16 a[156:159], v[44:47], a[60:63], a[156:159]
    v_perm_b32 v52, v102, v98, s39
    v_perm_b32 v53, v110, v106, s39
    v_mfma_f32_16x16x32_bf16 a[160:163], v[48:51], a[44:47], a[160:163]
    v_perm_b32 v54, v118, v114, s39
    v_perm_b32 v55, v126, v122, s39
    v_mfma_f32_16x16x32_bf16 a[164:167], v[48:51], a[60:63], a[164:167]
    s_xor_b32 s97, s82, 0x232000
    buffer_load_dwordx4 v[228:231], v3, s[40:43], s97 offen
    v_perm_b32 v56, v103, v99, s38
    v_perm_b32 v57, v111, v107, s38
    v_mfma_f32_16x16x32_bf16 a[168:171], v[52:55], a[44:47], a[168:171]
    v_perm_b32 v58, v119, v115, s38
    v_perm_b32 v59, v127, v123, s38
    v_mfma_f32_16x16x32_bf16 a[172:175], v[52:55], a[60:63], a[172:175]
    v_perm_b32 v60, v103, v99, s39
    v_perm_b32 v61, v111, v107, s39
    v_mfma_f32_16x16x32_bf16 a[176:179], v[56:59], a[44:47], a[176:179]
    s_xor_b32 s97, s82, 0x234000
    buffer_load_dwordx4 v[232:235], v3, s[40:43], s97 offen
    v_perm_b32 v62, v119, v115, s39
    v_perm_b32 v63, v127, v123, s39
    v_mfma_f32_16x16x32_bf16 a[180:183], v[56:59], a[60:63], a[180:183]
    s_nop 0
    v_mfma_f32_16x16x32_bf16 a[184:187], v[60:63], a[44:47], a[184:187]
    v_mfma_f32_16x16x32_bf16 a[188:191], v[60:63], a[60:63], a[188:191]
    s_xor_b32 s97, s82, 0x236000
    buffer_load_dwordx4 v[236:239], v3, s[40:43], s97 offen
    s_xor_b32 s97, s82, 0x238000
    buffer_load_dwordx4 v[240:243], v3, s[40:43], s97 offen
    s_xor_b32 s97, s82, 0x23a000
    buffer_load_dwordx4 v[244:247], v3, s[40:43], s97 offen
    s_xor_b32 s97, s82, 0x23c000
    buffer_load_dwordx4 v[248:251], v3, s[40:43], s97 offen
    s_waitcnt vmcnt(32)
    v_perm_b32 v32, v132, v128, s38
    v_perm_b32 v33, v140, v136, s38
    v_perm_b32 v34, v148, v144, s38
    v_perm_b32 v35, v156, v152, s38
    v_perm_b32 v36, v132, v128, s39
    v_perm_b32 v37, v140, v136, s39
    v_mfma_f32_16x16x32_bf16 a[128:131], v[32:35], a[64:67], a[128:131]
    v_perm_b32 v38, v148, v144, s39
    v_perm_b32 v39, v156, v152, s39
    s_xor_b32 s97, s82, 0x23e000
    buffer_load_dwordx4 v[252:255], v3, s[40:43], s97 offen
    v_mfma_f32_16x16x32_bf16 a[132:135], v[32:35], a[80:83], a[132:135]
    v_perm_b32 v40, v133, v129, s38
    v_perm_b32 v41, v141, v137, s38
    v_mfma_f32_16x16x32_bf16 a[136:139], v[36:39], a[64:67], a[136:139]
    v_perm_b32 v42, v149, v145, s38
    v_perm_b32 v43, v157, v153, s38
    v_mfma_f32_16x16x32_bf16 a[140:143], v[36:39], a[80:83], a[140:143]
    v_perm_b32 v44, v133, v129, s39
    s_add_u32 m0, s98, 0x6180
    s_xor_b32 s97, s99, 0x18000
    buffer_load_dwordx4 v1, s[52:55], s97 offen nt lds
    v_perm_b32 v45, v141, v137, s39
    v_mfma_f32_16x16x32_bf16 a[144:147], v[40:43], a[64:67], a[144:147]
    v_perm_b32 v46, v149, v145, s39
    v_perm_b32 v47, v157, v153, s39
    v_mfma_f32_16x16x32_bf16 a[148:151], v[40:43], a[80:83], a[148:151]
    v_perm_b32 v48, v134, v130, s38
    v_perm_b32 v49, v142, v138, s38
    v_mfma_f32_16x16x32_bf16 a[152:155], v[44:47], a[64:67], a[152:155]
    s_add_u32 m0, s98, 0x6490
    s_xor_b32 s97, s99, 0x18000
    buffer_load_dwordx4 v1, s[52:55], s97 offen offset:256 nt lds
    v_perm_b32 v50, v150, v146, s38
    v_perm_b32 v51, v158, v154, s38
    v_mfma_f32_16x16x32_bf16 a[156:159], v[44:47], a[80:83], a[156:159]
    v_perm_b32 v52, v134, v130, s39
    v_perm_b32 v53, v142, v138, s39
    v_mfma_f32_16x16x32_bf16 a[160:163], v[48:51], a[64:67], a[160:163]
    v_perm_b32 v54, v150, v146, s39
    v_perm_b32 v55, v158, v154, s39
    v_mfma_f32_16x16x32_bf16 a[164:167], v[48:51], a[80:83], a[164:167]
    s_add_u32 m0, s98, 0x67a0
    s_xor_b32 s97, s99, 0x18000
    buffer_load_dwordx4 v1, s[52:55], s97 offen offset:512 nt lds
    v_perm_b32 v56, v135, v131, s38
    v_perm_b32 v57, v143, v139, s38
    v_mfma_f32_16x16x32_bf16 a[168:171], v[52:55], a[64:67], a[168:171]
    v_perm_b32 v58, v151, v147, s38
    v_perm_b32 v59, v159, v155, s38
    v_mfma_f32_16x16x32_bf16 a[172:175], v[52:55], a[80:83], a[172:175]
    v_perm_b32 v60, v135, v131, s39
    v_perm_b32 v61, v143, v139, s39
    v_mfma_f32_16x16x32_bf16 a[176:179], v[56:59], a[64:67], a[176:179]
    s_add_u32 m0, s98, 0x6ab0
    s_xor_b32 s97, s99, 0x18000
    buffer_load_dwordx4 v1, s[52:55], s97 offen offset:768 nt lds
    v_perm_b32 v62, v151, v147, s39
    v_perm_b32 v63, v159, v155, s39
    v_mfma_f32_16x16x32_bf16 a[180:183], v[56:59], a[80:83], a[180:183]
    s_nop 0
    v_mfma_f32_16x16x32_bf16 a[184:187], v[60:63], a[64:67], a[184:187]
    v_mfma_f32_16x16x32_bf16 a[188:191], v[60:63], a[80:83], a[188:191]
    s_add_u32 m0, s98, 0x71c0
    s_xor_b32 s97, s99, 0x19000
    buffer_load_dwordx4 v1, s[52:55], s97 offen nt lds
    s_add_u32 m0, s98, 0x74d0
    s_xor_b32 s97, s99, 0x19000
    buffer_load_dwordx4 v1, s[52:55], s97 offen offset:256 nt lds
    s_add_u32 m0, s98, 0x77e0
    s_xor_b32 s97, s99, 0x19000
    buffer_load_dwordx4 v1, s[52:55], s97 offen offset:512 nt lds
    s_add_u32 m0, s98, 0x7af0
    s_xor_b32 s97, s99, 0x19000
    buffer_load_dwordx4 v1, s[52:55], s97 offen offset:768 nt lds
    s_waitcnt vmcnt(32)
    v_perm_b32 v32, v164, v160, s38
    v_perm_b32 v33, v172, v168, s38
    v_perm_b32 v34, v180, v176, s38
    v_perm_b32 v35, v188, v184, s38
    v_perm_b32 v36, v164, v160, s39
    v_perm_b32 v37, v172, v168, s39
    v_mfma_f32_16x16x32_bf16 a[128:131], v[32:35], a[68:71], a[128:131]
    v_perm_b32 v38, v180, v176, s39
    v_perm_b32 v39, v188, v184, s39
    s_xor_b32 s97, s82, 0x300000
    buffer_load_dwordx4 v[64:67], v3, s[40:43], s97 offen
    v_mfma_f32_16x16x32_bf16 a[132:135], v[32:35], a[84:87], a[132:135]
    v_perm_b32 v40, v165, v161, s38
    v_perm_b32 v41, v173, v169, s38
    v_mfma_f32_16x16x32_bf16 a[136:139], v[36:39], a[68:71], a[136:139]
    v_perm_b32 v42, v181, v177, s38
    v_perm_b32 v43, v189, v185, s38
    v_mfma_f32_16x16x32_bf16 a[140:143], v[36:39], a[84:87], a[140:143]
    v_perm_b32 v44, v165, v161, s39
    s_xor_b32 s97, s82, 0x302000
    buffer_load_dwordx4 v[68:71], v3, s[40:43], s97 offen
    v_perm_b32 v45, v173, v169, s39
    v_mfma_f32_16x16x32_bf16 a[144:147], v[40:43], a[68:71], a[144:147]
    v_perm_b32 v46, v181, v177, s39
    v_perm_b32 v47, v189, v185, s39
    v_mfma_f32_16x16x32_bf16 a[148:151], v[40:43], a[84:87], a[148:151]
    v_perm_b32 v48, v166, v162, s38
    v_perm_b32 v49, v174, v170, s38
    v_mfma_f32_16x16x32_bf16 a[152:155], v[44:47], a[68:71], a[152:155]
    s_xor_b32 s97, s82, 0x304000
    buffer_load_dwordx4 v[72:75], v3, s[40:43], s97 offen
    v_perm_b32 v50, v182, v178, s38
    v_perm_b32 v51, v190, v186, s38
    v_mfma_f32_16x16x32_bf16 a[156:159], v[44:47], a[84:87], a[156:159]
    v_perm_b32 v52, v166, v162, s39
    v_perm_b32 v53, v174, v170, s39
    v_mfma_f32_16x16x32_bf16 a[160:163], v[48:51], a[68:71], a[160:163]
    v_perm_b32 v54, v182, v178, s39
    v_perm_b32 v55, v190, v186, s39
    v_mfma_f32_16x16x32_bf16 a[164:167], v[48:51], a[84:87], a[164:167]
    s_xor_b32 s97, s82, 0x306000
    buffer_load_dwordx4 v[76:79], v3, s[40:43], s97 offen
    v_perm_b32 v56, v167, v163, s38
    v_perm_b32 v57, v175, v171, s38
    v_mfma_f32_16x16x32_bf16 a[168:171], v[52:55], a[68:71], a[168:171]
    v_perm_b32 v58, v183, v179, s38
    v_perm_b32 v59, v191, v187, s38
    v_mfma_f32_16x16x32_bf16 a[172:175], v[52:55], a[84:87], a[172:175]
    v_perm_b32 v60, v167, v163, s39
    v_perm_b32 v61, v175, v171, s39
    v_mfma_f32_16x16x32_bf16 a[176:179], v[56:59], a[68:71], a[176:179]
    s_xor_b32 s97, s82, 0x308000
    buffer_load_dwordx4 v[80:83], v3, s[40:43], s97 offen
    v_perm_b32 v62, v183, v179, s39
    v_perm_b32 v63, v191, v187, s39
    v_mfma_f32_16x16x32_bf16 a[180:183], v[56:59], a[84:87], a[180:183]
    s_nop 0
    v_mfma_f32_16x16x32_bf16 a[184:187], v[60:63], a[68:71], a[184:187]
    v_mfma_f32_16x16x32_bf16 a[188:191], v[60:63], a[84:87], a[188:191]
    s_xor_b32 s97, s82, 0x30a000
    buffer_load_dwordx4 v[84:87], v3, s[40:43], s97 offen
    s_xor_b32 s97, s82, 0x30c000
    buffer_load_dwordx4 v[88:91], v3, s[40:43], s97 offen
    s_xor_b32 s97, s82, 0x30e000
    buffer_load_dwordx4 v[92:95], v3, s[40:43], s97 offen
    s_xor_b32 s97, s82, 0x310000
    buffer_load_dwordx4 v[96:99], v3, s[40:43], s97 offen
    s_xor_b32 s97, s82, 0x312000
    buffer_load_dwordx4 v[100:103], v3, s[40:43], s97 offen
    s_xor_b32 s97, s82, 0x314000
    buffer_load_dwordx4 v[104:107], v3, s[40:43], s97 offen
    s_xor_b32 s97, s82, 0x316000
    buffer_load_dwordx4 v[108:111], v3, s[40:43], s97 offen
    s_xor_b32 s97, s82, 0x318000
    buffer_load_dwordx4 v[112:115], v3, s[40:43], s97 offen
    s_xor_b32 s97, s82, 0x31a000
    buffer_load_dwordx4 v[116:119], v3, s[40:43], s97 offen
    s_xor_b32 s97, s82, 0x31c000
    buffer_load_dwordx4 v[120:123], v3, s[40:43], s97 offen
    s_xor_b32 s97, s82, 0x31e000
    buffer_load_dwordx4 v[124:127], v3, s[40:43], s97 offen
    s_waitcnt vmcnt(32)
    v_perm_b32 v32, v196, v192, s38
    v_perm_b32 v33, v204, v200, s38
    v_perm_b32 v34, v212, v208, s38
    v_perm_b32 v35, v220, v216, s38
    v_perm_b32 v36, v196, v192, s39
    v_perm_b32 v37, v204, v200, s39
    v_mfma_f32_16x16x32_bf16 a[128:131], v[32:35], a[72:75], a[128:131]
    v_perm_b32 v38, v212, v208, s39
    v_perm_b32 v39, v220, v216, s39
    s_xor_b32 s97, s82, 0x320000
    buffer_load_dwordx4 v[128:131], v3, s[40:43], s97 offen
    v_mfma_f32_16x16x32_bf16 a[132:135], v[32:35], a[88:91], a[132:135]
    v_perm_b32 v40, v197, v193, s38
    v_perm_b32 v41, v205, v201, s38
    v_mfma_f32_16x16x32_bf16 a[136:139], v[36:39], a[72:75], a[136:139]
    v_perm_b32 v42, v213, v209, s38
    v_perm_b32 v43, v221, v217, s38
    v_mfma_f32_16x16x32_bf16 a[140:143], v[36:39], a[88:91], a[140:143]
    v_perm_b32 v44, v197, v193, s39
    s_xor_b32 s97, s82, 0x322000
    buffer_load_dwordx4 v[132:135], v3, s[40:43], s97 offen
    v_perm_b32 v45, v205, v201, s39
    v_mfma_f32_16x16x32_bf16 a[144:147], v[40:43], a[72:75], a[144:147]
    v_perm_b32 v46, v213, v209, s39
    v_perm_b32 v47, v221, v217, s39
    v_mfma_f32_16x16x32_bf16 a[148:151], v[40:43], a[88:91], a[148:151]
    v_perm_b32 v48, v198, v194, s38
    v_perm_b32 v49, v206, v202, s38
    v_mfma_f32_16x16x32_bf16 a[152:155], v[44:47], a[72:75], a[152:155]
    s_xor_b32 s97, s82, 0x324000
    buffer_load_dwordx4 v[136:139], v3, s[40:43], s97 offen
    v_perm_b32 v50, v214, v210, s38
    v_perm_b32 v51, v222, v218, s38
    v_mfma_f32_16x16x32_bf16 a[156:159], v[44:47], a[88:91], a[156:159]
    v_perm_b32 v52, v198, v194, s39
    v_perm_b32 v53, v206, v202, s39
    v_mfma_f32_16x16x32_bf16 a[160:163], v[48:51], a[72:75], a[160:163]
    v_perm_b32 v54, v214, v210, s39
    v_perm_b32 v55, v222, v218, s39
    v_mfma_f32_16x16x32_bf16 a[164:167], v[48:51], a[88:91], a[164:167]
    s_xor_b32 s97, s82, 0x326000
    buffer_load_dwordx4 v[140:143], v3, s[40:43], s97 offen
    v_perm_b32 v56, v199, v195, s38
    v_perm_b32 v57, v207, v203, s38
    v_mfma_f32_16x16x32_bf16 a[168:171], v[52:55], a[72:75], a[168:171]
    v_perm_b32 v58, v215, v211, s38
    v_perm_b32 v59, v223, v219, s38
    v_mfma_f32_16x16x32_bf16 a[172:175], v[52:55], a[88:91], a[172:175]
    v_perm_b32 v60, v199, v195, s39
    v_perm_b32 v61, v207, v203, s39
    v_mfma_f32_16x16x32_bf16 a[176:179], v[56:59], a[72:75], a[176:179]
    s_xor_b32 s97, s82, 0x328000
    buffer_load_dwordx4 v[144:147], v3, s[40:43], s97 offen
    v_perm_b32 v62, v215, v211, s39
    v_perm_b32 v63, v223, v219, s39
    v_mfma_f32_16x16x32_bf16 a[180:183], v[56:59], a[88:91], a[180:183]
    s_nop 0
    v_mfma_f32_16x16x32_bf16 a[184:187], v[60:63], a[72:75], a[184:187]
    v_mfma_f32_16x16x32_bf16 a[188:191], v[60:63], a[88:91], a[188:191]
    s_xor_b32 s97, s82, 0x32a000
    buffer_load_dwordx4 v[148:151], v3, s[40:43], s97 offen
    s_xor_b32 s97, s82, 0x32c000
    buffer_load_dwordx4 v[152:155], v3, s[40:43], s97 offen
    s_xor_b32 s97, s82, 0x32e000
    buffer_load_dwordx4 v[156:159], v3, s[40:43], s97 offen
    s_waitcnt vmcnt(32)
    v_perm_b32 v32, v228, v224, s38
    v_perm_b32 v33, v236, v232, s38
    v_perm_b32 v34, v244, v240, s38
    v_perm_b32 v35, v252, v248, s38
    v_perm_b32 v36, v228, v224, s39
    v_perm_b32 v37, v236, v232, s39
    v_mfma_f32_16x16x32_bf16 a[128:131], v[32:35], a[76:79], a[128:131]
    v_perm_b32 v38, v244, v240, s39
    v_perm_b32 v39, v252, v248, s39
    s_xor_b32 s97, s82, 0x330000
    buffer_load_dwordx4 v[160:163], v3, s[40:43], s97 offen
    v_mfma_f32_16x16x32_bf16 a[132:135], v[32:35], a[92:95], a[132:135]
    v_perm_b32 v40, v229, v225, s38
    v_perm_b32 v41, v237, v233, s38
    v_mfma_f32_16x16x32_bf16 a[136:139], v[36:39], a[76:79], a[136:139]
    v_perm_b32 v42, v245, v241, s38
    v_perm_b32 v43, v253, v249, s38
    v_mfma_f32_16x16x32_bf16 a[140:143], v[36:39], a[92:95], a[140:143]
    v_perm_b32 v44, v229, v225, s39
    s_xor_b32 s97, s82, 0x332000
    buffer_load_dwordx4 v[164:167], v3, s[40:43], s97 offen
    v_perm_b32 v45, v237, v233, s39
    v_mfma_f32_16x16x32_bf16 a[144:147], v[40:43], a[76:79], a[144:147]
    v_perm_b32 v46, v245, v241, s39
    v_perm_b32 v47, v253, v249, s39
    v_mfma_f32_16x16x32_bf16 a[148:151], v[40:43], a[92:95], a[148:151]
    v_perm_b32 v48, v230, v226, s38
    v_perm_b32 v49, v238, v234, s38
    v_mfma_f32_16x16x32_bf16 a[152:155], v[44:47], a[76:79], a[152:155]
    s_xor_b32 s97, s82, 0x334000
    buffer_load_dwordx4 v[168:171], v3, s[40:43], s97 offen
    v_perm_b32 v50, v246, v242, s38
    v_perm_b32 v51, v254, v250, s38
    v_mfma_f32_16x16x32_bf16 a[156:159], v[44:47], a[92:95], a[156:159]
    v_perm_b32 v52, v230, v226, s39
    v_perm_b32 v53, v238, v234, s39
    v_mfma_f32_16x16x32_bf16 a[160:163], v[48:51], a[76:79], a[160:163]
    v_perm_b32 v54, v246, v242, s39
    v_perm_b32 v55, v254, v250, s39
    v_mfma_f32_16x16x32_bf16 a[164:167], v[48:51], a[92:95], a[164:167]
    s_xor_b32 s97, s82, 0x336000
    buffer_load_dwordx4 v[172:175], v3, s[40:43], s97 offen
    v_perm_b32 v56, v231, v227, s38
    v_perm_b32 v57, v239, v235, s38
    v_mfma_f32_16x16x32_bf16 a[168:171], v[52:55], a[76:79], a[168:171]
    v_perm_b32 v58, v247, v243, s38
    v_perm_b32 v59, v255, v251, s38
    v_mfma_f32_16x16x32_bf16 a[172:175], v[52:55], a[92:95], a[172:175]
    v_perm_b32 v60, v231, v227, s39
    v_perm_b32 v61, v239, v235, s39
    v_mfma_f32_16x16x32_bf16 a[176:179], v[56:59], a[76:79], a[176:179]
    s_xor_b32 s97, s82, 0x338000
    buffer_load_dwordx4 v[176:179], v3, s[40:43], s97 offen
    v_perm_b32 v62, v247, v243, s39
    v_perm_b32 v63, v255, v251, s39
    v_mfma_f32_16x16x32_bf16 a[180:183], v[56:59], a[92:95], a[180:183]
    s_nop 0
    v_mfma_f32_16x16x32_bf16 a[184:187], v[60:63], a[76:79], a[184:187]
    v_mfma_f32_16x16x32_bf16 a[188:191], v[60:63], a[92:95], a[188:191]
    s_xor_b32 s97, s82, 0x33a000
    buffer_load_dwordx4 v[180:183], v3, s[40:43], s97 offen
    s_xor_b32 s97, s82, 0x33c000
    buffer_load_dwordx4 v[184:187], v3, s[40:43], s97 offen
    s_xor_b32 s97, s82, 0x33e000
    buffer_load_dwordx4 v[188:191], v3, s[40:43], s97 offen
    s_waitcnt vmcnt(24)
    v_perm_b32 v32, v68, v64, s38
    v_perm_b32 v33, v76, v72, s38
    v_perm_b32 v34, v84, v80, s38
    v_perm_b32 v35, v92, v88, s38
    v_perm_b32 v36, v68, v64, s39
    v_perm_b32 v37, v76, v72, s39
    v_mfma_f32_16x16x32_bf16 a[128:131], v[32:35], a[96:99], a[128:131]
    v_perm_b32 v38, v84, v80, s39
    v_perm_b32 v39, v92, v88, s39
    v_mfma_f32_16x16x32_bf16 a[132:135], v[32:35], a[112:115], a[132:135]
    v_perm_b32 v40, v69, v65, s38
    v_perm_b32 v41, v77, v73, s38
    v_mfma_f32_16x16x32_bf16 a[136:139], v[36:39], a[96:99], a[136:139]
    v_perm_b32 v42, v85, v81, s38
    v_perm_b32 v43, v93, v89, s38
    v_mfma_f32_16x16x32_bf16 a[140:143], v[36:39], a[112:115], a[140:143]
    v_perm_b32 v44, v69, v65, s39
    v_perm_b32 v45, v77, v73, s39
    v_mfma_f32_16x16x32_bf16 a[144:147], v[40:43], a[96:99], a[144:147]
    v_perm_b32 v46, v85, v81, s39
    v_perm_b32 v47, v93, v89, s39
    v_mfma_f32_16x16x32_bf16 a[148:151], v[40:43], a[112:115], a[148:151]
    v_perm_b32 v48, v70, v66, s38
    v_perm_b32 v49, v78, v74, s38
    v_mfma_f32_16x16x32_bf16 a[152:155], v[44:47], a[96:99], a[152:155]
    v_perm_b32 v50, v86, v82, s38
    v_perm_b32 v51, v94, v90, s38
    v_mfma_f32_16x16x32_bf16 a[156:159], v[44:47], a[112:115], a[156:159]
    v_perm_b32 v52, v70, v66, s39
    v_perm_b32 v53, v78, v74, s39
    v_mfma_f32_16x16x32_bf16 a[160:163], v[48:51], a[96:99], a[160:163]
    v_perm_b32 v54, v86, v82, s39
    v_perm_b32 v55, v94, v90, s39
    v_mfma_f32_16x16x32_bf16 a[164:167], v[48:51], a[112:115], a[164:167]
    v_perm_b32 v56, v71, v67, s38
    v_perm_b32 v57, v79, v75, s38
    v_mfma_f32_16x16x32_bf16 a[168:171], v[52:55], a[96:99], a[168:171]
    v_perm_b32 v58, v87, v83, s38
    v_perm_b32 v59, v95, v91, s38
    v_mfma_f32_16x16x32_bf16 a[172:175], v[52:55], a[112:115], a[172:175]
    v_perm_b32 v60, v71, v67, s39
    v_perm_b32 v61, v79, v75, s39
    v_mfma_f32_16x16x32_bf16 a[176:179], v[56:59], a[96:99], a[176:179]
    v_perm_b32 v62, v87, v83, s39
    v_perm_b32 v63, v95, v91, s39
    v_mfma_f32_16x16x32_bf16 a[180:183], v[56:59], a[112:115], a[180:183]
    s_nop 0
    v_mfma_f32_16x16x32_bf16 a[184:187], v[60:63], a[96:99], a[184:187]
    v_mfma_f32_16x16x32_bf16 a[188:191], v[60:63], a[112:115], a[188:191]
    s_waitcnt vmcnt(16)
    v_perm_b32 v32, v100, v96, s38
    v_perm_b32 v33, v108, v104, s38
    v_perm_b32 v34, v116, v112, s38
    v_perm_b32 v35, v124, v120, s38
    v_perm_b32 v36, v100, v96, s39
    v_perm_b32 v37, v108, v104, s39
    v_mfma_f32_16x16x32_bf16 a[128:131], v[32:35], a[100:103], a[128:131]
    v_perm_b32 v38, v116, v112, s39
    v_perm_b32 v39, v124, v120, s39
    v_mfma_f32_16x16x32_bf16 a[132:135], v[32:35], a[116:119], a[132:135]
    v_perm_b32 v40, v101, v97, s38
    v_perm_b32 v41, v109, v105, s38
    v_mfma_f32_16x16x32_bf16 a[136:139], v[36:39], a[100:103], a[136:139]
    v_perm_b32 v42, v117, v113, s38
    v_perm_b32 v43, v125, v121, s38
    v_mfma_f32_16x16x32_bf16 a[140:143], v[36:39], a[116:119], a[140:143]
    v_perm_b32 v44, v101, v97, s39
    v_perm_b32 v45, v109, v105, s39
    v_mfma_f32_16x16x32_bf16 a[144:147], v[40:43], a[100:103], a[144:147]
    v_perm_b32 v46, v117, v113, s39
    v_perm_b32 v47, v125, v121, s39
    v_mfma_f32_16x16x32_bf16 a[148:151], v[40:43], a[116:119], a[148:151]
    v_perm_b32 v48, v102, v98, s38
    v_perm_b32 v49, v110, v106, s38
    v_mfma_f32_16x16x32_bf16 a[152:155], v[44:47], a[100:103], a[152:155]
    v_perm_b32 v50, v118, v114, s38
    v_perm_b32 v51, v126, v122, s38
    v_mfma_f32_16x16x32_bf16 a[156:159], v[44:47], a[116:119], a[156:159]
    v_perm_b32 v52, v102, v98, s39
    v_perm_b32 v53, v110, v106, s39
    v_mfma_f32_16x16x32_bf16 a[160:163], v[48:51], a[100:103], a[160:163]
    v_perm_b32 v54, v118, v114, s39
    v_perm_b32 v55, v126, v122, s39
    v_mfma_f32_16x16x32_bf16 a[164:167], v[48:51], a[116:119], a[164:167]
    v_perm_b32 v56, v103, v99, s38
    v_perm_b32 v57, v111, v107, s38
    v_mfma_f32_16x16x32_bf16 a[168:171], v[52:55], a[100:103], a[168:171]
    v_perm_b32 v58, v119, v115, s38
    v_perm_b32 v59, v127, v123, s38
    v_mfma_f32_16x16x32_bf16 a[172:175], v[52:55], a[116:119], a[172:175]
    v_perm_b32 v60, v103, v99, s39
    v_perm_b32 v61, v111, v107, s39
    v_mfma_f32_16x16x32_bf16 a[176:179], v[56:59], a[100:103], a[176:179]
    v_perm_b32 v62, v119, v115, s39
    v_perm_b32 v63, v127, v123, s39
    v_mfma_f32_16x16x32_bf16 a[180:183], v[56:59], a[116:119], a[180:183]
    s_nop 0
    v_mfma_f32_16x16x32_bf16 a[184:187], v[60:63], a[100:103], a[184:187]
    v_mfma_f32_16x16x32_bf16 a[188:191], v[60:63], a[116:119], a[188:191]
    s_waitcnt vmcnt(8)
    v_perm_b32 v32, v132, v128, s38
    v_perm_b32 v33, v140, v136, s38
    v_perm_b32 v34, v148, v144, s38
    v_perm_b32 v35, v156, v152, s38
    v_perm_b32 v36, v132, v128, s39
    v_perm_b32 v37, v140, v136, s39
    v_mfma_f32_16x16x32_bf16 a[128:131], v[32:35], a[104:107], a[128:131]
    v_perm_b32 v38, v148, v144, s39
    v_perm_b32 v39, v156, v152, s39
    v_mfma_f32_16x16x32_bf16 a[132:135], v[32:35], a[120:123], a[132:135]
    v_perm_b32 v40, v133, v129, s38
    v_perm_b32 v41, v141, v137, s38
    v_mfma_f32_16x16x32_bf16 a[136:139], v[36:39], a[104:107], a[136:139]
    v_perm_b32 v42, v149, v145, s38
    v_perm_b32 v43, v157, v153, s38
    v_mfma_f32_16x16x32_bf16 a[140:143], v[36:39], a[120:123], a[140:143]
    v_perm_b32 v44, v133, v129, s39
    v_perm_b32 v45, v141, v137, s39
    v_mfma_f32_16x16x32_bf16 a[144:147], v[40:43], a[104:107], a[144:147]
    v_perm_b32 v46, v149, v145, s39
    v_perm_b32 v47, v157, v153, s39
    v_mfma_f32_16x16x32_bf16 a[148:151], v[40:43], a[120:123], a[148:151]
    v_perm_b32 v48, v134, v130, s38
    v_perm_b32 v49, v142, v138, s38
    v_mfma_f32_16x16x32_bf16 a[152:155], v[44:47], a[104:107], a[152:155]
    v_perm_b32 v50, v150, v146, s38
    v_perm_b32 v51, v158, v154, s38
    v_mfma_f32_16x16x32_bf16 a[156:159], v[44:47], a[120:123], a[156:159]
    v_perm_b32 v52, v134, v130, s39
    v_perm_b32 v53, v142, v138, s39
    v_mfma_f32_16x16x32_bf16 a[160:163], v[48:51], a[104:107], a[160:163]
    v_perm_b32 v54, v150, v146, s39
    v_perm_b32 v55, v158, v154, s39
    v_mfma_f32_16x16x32_bf16 a[164:167], v[48:51], a[120:123], a[164:167]
    v_perm_b32 v56, v135, v131, s38
    v_perm_b32 v57, v143, v139, s38
    v_mfma_f32_16x16x32_bf16 a[168:171], v[52:55], a[104:107], a[168:171]
    v_perm_b32 v58, v151, v147, s38
    v_perm_b32 v59, v159, v155, s38
    v_mfma_f32_16x16x32_bf16 a[172:175], v[52:55], a[120:123], a[172:175]
    v_perm_b32 v60, v135, v131, s39
    v_perm_b32 v61, v143, v139, s39
    v_mfma_f32_16x16x32_bf16 a[176:179], v[56:59], a[104:107], a[176:179]
    v_perm_b32 v62, v151, v147, s39
    v_perm_b32 v63, v159, v155, s39
    v_mfma_f32_16x16x32_bf16 a[180:183], v[56:59], a[120:123], a[180:183]
    s_nop 0
    v_mfma_f32_16x16x32_bf16 a[184:187], v[60:63], a[104:107], a[184:187]
    v_mfma_f32_16x16x32_bf16 a[188:191], v[60:63], a[120:123], a[188:191]
    s_waitcnt vmcnt(0)
    v_perm_b32 v32, v164, v160, s38
    v_perm_b32 v33, v172, v168, s38
    v_perm_b32 v34, v180, v176, s38
    v_perm_b32 v35, v188, v184, s38
    v_perm_b32 v36, v164, v160, s39
    v_perm_b32 v37, v172, v168, s39
    v_mfma_f32_16x16x32_bf16 a[128:131], v[32:35], a[108:111], a[128:131]
    v_perm_b32 v38, v180, v176, s39
    v_perm_b32 v39, v188, v184, s39
    v_mfma_f32_16x16x32_bf16 a[132:135], v[32:35], a[124:127], a[132:135]
    v_perm_b32 v40, v165, v161, s38
    v_perm_b32 v41, v173, v169, s38
    v_mfma_f32_16x16x32_bf16 a[136:139], v[36:39], a[108:111], a[136:139]
    v_perm_b32 v42, v181, v177, s38
    v_perm_b32 v43, v189, v185, s38
    v_mfma_f32_16x16x32_bf16 a[140:143], v[36:39], a[124:127], a[140:143]
    v_perm_b32 v44, v165, v161, s39
    v_perm_b32 v45, v173, v169, s39
    v_mfma_f32_16x16x32_bf16 a[144:147], v[40:43], a[108:111], a[144:147]
    v_perm_b32 v46, v181, v177, s39
    v_perm_b32 v47, v189, v185, s39
    v_mfma_f32_16x16x32_bf16 a[148:151], v[40:43], a[124:127], a[148:151]
    v_perm_b32 v48, v166, v162, s38
    v_perm_b32 v49, v174, v170, s38
    v_mfma_f32_16x16x32_bf16 a[152:155], v[44:47], a[108:111], a[152:155]
    v_perm_b32 v50, v182, v178, s38
    v_perm_b32 v51, v190, v186, s38
    v_mfma_f32_16x16x32_bf16 a[156:159], v[44:47], a[124:127], a[156:159]
    v_perm_b32 v52, v166, v162, s39
    v_perm_b32 v53, v174, v170, s39
    v_mfma_f32_16x16x32_bf16 a[160:163], v[48:51], a[108:111], a[160:163]
    v_perm_b32 v54, v182, v178, s39
    v_perm_b32 v55, v190, v186, s39
    v_mfma_f32_16x16x32_bf16 a[164:167], v[48:51], a[124:127], a[164:167]
    v_perm_b32 v56, v167, v163, s38
    v_perm_b32 v57, v175, v171, s38
    v_mfma_f32_16x16x32_bf16 a[168:171], v[52:55], a[108:111], a[168:171]
    v_perm_b32 v58, v183, v179, s38
    v_perm_b32 v59, v191, v187, s38
    v_mfma_f32_16x16x32_bf16 a[172:175], v[52:55], a[124:127], a[172:175]
    v_perm_b32 v60, v167, v163, s39
    v_perm_b32 v61, v175, v171, s39
    v_mfma_f32_16x16x32_bf16 a[176:179], v[56:59], a[108:111], a[176:179]
    v_perm_b32 v62, v183, v179, s39
    v_perm_b32 v63, v191, v187, s39
    v_mfma_f32_16x16x32_bf16 a[180:183], v[56:59], a[124:127], a[180:183]
    s_nop 0
    v_mfma_f32_16x16x32_bf16 a[184:187], v[60:63], a[108:111], a[184:187]
    v_mfma_f32_16x16x32_bf16 a[188:191], v[60:63], a[124:127], a[188:191]
    v_accvgpr_read_b32 v10, a128
    v_accvgpr_read_b32 v11, a136
    v_accvgpr_read_b32 v12, a144
    v_accvgpr_read_b32 v13, a152
    v_accvgpr_read_b32 v14, a160
    v_accvgpr_read_b32 v15, a168
    v_accvgpr_read_b32 v16, a176
    v_accvgpr_read_b32 v17, a184
    v_cvt_pk_bf16_f32 v32, v10, v11
    v_cvt_pk_bf16_f32 v33, v12, v13
    v_cvt_pk_bf16_f32 v34, v14, v15
    v_cvt_pk_bf16_f32 v35, v16, v17
    v_accvgpr_read_b32 v10, a129
    v_accvgpr_read_b32 v11, a137
    v_accvgpr_read_b32 v12, a145
    v_accvgpr_read_b32 v13, a153
    v_accvgpr_read_b32 v14, a161
    v_accvgpr_read_b32 v15, a169
    v_accvgpr_read_b32 v16, a177
    v_accvgpr_read_b32 v17, a185
    v_cvt_pk_bf16_f32 v40, v10, v11
    v_cvt_pk_bf16_f32 v41, v12, v13
    v_cvt_pk_bf16_f32 v42, v14, v15
    v_cvt_pk_bf16_f32 v43, v16, v17
    v_accvgpr_read_b32 v10, a130
    v_accvgpr_read_b32 v11, a138
    v_accvgpr_read_b32 v12, a146
    v_accvgpr_read_b32 v13, a154
    v_accvgpr_read_b32 v14, a162
    v_accvgpr_read_b32 v15, a170
    v_accvgpr_read_b32 v16, a178
    v_accvgpr_read_b32 v17, a186
    v_cvt_pk_bf16_f32 v48, v10, v11
    v_cvt_pk_bf16_f32 v49, v12, v13
    v_cvt_pk_bf16_f32 v50, v14, v15
    v_cvt_pk_bf16_f32 v51, v16, v17
    v_accvgpr_read_b32 v10, a131
    v_accvgpr_read_b32 v11, a139
    v_accvgpr_read_b32 v12, a147
    v_accvgpr_read_b32 v13, a155
    v_accvgpr_read_b32 v14, a163
    v_accvgpr_read_b32 v15, a171
    v_accvgpr_read_b32 v16, a179
    v_accvgpr_read_b32 v17, a187
    v_cvt_pk_bf16_f32 v56, v10, v11
    v_cvt_pk_bf16_f32 v57, v12, v13
    v_cvt_pk_bf16_f32 v58, v14, v15
    v_cvt_pk_bf16_f32 v59, v16, v17
    v_accvgpr_read_b32 v10, a132
    v_accvgpr_read_b32 v11, a140
    v_accvgpr_read_b32 v12, a148
    v_accvgpr_read_b32 v13, a156
    v_accvgpr_read_b32 v14, a164
    v_accvgpr_read_b32 v15, a172
    v_accvgpr_read_b32 v16, a180
    v_accvgpr_read_b32 v17, a188
    v_cvt_pk_bf16_f32 v36, v10, v11
    v_cvt_pk_bf16_f32 v37, v12, v13
    v_cvt_pk_bf16_f32 v38, v14, v15
    v_cvt_pk_bf16_f32 v39, v16, v17
    v_accvgpr_read_b32 v10, a133
    v_accvgpr_read_b32 v11, a141
    v_accvgpr_read_b32 v12, a149
    v_accvgpr_read_b32 v13, a157
    v_accvgpr_read_b32 v14, a165
    v_accvgpr_read_b32 v15, a173
    v_accvgpr_read_b32 v16, a181
    v_accvgpr_read_b32 v17, a189
    v_cvt_pk_bf16_f32 v44, v10, v11
    v_cvt_pk_bf16_f32 v45, v12, v13
    v_cvt_pk_bf16_f32 v46, v14, v15
    v_cvt_pk_bf16_f32 v47, v16, v17
    v_accvgpr_read_b32 v10, a134
    v_accvgpr_read_b32 v11, a142
    v_accvgpr_read_b32 v12, a150
    v_accvgpr_read_b32 v13, a158
    v_accvgpr_read_b32 v14, a166
    v_accvgpr_read_b32 v15, a174
    v_accvgpr_read_b32 v16, a182
    v_accvgpr_read_b32 v17, a190
    v_cvt_pk_bf16_f32 v52, v10, v11
    v_cvt_pk_bf16_f32 v53, v12, v13
    v_cvt_pk_bf16_f32 v54, v14, v15
    v_cvt_pk_bf16_f32 v55, v16, v17
    v_accvgpr_read_b32 v10, a135
    v_accvgpr_read_b32 v11, a143
    v_accvgpr_read_b32 v12, a151
    v_accvgpr_read_b32 v13, a159
    v_accvgpr_read_b32 v14, a167
    v_accvgpr_read_b32 v15, a175
    v_accvgpr_read_b32 v16, a183
    v_accvgpr_read_b32 v17, a191
    v_cvt_pk_bf16_f32 v60, v10, v11
    v_cvt_pk_bf16_f32 v61, v12, v13
    v_cvt_pk_bf16_f32 v62, v14, v15
    v_cvt_pk_bf16_f32 v63, v16, v17
    s_barrier
    v_lshlrev_b32 v3, 3, v0
    s_sub_u32 s6, 0, s98
    s_xor_b32 s97, s99, 0x0
    buffer_load_dwordx4 v[192:195], v0, s[56:59], s97 offen nt
    v_add_u32 v30, s6, v2
    ds_read_b128 v[128:131], v30
    ds_read_b128 v[132:135], v30 offset:16
    ds_read_b128 v[136:139], v30 offset:32
    ds_read_b128 v[140:143], v30 offset:48
    ds_read_b128 v[144:147], v30 offset:4160
    ds_read_b128 v[148:151], v30 offset:4176
    ds_read_b128 v[152:155], v30 offset:4192
    ds_read_b128 v[156:159], v30 offset:4208
    s_waitcnt lgkmcnt(0)
    s_xor_b32 s97, s99, 0x400
    buffer_load_dwordx4 v[196:199], v0, s[56:59], s97 offen nt
    s_sub_u32 s6, 0, s98
    v_add_u32 v30, s6, v2
    ds_read_b128 v[160:163], v30 offset:8320
    ds_read_b128 v[164:167], v30 offset:8336
    ds_read_b128 v[168:171], v30 offset:8352
    ds_read_b128 v[172:175], v30 offset:8368
    ds_read_b128 v[176:179], v30 offset:12480
    ds_read_b128 v[180:183], v30 offset:12496
    ds_read_b128 v[184:187], v30 offset:12512
    ds_read_b128 v[188:191], v30 offset:12528
    v_mfma_f32_16x16x32_bf16 a[0:3], v[128:131], v[32:35], 0
    v_mfma_f32_16x16x32_bf16 a[4:7], v[128:131], v[36:39], 0
    v_mfma_f32_16x16x32_bf16 a[8:11], v[144:147], v[32:35], 0
    v_mfma_f32_16x16x32_bf16 a[12:15], v[144:147], v[36:39], 0
    s_xor_b32 s97, s99, 0x800
    buffer_load_dwordx4 v[200:203], v0, s[56:59], s97 offen nt
    v_mfma_f32_16x16x32_bf16 a[0:3], v[132:135], v[40:43], a[0:3]
    v_mfma_f32_16x16x32_bf16 a[4:7], v[132:135], v[44:47], a[4:7]
    v_mfma_f32_16x16x32_bf16 a[8:11], v[148:151], v[40:43], a[8:11]
    v_mfma_f32_16x16x32_bf16 a[12:15], v[148:151], v[44:47], a[12:15]
    v_mfma_f32_16x16x32_bf16 a[0:3], v[136:139], v[48:51], a[0:3]
    v_mfma_f32_16x16x32_bf16 a[4:7], v[136:139], v[52:55], a[4:7]
    v_mfma_f32_16x16x32_bf16 a[8:11], v[152:155], v[48:51], a[8:11]
    v_mfma_f32_16x16x32_bf16 a[12:15], v[152:155], v[52:55], a[12:15]
    v_mfma_f32_16x16x32_bf16 a[0:3], v[140:143], v[56:59], a[0:3]
    s_xor_b32 s97, s99, 0xc00
    buffer_load_dwordx4 v[204:207], v0, s[56:59], s97 offen nt
    v_mfma_f32_16x16x32_bf16 a[4:7], v[140:143], v[60:63], a[4:7]
    v_mfma_f32_16x16x32_bf16 a[8:11], v[156:159], v[56:59], a[8:11]
    v_mfma_f32_16x16x32_bf16 a[12:15], v[156:159], v[60:63], a[12:15]
    s_waitcnt lgkmcnt(0)
    s_sub_u32 s6, 0, s98
    v_add_u32 v30, s6, v2
    ds_read_b128 v[128:131], v30 offset:16640
    ds_read_b128 v[132:135], v30 offset:16656
    ds_read_b128 v[136:139], v30 offset:16672
    s_xor_b32 s97, s99, 0x1000
    buffer_load_dwordx4 v[208:211], v0, s[56:59], s97 offen nt
    ds_read_b128 v[140:143], v30 offset:16688
    ds_read_b128 v[144:147], v30 offset:20800
    ds_read_b128 v[148:151], v30 offset:20816
    ds_read_b128 v[152:155], v30 offset:20832
    ds_read_b128 v[156:159], v30 offset:20848
    v_mfma_f32_16x16x32_bf16 a[16:19], v[160:163], v[32:35], 0
    v_mfma_f32_16x16x32_bf16 a[20:23], v[160:163], v[36:39], 0
    v_mfma_f32_16x16x32_bf16 a[24:27], v[176:179], v[32:35], 0
    v_mfma_f32_16x16x32_bf16 a[28:31], v[176:179], v[36:39], 0
    v_accvgpr_read_b32 v10, a0
    v_accvgpr_read_b32 v11, a1
    v_mfma_f32_16x16x32_bf16 a[16:19], v[164:167], v[40:43], a[16:19]
    v_accvgpr_read_b32 v12, a2
    v_accvgpr_read_b32 v13, a3
    v_mfma_f32_16x16x32_bf16 a[20:23], v[164:167], v[44:47], a[20:23]
    s_xor_b32 s97, s99, 0x1400
    buffer_load_dwordx4 v[212:215], v0, s[56:59], s97 offen nt
    v_accvgpr_read_b32 v14, a8
    v_accvgpr_read_b32 v15, a9
    v_mfma_f32_16x16x32_bf16 a[24:27], v[180:183], v[40:43], a[24:27]
    v_accvgpr_read_b32 v16, a10
    v_accvgpr_read_b32 v17, a11
    v_mfma_f32_16x16x32_bf16 a[28:31], v[180:183], v[44:47], a[28:31]
    v_accvgpr_read_b32 v18, a4
    v_accvgpr_read_b32 v19, a5
    v_mfma_f32_16x16x32_bf16 a[16:19], v[168:171], v[48:51], a[16:19]
    v_accvgpr_read_b32 v20, a6
    v_accvgpr_read_b32 v21, a7
    v_mfma_f32_16x16x32_bf16 a[20:23], v[168:171], v[52:55], a[20:23]
    v_accvgpr_read_b32 v22, a12
    v_accvgpr_read_b32 v23, a13
    v_mfma_f32_16x16x32_bf16 a[24:27], v[184:187], v[48:51], a[24:27]
    v_accvgpr_read_b32 v24, a14
    v_accvgpr_read_b32 v25, a15
    v_mfma_f32_16x16x32_bf16 a[28:31], v[184:187], v[52:55], a[28:31]
    v_max3_f32 v26, v10, v11, v12
    v_max3_f32 v26, v26, v13, v14
    v_mfma_f32_16x16x32_bf16 a[16:19], v[172:175], v[56:59], a[16:19]
    v_max3_f32 v26, v26, v15, v16
    v_max_f32 v26, v26, v17
    v_mfma_f32_16x16x32_bf16 a[20:23], v[172:175], v[60:63], a[20:23]
    v_max3_f32 v27, v18, v19, v20
    v_max3_f32 v27, v27, v21, v22
    s_xor_b32 s97, s99, 0x1800
    buffer_load_dwordx4 v[216:219], v0, s[56:59], s97 offen nt
    v_mfma_f32_16x16x32_bf16 a[24:27], v[188:191], v[56:59], a[24:27]
    v_max3_f32 v27, v27, v23, v24
    v_max_f32 v27, v27, v25
    v_mfma_f32_16x16x32_bf16 a[28:31], v[188:191], v[60:63], a[28:31]
    s_waitcnt lgkmcnt(0)
    s_sub_u32 s6, 0, s98
    v_add_u32 v30, s6, v2
    ds_read_b128 v[160:163], v30 offset:24960
    ds_read_b128 v[164:167], v30 offset:24976
    ds_read_b128 v[168:171], v30 offset:24992
    ds_read_b128 v[172:175], v30 offset:25008
    ds_read_b128 v[176:179], v30 offset:29120
    s_xor_b32 s97, s99, 0x1c00
    buffer_load_dwordx4 v[220:223], v0, s[56:59], s97 offen nt
    ds_read_b128 v[180:183], v30 offset:29136
    ds_read_b128 v[184:187], v30 offset:29152
    ds_read_b128 v[188:191], v30 offset:29168
    v_mfma_f32_16x16x32_bf16 a[32:35], v[128:131], v[32:35], 0
    v_mfma_f32_16x16x32_bf16 a[36:39], v[128:131], v[36:39], 0
    v_mfma_f32_16x16x32_bf16 a[40:43], v[144:147], v[32:35], 0
    v_mfma_f32_16x16x32_bf16 a[44:47], v[144:147], v[36:39], 0
    v_accvgpr_read_b32 v10, a16
    v_accvgpr_read_b32 v11, a17
    v_mfma_f32_16x16x32_bf16 a[32:35], v[132:135], v[40:43], a[32:35]
    v_accvgpr_read_b32 v12, a18
    v_accvgpr_read_b32 v13, a19
    v_mfma_f32_16x16x32_bf16 a[36:39], v[132:135], v[44:47], a[36:39]
    v_accvgpr_read_b32 v14, a24
    v_accvgpr_read_b32 v15, a25
    v_mfma_f32_16x16x32_bf16 a[40:43], v[148:151], v[40:43], a[40:43]
    s_xor_b32 s97, s99, 0x8000
    buffer_load_dwordx4 v[224:227], v0, s[56:59], s97 offen nt
    v_accvgpr_read_b32 v16, a26
    v_accvgpr_read_b32 v17, a27
    v_mfma_f32_16x16x32_bf16 a[44:47], v[148:151], v[44:47], a[44:47]
    v_accvgpr_read_b32 v18, a20
    v_accvgpr_read_b32 v19, a21
    v_mfma_f32_16x16x32_bf16 a[32:35], v[136:139], v[48:51], a[32:35]
    v_accvgpr_read_b32 v20, a22
    v_accvgpr_read_b32 v21, a23
    v_mfma_f32_16x16x32_bf16 a[36:39], v[136:139], v[52:55], a[36:39]
    v_accvgpr_read_b32 v22, a28
    v_accvgpr_read_b32 v23, a29
    v_mfma_f32_16x16x32_bf16 a[40:43], v[152:155], v[48:51], a[40:43]
    v_accvgpr_read_b32 v24, a30
    v_accvgpr_read_b32 v25, a31
    v_mfma_f32_16x16x32_bf16 a[44:47], v[152:155], v[52:55], a[44:47]
    v_max3_f32 v26, v26, v10, v11
    v_max3_f32 v26, v26, v12, v13
    v_mfma_f32_16x16x32_bf16 a[32:35], v[140:143], v[56:59], a[32:35]
    v_max3_f32 v26, v26, v14, v15
    v_max3_f32 v26, v26, v16, v17
    v_mfma_f32_16x16x32_bf16 a[36:39], v[140:143], v[60:63], a[36:39]
    v_max3_f32 v27, v27, v18, v19
    v_max3_f32 v27, v27, v20, v21
    v_mfma_f32_16x16x32_bf16 a[40:43], v[156:159], v[56:59], a[40:43]
    v_max3_f32 v27, v27, v22, v23
    v_max3_f32 v27, v27, v24, v25
    s_xor_b32 s97, s99, 0x8400
    buffer_load_dwordx4 v[228:231], v0, s[56:59], s97 offen nt
    v_mfma_f32_16x16x32_bf16 a[44:47], v[156:159], v[60:63], a[44:47]
    s_waitcnt lgkmcnt(0)
    s_sub_u32 s6, 33280, s98
    v_add_u32 v30, s6, v2
    ds_read_b128 v[128:131], v30
    ds_read_b128 v[132:135], v30 offset:16
    ds_read_b128 v[136:139], v30 offset:32
    ds_read_b128 v[140:143], v30 offset:48
    ds_read_b128 v[144:147], v30 offset:4160
    ds_read_b128 v[148:151], v30 offset:4176
    s_xor_b32 s97, s99, 0x8800
    buffer_load_dwordx4 v[232:235], v0, s[56:59], s97 offen nt
    ds_read_b128 v[152:155], v30 offset:4192
    ds_read_b128 v[156:159], v30 offset:4208
    v_mfma_f32_16x16x32_bf16 a[48:51], v[160:163], v[32:35], 0
    v_mfma_f32_16x16x32_bf16 a[52:55], v[160:163], v[36:39], 0
    v_mfma_f32_16x16x32_bf16 a[56:59], v[176:179], v[32:35], 0
    v_mfma_f32_16x16x32_bf16 a[60:63], v[176:179], v[36:39], 0
    v_accvgpr_read_b32 v10, a32
    v_accvgpr_read_b32 v11, a33
    v_mfma_f32_16x16x32_bf16 a[48:51], v[164:167], v[40:43], a[48:51]
    v_accvgpr_read_b32 v12, a34
    v_accvgpr_read_b32 v13, a35
    v_mfma_f32_16x16x32_bf16 a[52:55], v[164:167], v[44:47], a[52:55]
    v_accvgpr_read_b32 v14, a40
    v_accvgpr_read_b32 v15, a41
    v_mfma_f32_16x16x32_bf16 a[56:59], v[180:183], v[40:43], a[56:59]
    v_accvgpr_read_b32 v16, a42
    v_accvgpr_read_b32 v17, a43
    v_mfma_f32_16x16x32_bf16 a[60:63], v[180:183], v[44:47], a[60:63]
    s_xor_b32 s97, s99, 0x8c00
    buffer_load_dwordx4 v[236:239], v0, s[56:59], s97 offen nt
    v_accvgpr_read_b32 v18, a36
    v_accvgpr_read_b32 v19, a37
    v_mfma_f32_16x16x32_bf16 a[48:51], v[168:171], v[48:51], a[48:51]
    v_accvgpr_read_b32 v20, a38
    v_accvgpr_read_b32 v21, a39
    v_mfma_f32_16x16x32_bf16 a[52:55], v[168:171], v[52:55], a[52:55]
    v_accvgpr_read_b32 v22, a44
    v_accvgpr_read_b32 v23, a45
    v_mfma_f32_16x16x32_bf16 a[56:59], v[184:187], v[48:51], a[56:59]
    v_accvgpr_read_b32 v24, a46
    v_accvgpr_read_b32 v25, a47
    v_mfma_f32_16x16x32_bf16 a[60:63], v[184:187], v[52:55], a[60:63]
    v_max3_f32 v26, v26, v10, v11
    v_max3_f32 v26, v26, v12, v13
    v_mfma_f32_16x16x32_bf16 a[48:51], v[172:175], v[56:59], a[48:51]
    v_max3_f32 v26, v26, v14, v15
    v_max3_f32 v26, v26, v16, v17
    v_mfma_f32_16x16x32_bf16 a[52:55], v[172:175], v[60:63], a[52:55]
    v_max3_f32 v27, v27, v18, v19
    v_max3_f32 v27, v27, v20, v21
    v_mfma_f32_16x16x32_bf16 a[56:59], v[188:191], v[56:59], a[56:59]
    v_max3_f32 v27, v27, v22, v23
    v_max3_f32 v27, v27, v24, v25
    v_mfma_f32_16x16x32_bf16 a[60:63], v[188:191], v[60:63], a[60:63]
    s_waitcnt lgkmcnt(0)
    s_xor_b32 s97, s99, 0x9000
    buffer_load_dwordx4 v[240:243], v0, s[56:59], s97 offen nt
    s_sub_u32 s6, 33280, s98
    v_add_u32 v30, s6, v2
    ds_read_b128 v[160:163], v30 offset:8320
    ds_read_b128 v[164:167], v30 offset:8336
    ds_read_b128 v[168:171], v30 offset:8352
    ds_read_b128 v[172:175], v30 offset:8368
    ds_read_b128 v[176:179], v30 offset:12480
    ds_read_b128 v[180:183], v30 offset:12496
    ds_read_b128 v[184:187], v30 offset:12512
    ds_read_b128 v[188:191], v30 offset:12528
    v_mfma_f32_16x16x32_bf16 a[64:67], v[128:131], v[32:35], 0
    v_mfma_f32_16x16x32_bf16 a[68:71], v[128:131], v[36:39], 0
    v_mfma_f32_16x16x32_bf16 a[72:75], v[144:147], v[32:35], 0
    v_mfma_f32_16x16x32_bf16 a[76:79], v[144:147], v[36:39], 0
    s_xor_b32 s97, s99, 0x9400
    buffer_load_dwordx4 v[244:247], v0, s[56:59], s97 offen nt
    v_accvgpr_read_b32 v10, a48
    v_accvgpr_read_b32 v11, a49
    v_mfma_f32_16x16x32_bf16 a[64:67], v[132:135], v[40:43], a[64:67]
    v_accvgpr_read_b32 v12, a50
    v_accvgpr_read_b32 v13, a51
    v_mfma_f32_16x16x32_bf16 a[68:71], v[132:135], v[44:47], a[68:71]
    v_accvgpr_read_b32 v14, a56
    v_accvgpr_read_b32 v15, a57
    v_mfma_f32_16x16x32_bf16 a[72:75], v[148:151], v[40:43], a[72:75]
    v_accvgpr_read_b32 v16, a58
    v_accvgpr_read_b32 v17, a59
    v_mfma_f32_16x16x32_bf16 a[76:79], v[148:151], v[44:47], a[76:79]
    v_accvgpr_read_b32 v18, a52
    v_accvgpr_read_b32 v19, a53
    v_mfma_f32_16x16x32_bf16 a[64:67], v[136:139], v[48:51], a[64:67]
    v_accvgpr_read_b32 v20, a54
    v_accvgpr_read_b32 v21, a55
    v_mfma_f32_16x16x32_bf16 a[68:71], v[136:139], v[52:55], a[68:71]
    v_accvgpr_read_b32 v22, a60
    v_accvgpr_read_b32 v23, a61
    v_mfma_f32_16x16x32_bf16 a[72:75], v[152:155], v[48:51], a[72:75]
    v_accvgpr_read_b32 v24, a62
    v_accvgpr_read_b32 v25, a63
    v_mfma_f32_16x16x32_bf16 a[76:79], v[152:155], v[52:55], a[76:79]
    v_max3_f32 v26, v26, v10, v11
    v_max3_f32 v26, v26, v12, v13
    s_xor_b32 s97, s99, 0x9800
    buffer_load_dwordx4 v[248:251], v0, s[56:59], s97 offen nt
    v_mfma_f32_16x16x32_bf16 a[64:67], v[140:143], v[56:59], a[64:67]
    v_max3_f32 v26, v26, v14, v15
    v_max3_f32 v26, v26, v16, v17
    v_mfma_f32_16x16x32_bf16 a[68:71], v[140:143], v[60:63], a[68:71]
    v_max3_f32 v27, v27, v18, v19
    v_max3_f32 v27, v27, v20, v21
    v_mfma_f32_16x16x32_bf16 a[72:75], v[156:159], v[56:59], a[72:75]
    v_max3_f32 v27, v27, v22, v23
    v_max3_f32 v27, v27, v24, v25
    v_mfma_f32_16x16x32_bf16 a[76:79], v[156:159], v[60:63], a[76:79]
    s_waitcnt lgkmcnt(0)
    s_sub_u32 s6, 33280, s98
    v_add_u32 v30, s6, v2
    ds_read_b128 v[128:131], v30 offset:16640
    s_xor_b32 s97, s99, 0x9c00
    buffer_load_dwordx4 v[252:255], v0, s[56:59], s97 offen nt
    ds_read_b128 v[132:135], v30 offset:16656
    ds_read_b128 v[136:139], v30 offset:16672
    ds_read_b128 v[140:143], v30 offset:16688
    ds_read_b128 v[144:147], v30 offset:20800
    ds_read_b128 v[148:151], v30 offset:20816
    ds_read_b128 v[152:155], v30 offset:20832
    ds_read_b128 v[156:159], v30 offset:20848
    v_mfma_f32_16x16x32_bf16 a[80:83], v[160:163], v[32:35], 0
    v_mfma_f32_16x16x32_bf16 a[84:87], v[160:163], v[36:39], 0
    v_mfma_f32_16x16x32_bf16 a[88:91], v[176:179], v[32:35], 0
    v_mfma_f32_16x16x32_bf16 a[92:95], v[176:179], v[36:39], 0
    v_accvgpr_read_b32 v10, a64
    v_accvgpr_read_b32 v11, a65
    s_xor_b32 s97, s99, 0x10000
    buffer_load_dwordx4 v[64:67], v0, s[56:59], s97 offen nt
    v_mfma_f32_16x16x32_bf16 a[80:83], v[164:167], v[40:43], a[80:83]
    v_accvgpr_read_b32 v12, a66
    v_accvgpr_read_b32 v13, a67
    v_mfma_f32_16x16x32_bf16 a[84:87], v[164:167], v[44:47], a[84:87]
    v_accvgpr_read_b32 v14, a72
    v_accvgpr_read_b32 v15, a73
    v_mfma_f32_16x16x32_bf16 a[88:91], v[180:183], v[40:43], a[88:91]
    v_accvgpr_read_b32 v16, a74
    v_accvgpr_read_b32 v17, a75
    v_mfma_f32_16x16x32_bf16 a[92:95], v[180:183], v[44:47], a[92:95]
    v_accvgpr_read_b32 v18, a68
    v_accvgpr_read_b32 v19, a69
    v_mfma_f32_16x16x32_bf16 a[80:83], v[168:171], v[48:51], a[80:83]
    v_accvgpr_read_b32 v20, a70
    v_accvgpr_read_b32 v21, a71
    v_mfma_f32_16x16x32_bf16 a[84:87], v[168:171], v[52:55], a[84:87]
    v_accvgpr_read_b32 v22, a76
    v_accvgpr_read_b32 v23, a77
    v_mfma_f32_16x16x32_bf16 a[88:91], v[184:187], v[48:51], a[88:91]
    v_accvgpr_read_b32 v24, a78
    v_accvgpr_read_b32 v25, a79
    v_mfma_f32_16x16x32_bf16 a[92:95], v[184:187], v[52:55], a[92:95]
    v_max3_f32 v26, v26, v10, v11
    v_max3_f32 v26, v26, v12, v13
    v_mfma_f32_16x16x32_bf16 a[80:83], v[172:175], v[56:59], a[80:83]
    s_xor_b32 s97, s99, 0x10400
    buffer_load_dwordx4 v[68:71], v0, s[56:59], s97 offen nt
    v_max3_f32 v26, v26, v14, v15
    v_max3_f32 v26, v26, v16, v17
    v_mfma_f32_16x16x32_bf16 a[84:87], v[172:175], v[60:63], a[84:87]
    v_max3_f32 v27, v27, v18, v19
    v_max3_f32 v27, v27, v20, v21
    v_mfma_f32_16x16x32_bf16 a[88:91], v[188:191], v[56:59], a[88:91]
    v_max3_f32 v27, v27, v22, v23
    v_max3_f32 v27, v27, v24, v25
    v_mfma_f32_16x16x32_bf16 a[92:95], v[188:191], v[60:63], a[92:95]
    s_waitcnt lgkmcnt(0)
    s_sub_u32 s6, 33280, s98
    v_add_u32 v30, s6, v2
    ds_read_b128 v[160:163], v30 offset:24960
    ds_read_b128 v[164:167], v30 offset:24976
    s_xor_b32 s97, s99, 0x10800
    buffer_load_dwordx4 v[72:75], v0, s[56:59], s97 offen nt
    ds_read_b128 v[168:171], v30 offset:24992
    ds_read_b128 v[172:175], v30 offset:25008
    ds_read_b128 v[176:179], v30 offset:29120
    ds_read_b128 v[180:183], v30 offset:29136
    ds_read_b128 v[184:187], v30 offset:29152
    ds_read_b128 v[188:191], v30 offset:29168
    v_mfma_f32_16x16x32_bf16 a[96:99], v[128:131], v[32:35], 0
    v_mfma_f32_16x16x32_bf16 a[100:103], v[128:131], v[36:39], 0
    v_mfma_f32_16x16x32_bf16 a[104:107], v[144:147], v[32:35], 0
    v_mfma_f32_16x16x32_bf16 a[108:111], v[144:147], v[36:39], 0
    v_accvgpr_read_b32 v10, a80
    v_accvgpr_read_b32 v11, a81
    v_mfma_f32_16x16x32_bf16 a[96:99], v[132:135], v[40:43], a[96:99]
    v_accvgpr_read_b32 v12, a82
    s_xor_b32 s97, s99, 0x10c00
    buffer_load_dwordx4 v[76:79], v0, s[56:59], s97 offen nt
    v_accvgpr_read_b32 v13, a83
    v_mfma_f32_16x16x32_bf16 a[100:103], v[132:135], v[44:47], a[100:103]
    v_accvgpr_read_b32 v14, a88
    v_accvgpr_read_b32 v15, a89
    v_mfma_f32_16x16x32_bf16 a[104:107], v[148:151], v[40:43], a[104:107]
    v_accvgpr_read_b32 v16, a90
    v_accvgpr_read_b32 v17, a91
    v_mfma_f32_16x16x32_bf16 a[108:111], v[148:151], v[44:47], a[108:111]
    v_accvgpr_read_b32 v18, a84
    v_accvgpr_read_b32 v19, a85
    v_mfma_f32_16x16x32_bf16 a[96:99], v[136:139], v[48:51], a[96:99]
    v_accvgpr_read_b32 v20, a86
    v_accvgpr_read_b32 v21, a87
    v_mfma_f32_16x16x32_bf16 a[100:103], v[136:139], v[52:55], a[100:103]
    v_accvgpr_read_b32 v22, a92
    v_accvgpr_read_b32 v23, a93
    v_mfma_f32_16x16x32_bf16 a[104:107], v[152:155], v[48:51], a[104:107]
    v_accvgpr_read_b32 v24, a94
    v_accvgpr_read_b32 v25, a95
    v_mfma_f32_16x16x32_bf16 a[108:111], v[152:155], v[52:55], a[108:111]
    v_max3_f32 v26, v26, v10, v11
    v_max3_f32 v26, v26, v12, v13
    v_mfma_f32_16x16x32_bf16 a[96:99], v[140:143], v[56:59], a[96:99]
    v_max3_f32 v26, v26, v14, v15
    v_max3_f32 v26, v26, v16, v17
    v_mfma_f32_16x16x32_bf16 a[100:103], v[140:143], v[60:63], a[100:103]
    s_xor_b32 s97, s99, 0x11000
    buffer_load_dwordx4 v[80:83], v0, s[56:59], s97 offen nt
    v_max3_f32 v27, v27, v18, v19
    v_max3_f32 v27, v27, v20, v21
    v_mfma_f32_16x16x32_bf16 a[104:107], v[156:159], v[56:59], a[104:107]
    v_max3_f32 v27, v27, v22, v23
    v_max3_f32 v27, v27, v24, v25
    v_mfma_f32_16x16x32_bf16 a[108:111], v[156:159], v[60:63], a[108:111]
    s_waitcnt lgkmcnt(0)
    s_sub_u32 s6, 66560, s98
    v_add_u32 v30, s6, v2
    ds_read_b128 v[128:131], v30
    ds_read_b128 v[132:135], v30 offset:16
    ds_read_b128 v[136:139], v30 offset:32
    ds_read_b128 v[140:143], v30 offset:48
    s_xor_b32 s97, s99, 0x11400
    buffer_load_dwordx4 v[84:87], v0, s[56:59], s97 offen nt
    ds_read_b128 v[144:147], v30 offset:4160
    ds_read_b128 v[148:151], v30 offset:4176
    ds_read_b128 v[152:155], v30 offset:4192
    ds_read_b128 v[156:159], v30 offset:4208
    v_mfma_f32_16x16x32_bf16 a[112:115], v[160:163], v[32:35], 0
    v_mfma_f32_16x16x32_bf16 a[116:119], v[160:163], v[36:39], 0
    v_mfma_f32_16x16x32_bf16 a[120:123], v[176:179], v[32:35], 0
    v_mfma_f32_16x16x32_bf16 a[124:127], v[176:179], v[36:39], 0
    v_accvgpr_read_b32 v10, a96
    v_accvgpr_read_b32 v11, a97
    v_mfma_f32_16x16x32_bf16 a[112:115], v[164:167], v[40:43], a[112:115]
    v_accvgpr_read_b32 v12, a98
    v_accvgpr_read_b32 v13, a99
    v_mfma_f32_16x16x32_bf16 a[116:119], v[164:167], v[44:47], a[116:119]
    v_accvgpr_read_b32 v14, a104
    v_accvgpr_read_b32 v15, a105
    s_xor_b32 s97, s99, 0x11800
    buffer_load_dwordx4 v[88:91], v0, s[56:59], s97 offen nt
    v_mfma_f32_16x16x32_bf16 a[120:123], v[180:183], v[40:43], a[120:123]
    v_accvgpr_read_b32 v16, a106
    v_accvgpr_read_b32 v17, a107
    v_mfma_f32_16x16x32_bf16 a[124:127], v[180:183], v[44:47], a[124:127]
    v_accvgpr_read_b32 v18, a100
    v_accvgpr_read_b32 v19, a101
    v_mfma_f32_16x16x32_bf16 a[112:115], v[168:171], v[48:51], a[112:115]
    v_accvgpr_read_b32 v20, a102
    v_accvgpr_read_b32 v21, a103
    v_mfma_f32_16x16x32_bf16 a[116:119], v[168:171], v[52:55], a[116:119]
    v_accvgpr_read_b32 v22, a108
    v_accvgpr_read_b32 v23, a109
    v_mfma_f32_16x16x32_bf16 a[120:123], v[184:187], v[48:51], a[120:123]
    v_accvgpr_read_b32 v24, a110
    v_accvgpr_read_b32 v25, a111
    v_mfma_f32_16x16x32_bf16 a[124:127], v[184:187], v[52:55], a[124:127]
    v_max3_f32 v26, v26, v10, v11
    v_max3_f32 v26, v26, v12, v13
    v_mfma_f32_16x16x32_bf16 a[112:115], v[172:175], v[56:59], a[112:115]
    v_max3_f32 v26, v26, v14, v15
    v_max3_f32 v26, v26, v16, v17
    v_mfma_f32_16x16x32_bf16 a[116:119], v[172:175], v[60:63], a[116:119]
    v_max3_f32 v27, v27, v18, v19
    v_max3_f32 v27, v27, v20, v21
    v_mfma_f32_16x16x32_bf16 a[120:123], v[188:191], v[56:59], a[120:123]
    s_xor_b32 s97, s99, 0x11c00
    buffer_load_dwordx4 v[92:95], v0, s[56:59], s97 offen nt
    v_max3_f32 v27, v27, v22, v23
    v_max3_f32 v27, v27, v24, v25
    v_mfma_f32_16x16x32_bf16 a[124:127], v[188:191], v[60:63], a[124:127]
    s_waitcnt lgkmcnt(0)
    s_sub_u32 s6, 66560, s98
    v_add_u32 v30, s6, v2
    ds_read_b128 v[160:163], v30 offset:8320
    ds_read_b128 v[164:167], v30 offset:8336
    ds_read_b128 v[168:171], v30 offset:8352
    ds_read_b128 v[172:175], v30 offset:8368
    ds_read_b128 v[176:179], v30 offset:12480
    s_xor_b32 s97, s99, 0x18000
    buffer_load_dwordx4 v[96:99], v0, s[56:59], s97 offen nt
    ds_read_b128 v[180:183], v30 offset:12496
    ds_read_b128 v[184:187], v30 offset:12512
    ds_read_b128 v[188:191], v30 offset:12528
    v_mfma_f32_16x16x32_bf16 a[128:131], v[128:131], v[32:35], 0
    v_mfma_f32_16x16x32_bf16 a[132:135], v[128:131], v[36:39], 0
    v_mfma_f32_16x16x32_bf16 a[136:139], v[144:147], v[32:35], 0
    v_mfma_f32_16x16x32_bf16 a[140:143], v[144:147], v[36:39], 0
    v_accvgpr_read_b32 v10, a112
    v_accvgpr_read_b32 v11, a113
    v_mfma_f32_16x16x32_bf16 a[128:131], v[132:135], v[40:43], a[128:131]
    v_accvgpr_read_b32 v12, a114
    v_accvgpr_read_b32 v13, a115
    v_mfma_f32_16x16x32_bf16 a[132:135], v[132:135], v[44:47], a[132:135]
    v_accvgpr_read_b32 v14, a120
    v_accvgpr_read_b32 v15, a121
    v_mfma_f32_16x16x32_bf16 a[136:139], v[148:151], v[40:43], a[136:139]
    s_xor_b32 s97, s99, 0x18400
    buffer_load_dwordx4 v[100:103], v0, s[56:59], s97 offen nt
    v_accvgpr_read_b32 v16, a122
    v_accvgpr_read_b32 v17, a123
    v_mfma_f32_16x16x32_bf16 a[140:143], v[148:151], v[44:47], a[140:143]
    v_accvgpr_read_b32 v18, a116
    v_accvgpr_read_b32 v19, a117
    v_mfma_f32_16x16x32_bf16 a[128:131], v[136:139], v[48:51], a[128:131]
    v_accvgpr_read_b32 v20, a118
    v_accvgpr_read_b32 v21, a119
    v_mfma_f32_16x16x32_bf16 a[132:135], v[136:139], v[52:55], a[132:135]
    v_accvgpr_read_b32 v22, a124
    v_accvgpr_read_b32 v23, a125
    v_mfma_f32_16x16x32_bf16 a[136:139], v[152:155], v[48:51], a[136:139]
    v_accvgpr_read_b32 v24, a126
    v_accvgpr_read_b32 v25, a127
    v_mfma_f32_16x16x32_bf16 a[140:143], v[152:155], v[52:55], a[140:143]
    v_max3_f32 v26, v26, v10, v11
    v_max3_f32 v26, v26, v12, v13
    v_mfma_f32_16x16x32_bf16 a[128:131], v[140:143], v[56:59], a[128:131]
    v_max3_f32 v26, v26, v14, v15
    v_max3_f32 v26, v26, v16, v17
    v_mfma_f32_16x16x32_bf16 a[132:135], v[140:143], v[60:63], a[132:135]
    v_max3_f32 v27, v27, v18, v19
    v_max3_f32 v27, v27, v20, v21
    v_mfma_f32_16x16x32_bf16 a[136:139], v[156:159], v[56:59], a[136:139]
    v_max3_f32 v27, v27, v22, v23
    v_max3_f32 v27, v27, v24, v25
    s_xor_b32 s97, s99, 0x18800
    buffer_load_dwordx4 v[104:107], v0, s[56:59], s97 offen nt
    v_mfma_f32_16x16x32_bf16 a[140:143], v[156:159], v[60:63], a[140:143]
    s_waitcnt lgkmcnt(0)
    s_sub_u32 s6, 66560, s98
    v_add_u32 v30, s6, v2
    ds_read_b128 v[128:131], v30 offset:16640
    ds_read_b128 v[132:135], v30 offset:16656
    ds_read_b128 v[136:139], v30 offset:16672
    ds_read_b128 v[140:143], v30 offset:16688
    ds_read_b128 v[144:147], v30 offset:20800
    ds_read_b128 v[148:151], v30 offset:20816
    s_xor_b32 s97, s99, 0x18c00
    buffer_load_dwordx4 v[108:111], v0, s[56:59], s97 offen nt
    ds_read_b128 v[152:155], v30 offset:20832
    ds_read_b128 v[156:159], v30 offset:20848
    v_mfma_f32_16x16x32_bf16 a[144:147], v[160:163], v[32:35], 0
    v_mfma_f32_16x16x32_bf16 a[148:151], v[160:163], v[36:39], 0
    v_mfma_f32_16x16x32_bf16 a[152:155], v[176:179], v[32:35], 0
    v_mfma_f32_16x16x32_bf16 a[156:159], v[176:179], v[36:39], 0
    v_accvgpr_read_b32 v10, a128
    v_accvgpr_read_b32 v11, a129
    v_mfma_f32_16x16x32_bf16 a[144:147], v[164:167], v[40:43], a[144:147]
    v_accvgpr_read_b32 v12, a130
    v_accvgpr_read_b32 v13, a131
    v_mfma_f32_16x16x32_bf16 a[148:151], v[164:167], v[44:47], a[148:151]
    v_accvgpr_read_b32 v14, a136
    v_accvgpr_read_b32 v15, a137
    v_mfma_f32_16x16x32_bf16 a[152:155], v[180:183], v[40:43], a[152:155]
    v_accvgpr_read_b32 v16, a138
    v_accvgpr_read_b32 v17, a139
    v_mfma_f32_16x16x32_bf16 a[156:159], v[180:183], v[44:47], a[156:159]
    s_xor_b32 s97, s99, 0x19000
    buffer_load_dwordx4 v[112:115], v0, s[56:59], s97 offen nt
    v_accvgpr_read_b32 v18, a132
    v_accvgpr_read_b32 v19, a133
    v_mfma_f32_16x16x32_bf16 a[144:147], v[168:171], v[48:51], a[144:147]
    v_accvgpr_read_b32 v20, a134
    v_accvgpr_read_b32 v21, a135
    v_mfma_f32_16x16x32_bf16 a[148:151], v[168:171], v[52:55], a[148:151]
    v_accvgpr_read_b32 v22, a140
    v_accvgpr_read_b32 v23, a141
    v_mfma_f32_16x16x32_bf16 a[152:155], v[184:187], v[48:51], a[152:155]
    v_accvgpr_read_b32 v24, a142
    v_accvgpr_read_b32 v25, a143
    v_mfma_f32_16x16x32_bf16 a[156:159], v[184:187], v[52:55], a[156:159]
    v_max3_f32 v26, v26, v10, v11
    v_max3_f32 v26, v26, v12, v13
    v_mfma_f32_16x16x32_bf16 a[144:147], v[172:175], v[56:59], a[144:147]
    v_max3_f32 v26, v26, v14, v15
    v_max3_f32 v26, v26, v16, v17
    v_mfma_f32_16x16x32_bf16 a[148:151], v[172:175], v[60:63], a[148:151]
    v_max3_f32 v27, v27, v18, v19
    v_max3_f32 v27, v27, v20, v21
    v_mfma_f32_16x16x32_bf16 a[152:155], v[188:191], v[56:59], a[152:155]
    v_max3_f32 v27, v27, v22, v23
    v_max3_f32 v27, v27, v24, v25
    v_mfma_f32_16x16x32_bf16 a[156:159], v[188:191], v[60:63], a[156:159]
    s_waitcnt lgkmcnt(0)
    s_xor_b32 s97, s99, 0x19400
    buffer_load_dwordx4 v[116:119], v0, s[56:59], s97 offen nt
    s_sub_u32 s6, 66560, s98
    v_add_u32 v30, s6, v2
    ds_read_b128 v[160:163], v30 offset:24960
    ds_read_b128 v[164:167], v30 offset:24976
    ds_read_b128 v[168:171], v30 offset:24992
    ds_read_b128 v[172:175], v30 offset:25008
    ds_read_b128 v[176:179], v30 offset:29120
    ds_read_b128 v[180:183], v30 offset:29136
    ds_read_b128 v[184:187], v30 offset:29152
    ds_read_b128 v[188:191], v30 offset:29168
    v_mfma_f32_16x16x32_bf16 a[160:163], v[128:131], v[32:35], 0
    v_mfma_f32_16x16x32_bf16 a[164:167], v[128:131], v[36:39], 0
    v_mfma_f32_16x16x32_bf16 a[168:171], v[144:147], v[32:35], 0
    v_mfma_f32_16x16x32_bf16 a[172:175], v[144:147], v[36:39], 0
    s_xor_b32 s97, s99, 0x19800
    buffer_load_dwordx4 v[120:123], v0, s[56:59], s97 offen nt
    v_accvgpr_read_b32 v10, a144
    v_accvgpr_read_b32 v11, a145
    v_mfma_f32_16x16x32_bf16 a[160:163], v[132:135], v[40:43], a[160:163]
    v_accvgpr_read_b32 v12, a146
    v_accvgpr_read_b32 v13, a147
    v_mfma_f32_16x16x32_bf16 a[164:167], v[132:135], v[44:47], a[164:167]
    v_accvgpr_read_b32 v14, a152
    v_accvgpr_read_b32 v15, a153
    v_mfma_f32_16x16x32_bf16 a[168:171], v[148:151], v[40:43], a[168:171]
    v_accvgpr_read_b32 v16, a154
    v_accvgpr_read_b32 v17, a155
    v_mfma_f32_16x16x32_bf16 a[172:175], v[148:151], v[44:47], a[172:175]
    v_accvgpr_read_b32 v18, a148
    v_accvgpr_read_b32 v19, a149
    v_mfma_f32_16x16x32_bf16 a[160:163], v[136:139], v[48:51], a[160:163]
    v_accvgpr_read_b32 v20, a150
    v_accvgpr_read_b32 v21, a151
    v_mfma_f32_16x16x32_bf16 a[164:167], v[136:139], v[52:55], a[164:167]
    v_accvgpr_read_b32 v22, a156
    v_accvgpr_read_b32 v23, a157
    v_mfma_f32_16x16x32_bf16 a[168:171], v[152:155], v[48:51], a[168:171]
    v_accvgpr_read_b32 v24, a158
    v_accvgpr_read_b32 v25, a159
    v_mfma_f32_16x16x32_bf16 a[172:175], v[152:155], v[52:55], a[172:175]
    v_max3_f32 v26, v26, v10, v11
    v_max3_f32 v26, v26, v12, v13
    s_xor_b32 s97, s99, 0x19c00
    buffer_load_dwordx4 v[124:127], v0, s[56:59], s97 offen nt
    v_mfma_f32_16x16x32_bf16 a[160:163], v[140:143], v[56:59], a[160:163]
    v_max3_f32 v26, v26, v14, v15
    v_max3_f32 v26, v26, v16, v17
    v_mfma_f32_16x16x32_bf16 a[164:167], v[140:143], v[60:63], a[164:167]
    v_max3_f32 v27, v27, v18, v19
    v_max3_f32 v27, v27, v20, v21
    v_mfma_f32_16x16x32_bf16 a[168:171], v[156:159], v[56:59], a[168:171]
    v_max3_f32 v27, v27, v22, v23
    v_max3_f32 v27, v27, v24, v25
    v_mfma_f32_16x16x32_bf16 a[172:175], v[156:159], v[60:63], a[172:175]
    s_waitcnt lgkmcnt(0)
    s_sub_u32 s6, 99840, s98
    v_add_u32 v30, s6, v2
    ds_read_b128 v[128:131], v30
    ds_read_b128 v[132:135], v30 offset:16
    ds_read_b128 v[136:139], v30 offset:32
    ds_read_b128 v[140:143], v30 offset:48
    ds_read_b128 v[144:147], v30 offset:4160
    ds_read_b128 v[148:151], v30 offset:4176
    ds_read_b128 v[152:155], v30 offset:4192
    ds_read_b128 v[156:159], v30 offset:4208
    v_mfma_f32_16x16x32_bf16 a[176:179], v[160:163], v[32:35], 0
    v_mfma_f32_16x16x32_bf16 a[180:183], v[160:163], v[36:39], 0
    v_mfma_f32_16x16x32_bf16 a[184:187], v[176:179], v[32:35], 0
    v_mfma_f32_16x16x32_bf16 a[188:191], v[176:179], v[36:39], 0
    v_accvgpr_read_b32 v10, a160
    v_accvgpr_read_b32 v11, a161
    v_mfma_f32_16x16x32_bf16 a[176:179], v[164:167], v[40:43], a[176:179]
    v_accvgpr_read_b32 v12, a162
    v_accvgpr_read_b32 v13, a163
    v_mfma_f32_16x16x32_bf16 a[180:183], v[164:167], v[44:47], a[180:183]
    v_accvgpr_read_b32 v14, a168
    v_accvgpr_read_b32 v15, a169
    v_mfma_f32_16x16x32_bf16 a[184:187], v[180:183], v[40:43], a[184:187]
    v_accvgpr_read_b32 v16, a170
    v_accvgpr_read_b32 v17, a171
    v_mfma_f32_16x16x32_bf16 a[188:191], v[180:183], v[44:47], a[188:191]
    v_accvgpr_read_b32 v18, a164
    v_accvgpr_read_b32 v19, a165
    v_mfma_f32_16x16x32_bf16 a[176:179], v[168:171], v[48:51], a[176:179]
    v_accvgpr_read_b32 v20, a166
    v_accvgpr_read_b32 v21, a167
    v_mfma_f32_16x16x32_bf16 a[180:183], v[168:171], v[52:55], a[180:183]
    v_accvgpr_read_b32 v22, a172
    v_accvgpr_read_b32 v23, a173
    v_mfma_f32_16x16x32_bf16 a[184:187], v[184:187], v[48:51], a[184:187]
    v_accvgpr_read_b32 v24, a174
    v_accvgpr_read_b32 v25, a175
    v_mfma_f32_16x16x32_bf16 a[188:191], v[184:187], v[52:55], a[188:191]
    v_max3_f32 v26, v26, v10, v11
    v_max3_f32 v26, v26, v12, v13
    v_mfma_f32_16x16x32_bf16 a[176:179], v[172:175], v[56:59], a[176:179]
    v_max3_f32 v26, v26, v14, v15
    v_max3_f32 v26, v26, v16, v17
    v_mfma_f32_16x16x32_bf16 a[180:183], v[172:175], v[60:63], a[180:183]
    v_max3_f32 v27, v27, v18, v19
    v_max3_f32 v27, v27, v20, v21
    v_mfma_f32_16x16x32_bf16 a[184:187], v[188:191], v[56:59], a[184:187]
    v_max3_f32 v27, v27, v22, v23
    v_max3_f32 v27, v27, v24, v25
    v_mfma_f32_16x16x32_bf16 a[188:191], v[188:191], v[60:63], a[188:191]
    s_waitcnt lgkmcnt(0)
    s_sub_u32 s6, 99840, s98
    v_add_u32 v30, s6, v2
    ds_read_b128 v[160:163], v30 offset:8320
    ds_read_b128 v[164:167], v30 offset:8336
    ds_read_b128 v[168:171], v30 offset:8352
    ds_read_b128 v[172:175], v30 offset:8368
    ds_read_b128 v[176:179], v30 offset:12480
    ds_read_b128 v[180:183], v30 offset:12496
    ds_read_b128 v[184:187], v30 offset:12512
    ds_read_b128 v[188:191], v30 offset:12528
    v_mfma_f32_16x16x32_bf16 a[192:195], v[128:131], v[32:35], 0
    v_mfma_f32_16x16x32_bf16 a[196:199], v[128:131], v[36:39], 0
    v_mfma_f32_16x16x32_bf16 a[200:203], v[144:147], v[32:35], 0
    v_mfma_f32_16x16x32_bf16 a[204:207], v[144:147], v[36:39], 0
    v_accvgpr_read_b32 v10, a176
    v_accvgpr_read_b32 v11, a177
    v_mfma_f32_16x16x32_bf16 a[192:195], v[132:135], v[40:43], a[192:195]
    v_accvgpr_read_b32 v12, a178
    v_accvgpr_read_b32 v13, a179
    v_mfma_f32_16x16x32_bf16 a[196:199], v[132:135], v[44:47], a[196:199]
    v_accvgpr_read_b32 v14, a184
    v_accvgpr_read_b32 v15, a185
    v_mfma_f32_16x16x32_bf16 a[200:203], v[148:151], v[40:43], a[200:203]
    v_accvgpr_read_b32 v16, a186
    v_accvgpr_read_b32 v17, a187
    v_mfma_f32_16x16x32_bf16 a[204:207], v[148:151], v[44:47], a[204:207]
    v_accvgpr_read_b32 v18, a180
    v_accvgpr_read_b32 v19, a181
    v_mfma_f32_16x16x32_bf16 a[192:195], v[136:139], v[48:51], a[192:195]
    v_accvgpr_read_b32 v20, a182
    v_accvgpr_read_b32 v21, a183
    v_mfma_f32_16x16x32_bf16 a[196:199], v[136:139], v[52:55], a[196:199]
    v_accvgpr_read_b32 v22, a188
    v_accvgpr_read_b32 v23, a189
    v_mfma_f32_16x16x32_bf16 a[200:203], v[152:155], v[48:51], a[200:203]
    v_accvgpr_read_b32 v24, a190
    v_accvgpr_read_b32 v25, a191
    v_mfma_f32_16x16x32_bf16 a[204:207], v[152:155], v[52:55], a[204:207]
    v_max3_f32 v26, v26, v10, v11
    v_max3_f32 v26, v26, v12, v13
    v_mfma_f32_16x16x32_bf16 a[192:195], v[140:143], v[56:59], a[192:195]
    v_max3_f32 v26, v26, v14, v15
    v_max3_f32 v26, v26, v16, v17
    v_mfma_f32_16x16x32_bf16 a[196:199], v[140:143], v[60:63], a[196:199]
    v_max3_f32 v27, v27, v18, v19
    v_max3_f32 v27, v27, v20, v21
    v_mfma_f32_16x16x32_bf16 a[200:203], v[156:159], v[56:59], a[200:203]
    v_max3_f32 v27, v27, v22, v23
    v_max3_f32 v27, v27, v24, v25
    v_mfma_f32_16x16x32_bf16 a[204:207], v[156:159], v[60:63], a[204:207]
    s_waitcnt lgkmcnt(0)
    s_sub_u32 s6, 99840, s98
    v_add_u32 v30, s6, v2
    ds_read_b128 v[128:131], v30 offset:16640
    ds_read_b128 v[132:135], v30 offset:16656
    ds_read_b128 v[136:139], v30 offset:16672
    ds_read_b128 v[140:143], v30 offset:16688
    ds_read_b128 v[144:147], v30 offset:20800
    ds_read_b128 v[148:151], v30 offset:20816
    ds_read_b128 v[152:155], v30 offset:20832
    ds_read_b128 v[156:159], v30 offset:20848
    v_mfma_f32_16x16x32_bf16 a[208:211], v[160:163], v[32:35], 0
    v_mfma_f32_16x16x32_bf16 a[212:215], v[160:163], v[36:39], 0
    v_mfma_f32_16x16x32_bf16 a[216:219], v[176:179], v[32:35], 0
    v_mfma_f32_16x16x32_bf16 a[220:223], v[176:179], v[36:39], 0
    v_accvgpr_read_b32 v10, a192
    v_accvgpr_read_b32 v11, a193
    v_mfma_f32_16x16x32_bf16 a[208:211], v[164:167], v[40:43], a[208:211]
    v_accvgpr_read_b32 v12, a194
    v_accvgpr_read_b32 v13, a195
    v_mfma_f32_16x16x32_bf16 a[212:215], v[164:167], v[44:47], a[212:215]
    v_accvgpr_read_b32 v14, a200
    v_accvgpr_read_b32 v15, a201
    v_mfma_f32_16x16x32_bf16 a[216:219], v[180:183], v[40:43], a[216:219]
    v_accvgpr_read_b32 v16, a202
    v_accvgpr_read_b32 v17, a203
    v_mfma_f32_16x16x32_bf16 a[220:223], v[180:183], v[44:47], a[220:223]
    v_accvgpr_read_b32 v18, a196
    v_accvgpr_read_b32 v19, a197
    v_mfma_f32_16x16x32_bf16 a[208:211], v[168:171], v[48:51], a[208:211]
    v_accvgpr_read_b32 v20, a198
    v_accvgpr_read_b32 v21, a199
    v_mfma_f32_16x16x32_bf16 a[212:215], v[168:171], v[52:55], a[212:215]
    v_accvgpr_read_b32 v22, a204
    v_accvgpr_read_b32 v23, a205
    v_mfma_f32_16x16x32_bf16 a[216:219], v[184:187], v[48:51], a[216:219]
    v_accvgpr_read_b32 v24, a206
    v_accvgpr_read_b32 v25, a207
    v_mfma_f32_16x16x32_bf16 a[220:223], v[184:187], v[52:55], a[220:223]
    v_max3_f32 v26, v26, v10, v11
    v_max3_f32 v26, v26, v12, v13
    v_mfma_f32_16x16x32_bf16 a[208:211], v[172:175], v[56:59], a[208:211]
    v_max3_f32 v26, v26, v14, v15
    v_max3_f32 v26, v26, v16, v17
    v_mfma_f32_16x16x32_bf16 a[212:215], v[172:175], v[60:63], a[212:215]
    v_max3_f32 v27, v27, v18, v19
    v_max3_f32 v27, v27, v20, v21
    v_mfma_f32_16x16x32_bf16 a[216:219], v[188:191], v[56:59], a[216:219]
    v_max3_f32 v27, v27, v22, v23
    v_max3_f32 v27, v27, v24, v25
    v_mfma_f32_16x16x32_bf16 a[220:223], v[188:191], v[60:63], a[220:223]
    s_waitcnt lgkmcnt(0)
    s_sub_u32 s6, 99840, s98
    v_add_u32 v30, s6, v2
    ds_read_b128 v[160:163], v30 offset:24960
    ds_read_b128 v[164:167], v30 offset:24976
    ds_read_b128 v[168:171], v30 offset:24992
    ds_read_b128 v[172:175], v30 offset:25008
    ds_read_b128 v[176:179], v30 offset:29120
    ds_read_b128 v[180:183], v30 offset:29136
    ds_read_b128 v[184:187], v30 offset:29152
    ds_read_b128 v[188:191], v30 offset:29168
    v_mfma_f32_16x16x32_bf16 a[224:227], v[128:131], v[32:35], 0
    v_mfma_f32_16x16x32_bf16 a[228:231], v[128:131], v[36:39], 0
    v_mfma_f32_16x16x32_bf16 a[232:235], v[144:147], v[32:35], 0
    v_mfma_f32_16x16x32_bf16 a[236:239], v[144:147], v[36:39], 0
    v_accvgpr_read_b32 v10, a208
    v_accvgpr_read_b32 v11, a209
    v_mfma_f32_16x16x32_bf16 a[224:227], v[132:135], v[40:43], a[224:227]
    v_accvgpr_read_b32 v12, a210
    v_accvgpr_read_b32 v13, a211
    v_mfma_f32_16x16x32_bf16 a[228:231], v[132:135], v[44:47], a[228:231]
    v_accvgpr_read_b32 v14, a216
    v_accvgpr_read_b32 v15, a217
    v_mfma_f32_16x16x32_bf16 a[232:235], v[148:151], v[40:43], a[232:235]
    v_accvgpr_read_b32 v16, a218
    v_accvgpr_read_b32 v17, a219
    v_mfma_f32_16x16x32_bf16 a[236:239], v[148:151], v[44:47], a[236:239]
    v_accvgpr_read_b32 v18, a212
    v_accvgpr_read_b32 v19, a213
    v_mfma_f32_16x16x32_bf16 a[224:227], v[136:139], v[48:51], a[224:227]
    v_accvgpr_read_b32 v20, a214
    v_accvgpr_read_b32 v21, a215
    v_mfma_f32_16x16x32_bf16 a[228:231], v[136:139], v[52:55], a[228:231]
    v_accvgpr_read_b32 v22, a220
    v_accvgpr_read_b32 v23, a221
    v_mfma_f32_16x16x32_bf16 a[232:235], v[152:155], v[48:51], a[232:235]
    v_accvgpr_read_b32 v24, a222
    v_accvgpr_read_b32 v25, a223
    v_mfma_f32_16x16x32_bf16 a[236:239], v[152:155], v[52:55], a[236:239]
    v_max3_f32 v26, v26, v10, v11
    v_max3_f32 v26, v26, v12, v13
    v_mfma_f32_16x16x32_bf16 a[224:227], v[140:143], v[56:59], a[224:227]
    v_max3_f32 v26, v26, v14, v15
    v_max3_f32 v26, v26, v16, v17
    v_mfma_f32_16x16x32_bf16 a[228:231], v[140:143], v[60:63], a[228:231]
    v_max3_f32 v27, v27, v18, v19
    v_max3_f32 v27, v27, v20, v21
    v_mfma_f32_16x16x32_bf16 a[232:235], v[156:159], v[56:59], a[232:235]
    v_max3_f32 v27, v27, v22, v23
    v_max3_f32 v27, v27, v24, v25
    v_mfma_f32_16x16x32_bf16 a[236:239], v[156:159], v[60:63], a[236:239]
    s_waitcnt lgkmcnt(0)
    v_mfma_f32_16x16x32_bf16 a[240:243], v[160:163], v[32:35], 0
    v_mfma_f32_16x16x32_bf16 a[244:247], v[160:163], v[36:39], 0
    v_mfma_f32_16x16x32_bf16 a[248:251], v[176:179], v[32:35], 0
    v_mfma_f32_16x16x32_bf16 a[252:255], v[176:179], v[36:39], 0
    v_accvgpr_read_b32 v10, a224
    v_accvgpr_read_b32 v11, a225
    v_mfma_f32_16x16x32_bf16 a[240:243], v[164:167], v[40:43], a[240:243]
    v_accvgpr_read_b32 v12, a226
    v_accvgpr_read_b32 v13, a227
    v_mfma_f32_16x16x32_bf16 a[244:247], v[164:167], v[44:47], a[244:247]
    v_accvgpr_read_b32 v14, a232
    v_accvgpr_read_b32 v15, a233
    v_mfma_f32_16x16x32_bf16 a[248:251], v[180:183], v[40:43], a[248:251]
    v_accvgpr_read_b32 v16, a234
    v_accvgpr_read_b32 v17, a235
    v_mfma_f32_16x16x32_bf16 a[252:255], v[180:183], v[44:47], a[252:255]
    v_accvgpr_read_b32 v18, a228
    v_accvgpr_read_b32 v19, a229
    v_mfma_f32_16x16x32_bf16 a[240:243], v[168:171], v[48:51], a[240:243]
    v_accvgpr_read_b32 v20, a230
    v_accvgpr_read_b32 v21, a231
    v_mfma_f32_16x16x32_bf16 a[244:247], v[168:171], v[52:55], a[244:247]
    v_accvgpr_read_b32 v22, a236
    v_accvgpr_read_b32 v23, a237
    v_mfma_f32_16x16x32_bf16 a[248:251], v[184:187], v[48:51], a[248:251]
    v_accvgpr_read_b32 v24, a238
    v_accvgpr_read_b32 v25, a239
    v_mfma_f32_16x16x32_bf16 a[252:255], v[184:187], v[52:55], a[252:255]
    v_max3_f32 v26, v26, v10, v11
    v_max3_f32 v26, v26, v12, v13
    v_mfma_f32_16x16x32_bf16 a[240:243], v[172:175], v[56:59], a[240:243]
    v_max3_f32 v26, v26, v14, v15
    v_max3_f32 v26, v26, v16, v17
    v_mfma_f32_16x16x32_bf16 a[244:247], v[172:175], v[60:63], a[244:247]
    v_max3_f32 v27, v27, v18, v19
    v_max3_f32 v27, v27, v20, v21
    v_mfma_f32_16x16x32_bf16 a[248:251], v[188:191], v[56:59], a[248:251]
    v_max3_f32 v27, v27, v22, v23
    v_max3_f32 v27, v27, v24, v25
    v_mfma_f32_16x16x32_bf16 a[252:255], v[188:191], v[60:63], a[252:255]
    s_waitcnt lgkmcnt(0)
    s_barrier
    s_lshl_b32 s6, s4, 2
    s_add_u32 s6, s6, s3
    s_lshl_b32 s6, s6, 17
    s_lshl_b32 s7, s37, 8
    s_add_u32 s6, s6, s7
    s_sub_u32 s7, 0x400000, s6
    s_add_u32 s40, s16, s6
    s_addc_u32 s41, s17, 0
    s_and_b32 s41, s41, 0xffff
    s_mov_b32 s42, s7
    s_mov_b32 s43, 0x20000
    s_waitcnt vmcnt(24)
    v_perm_b32 v128, v196, v192, s38
    v_perm_b32 v129, v204, v200, s38
    v_perm_b32 v130, v212, v208, s38
    v_perm_b32 v131, v220, v216, s38
    ds_write_b128 v5, v[128:131]
    v_perm_b32 v132, v196, v192, s39
    v_perm_b32 v133, v204, v200, s39
    v_perm_b32 v134, v212, v208, s39
    v_perm_b32 v135, v220, v216, s39
    ds_write_b128 v5, v[132:135] offset:1024
    v_perm_b32 v136, v197, v193, s38
    v_perm_b32 v137, v205, v201, s38
    v_perm_b32 v138, v213, v209, s38
    v_perm_b32 v139, v221, v217, s38
    ds_write_b128 v5, v[136:139] offset:2048
    v_perm_b32 v140, v197, v193, s39
    v_perm_b32 v141, v205, v201, s39
    v_perm_b32 v142, v213, v209, s39
    v_perm_b32 v143, v221, v217, s39
    ds_write_b128 v5, v[140:143] offset:3072
    v_perm_b32 v144, v198, v194, s38
    v_perm_b32 v145, v206, v202, s38
    v_perm_b32 v146, v214, v210, s38
    v_perm_b32 v147, v222, v218, s38
    ds_write_b128 v5, v[144:147] offset:4096
    v_perm_b32 v148, v198, v194, s39
    v_perm_b32 v149, v206, v202, s39
    v_perm_b32 v150, v214, v210, s39
    v_perm_b32 v151, v222, v218, s39
    ds_write_b128 v5, v[148:151] offset:5120
    v_perm_b32 v152, v199, v195, s38
    v_perm_b32 v153, v207, v203, s38
    v_perm_b32 v154, v215, v211, s38
    v_perm_b32 v155, v223, v219, s38
    ds_write_b128 v5, v[152:155] offset:6144
    v_perm_b32 v156, v199, v195, s39
    v_perm_b32 v157, v207, v203, s39
    v_perm_b32 v158, v215, v211, s39
    v_perm_b32 v159, v223, v219, s39
    ds_write_b128 v5, v[156:159] offset:7168
    s_mov_b32 s97, 0x0
    buffer_load_dwordx4 v[192:195], v4, s[40:43], s97 offen
    s_mov_b32 s97, 0x400
    buffer_load_dwordx4 v[196:199], v4, s[40:43], s97 offen
    s_mov_b32 s97, 0x800
    buffer_load_dwordx4 v[200:203], v4, s[40:43], s97 offen
    s_mov_b32 s97, 0xc00
    buffer_load_dwordx4 v[204:207], v4, s[40:43], s97 offen
    s_mov_b32 s97, 0x1000
    buffer_load_dwordx4 v[208:211], v4, s[40:43], s97 offen
    s_mov_b32 s97, 0x1400
    buffer_load_dwordx4 v[212:215], v4, s[40:43], s97 offen
    s_mov_b32 s97, 0x1800
    buffer_load_dwordx4 v[216:219], v4, s[40:43], s97 offen
    s_mov_b32 s97, 0x1c00
    buffer_load_dwordx4 v[220:223], v4, s[40:43], s97 offen
    s_waitcnt vmcnt(24)
    v_perm_b32 v160, v228, v224, s38
    v_perm_b32 v161, v236, v232, s38
    v_perm_b32 v162, v244, v240, s38
    v_perm_b32 v163, v252, v248, s38
    ds_write_b128 v5, v[160:163] offset:8192
    v_perm_b32 v164, v228, v224, s39
    v_perm_b32 v165, v236, v232, s39
    v_perm_b32 v166, v244, v240, s39
    v_perm_b32 v167, v252, v248, s39
    ds_write_b128 v5, v[164:167] offset:9216
    v_perm_b32 v168, v229, v225, s38
    v_perm_b32 v169, v237, v233, s38
    v_perm_b32 v170, v245, v241, s38
    v_perm_b32 v171, v253, v249, s38
    ds_write_b128 v5, v[168:171] offset:10240
    v_perm_b32 v172, v229, v225, s39
    v_perm_b32 v173, v237, v233, s39
    v_perm_b32 v174, v245, v241, s39
    v_perm_b32 v175, v253, v249, s39
    ds_write_b128 v5, v[172:175] offset:11264
    v_perm_b32 v176, v230, v226, s38
    v_perm_b32 v177, v238, v234, s38
    v_perm_b32 v178, v246, v242, s38
    v_perm_b32 v179, v254, v250, s38
    ds_write_b128 v5, v[176:179] offset:12288
    v_perm_b32 v180, v230, v226, s39
    v_perm_b32 v181, v238, v234, s39
    v_perm_b32 v182, v246, v242, s39
    v_perm_b32 v183, v254, v250, s39
    ds_write_b128 v5, v[180:183] offset:13312
    v_perm_b32 v184, v231, v227, s38
    v_perm_b32 v185, v239, v235, s38
    v_perm_b32 v186, v247, v243, s38
    v_perm_b32 v187, v255, v251, s38
    ds_write_b128 v5, v[184:187] offset:14336
    v_perm_b32 v188, v231, v227, s39
    v_perm_b32 v189, v239, v235, s39
    v_perm_b32 v190, v247, v243, s39
    v_perm_b32 v191, v255, v251, s39
    ds_write_b128 v5, v[188:191] offset:15360
    s_mov_b32 s97, 0x2000
    buffer_load_dwordx4 v[224:227], v4, s[40:43], s97 offen
    s_mov_b32 s97, 0x2400
    buffer_load_dwordx4 v[228:231], v4, s[40:43], s97 offen
    s_mov_b32 s97, 0x2800
    buffer_load_dwordx4 v[232:235], v4, s[40:43], s97 offen
    s_mov_b32 s97, 0x2c00
    buffer_load_dwordx4 v[236:239], v4, s[40:43], s97 offen
    s_mov_b32 s97, 0x3000
    buffer_load_dwordx4 v[240:243], v4, s[40:43], s97 offen
    s_mov_b32 s97, 0x3400
    buffer_load_dwordx4 v[244:247], v4, s[40:43], s97 offen
    s_mov_b32 s97, 0x3800
    buffer_load_dwordx4 v[248:251], v4, s[40:43], s97 offen
    s_mov_b32 s97, 0x3c00
    buffer_load_dwordx4 v[252:255], v4, s[40:43], s97 offen
    s_waitcnt vmcnt(24)
    s_waitcnt lgkmcnt(8)
    v_perm_b32 v128, v68, v64, s38
    v_perm_b32 v129, v76, v72, s38
    v_perm_b32 v130, v84, v80, s38
    v_perm_b32 v131, v92, v88, s38
    ds_write_b128 v5, v[128:131] offset:16384
    v_perm_b32 v132, v68, v64, s39
    v_perm_b32 v133, v76, v72, s39
    v_perm_b32 v134, v84, v80, s39
    v_perm_b32 v135, v92, v88, s39
    ds_write_b128 v5, v[132:135] offset:17408
    v_perm_b32 v136, v69, v65, s38
    v_perm_b32 v137, v77, v73, s38
    v_perm_b32 v138, v85, v81, s38
    v_perm_b32 v139, v93, v89, s38
    ds_write_b128 v5, v[136:139] offset:18432
    v_perm_b32 v140, v69, v65, s39
    v_perm_b32 v141, v77, v73, s39
    v_perm_b32 v142, v85, v81, s39
    v_perm_b32 v143, v93, v89, s39
    ds_write_b128 v5, v[140:143] offset:19456
    v_perm_b32 v144, v70, v66, s38
    v_perm_b32 v145, v78, v74, s38
    v_perm_b32 v146, v86, v82, s38
    v_perm_b32 v147, v94, v90, s38
    ds_write_b128 v5, v[144:147] offset:20480
    v_perm_b32 v148, v70, v66, s39
    v_perm_b32 v149, v78, v74, s39
    v_perm_b32 v150, v86, v82, s39
    v_perm_b32 v151, v94, v90, s39
    ds_write_b128 v5, v[148:151] offset:21504
    v_perm_b32 v152, v71, v67, s38
    v_perm_b32 v153, v79, v75, s38
    v_perm_b32 v154, v87, v83, s38
    v_perm_b32 v155, v95, v91, s38
    ds_write_b128 v5, v[152:155] offset:22528
    v_perm_b32 v156, v71, v67, s39
    v_perm_b32 v157, v79, v75, s39
    v_perm_b32 v158, v87, v83, s39
    v_perm_b32 v159, v95, v91, s39
    ds_write_b128 v5, v[156:159] offset:23552
    s_mov_b32 s97, 0x4000
    buffer_load_dwordx4 v[64:67], v4, s[40:43], s97 offen
    s_mov_b32 s97, 0x4400
    buffer_load_dwordx4 v[68:71], v4, s[40:43], s97 offen
    s_mov_b32 s97, 0x4800
    buffer_load_dwordx4 v[72:75], v4, s[40:43], s97 offen
    s_mov_b32 s97, 0x4c00
    buffer_load_dwordx4 v[76:79], v4, s[40:43], s97 offen
    s_mov_b32 s97, 0x5000
    buffer_load_dwordx4 v[80:83], v4, s[40:43], s97 offen
    s_mov_b32 s97, 0x5400
    buffer_load_dwordx4 v[84:87], v4, s[40:43], s97 offen
    s_mov_b32 s97, 0x5800
    buffer_load_dwordx4 v[88:91], v4, s[40:43], s97 offen
    s_mov_b32 s97, 0x5c00
    buffer_load_dwordx4 v[92:95], v4, s[40:43], s97 offen
    s_waitcnt vmcnt(24)
    s_waitcnt lgkmcnt(8)
    v_perm_b32 v160, v100, v96, s38
    v_perm_b32 v161, v108, v104, s38
    v_perm_b32 v162, v116, v112, s38
    v_perm_b32 v163, v124, v120, s38
    ds_write_b128 v5, v[160:163] offset:24576
    v_perm_b32 v164, v100, v96, s39
    v_perm_b32 v165, v108, v104, s39
    v_perm_b32 v166, v116, v112, s39
    v_perm_b32 v167, v124, v120, s39
    ds_write_b128 v5, v[164:167] offset:25600
    v_perm_b32 v168, v101, v97, s38
    v_perm_b32 v169, v109, v105, s38
    v_perm_b32 v170, v117, v113, s38
    v_perm_b32 v171, v125, v121, s38
    ds_write_b128 v5, v[168:171] offset:26624
    v_perm_b32 v172, v101, v97, s39
    v_perm_b32 v173, v109, v105, s39
    v_perm_b32 v174, v117, v113, s39
    v_perm_b32 v175, v125, v121, s39
    ds_write_b128 v5, v[172:175] offset:27648
    v_perm_b32 v176, v102, v98, s38
    v_perm_b32 v177, v110, v106, s38
    v_perm_b32 v178, v118, v114, s38
    v_perm_b32 v179, v126, v122, s38
    ds_write_b128 v5, v[176:179] offset:28672
    v_perm_b32 v180, v102, v98, s39
    v_perm_b32 v181, v110, v106, s39
    v_perm_b32 v182, v118, v114, s39
    v_perm_b32 v183, v126, v122, s39
    ds_write_b128 v5, v[180:183] offset:29696
    v_perm_b32 v184, v103, v99, s38
    v_perm_b32 v185, v111, v107, s38
    v_perm_b32 v186, v119, v115, s38
    v_perm_b32 v187, v127, v123, s38
    ds_write_b128 v5, v[184:187] offset:30720
    v_perm_b32 v188, v103, v99, s39
    v_perm_b32 v189, v111, v107, s39
    v_perm_b32 v190, v119, v115, s39
    v_perm_b32 v191, v127, v123, s39
    ds_write_b128 v5, v[188:191] offset:31744
    s_mov_b32 s97, 0x6000
    buffer_load_dwordx4 v[96:99], v4, s[40:43], s97 offen
    s_mov_b32 s97, 0x6400
    buffer_load_dwordx4 v[100:103], v4, s[40:43], s97 offen
    s_mov_b32 s97, 0x6800
    buffer_load_dwordx4 v[104:107], v4, s[40:43], s97 offen
    s_mov_b32 s97, 0x6c00
    buffer_load_dwordx4 v[108:111], v4, s[40:43], s97 offen
    s_mov_b32 s97, 0x7000
    buffer_load_dwordx4 v[112:115], v4, s[40:43], s97 offen
    s_mov_b32 s97, 0x7400
    buffer_load_dwordx4 v[116:119], v4, s[40:43], s97 offen
    s_mov_b32 s97, 0x7800
    buffer_load_dwordx4 v[120:123], v4, s[40:43], s97 offen
    s_mov_b32 s97, 0x7c00
    buffer_load_dwordx4 v[124:127], v4, s[40:43], s97 offen
    v_accvgpr_read_b32 v10, a240
    v_accvgpr_read_b32 v11, a241
    v_accvgpr_read_b32 v12, a242
    v_accvgpr_read_b32 v13, a243
    v_accvgpr_read_b32 v14, a248
    v_accvgpr_read_b32 v15, a249
    v_accvgpr_read_b32 v16, a250
    v_accvgpr_read_b32 v17, a251
    v_accvgpr_read_b32 v18, a244
    v_accvgpr_read_b32 v19, a245
    v_accvgpr_read_b32 v20, a246
    v_accvgpr_read_b32 v21, a247
    v_accvgpr_read_b32 v22, a252
    v_accvgpr_read_b32 v23, a253
    v_accvgpr_read_b32 v24, a254
    v_accvgpr_read_b32 v25, a255
    v_max3_f32 v26, v26, v10, v11
    v_max3_f32 v26, v26, v12, v13
    v_max3_f32 v26, v26, v14, v15
    v_max3_f32 v26, v26, v16, v17
    v_max3_f32 v27, v27, v18, v19
    v_max3_f32 v27, v27, v20, v21
    v_max3_f32 v27, v27, v22, v23
    v_max3_f32 v27, v27, v24, v25
    v_mov_b32 v10, v26
    s_nop 1
    v_permlane32_swap_b32 v26, v10
    v_max_f32 v26, v26, v10
    v_mov_b32 v10, v26
    s_nop 1
    v_permlane16_swap_b32 v26, v10
    v_max_f32 v26, v26, v10
    v_mul_f32 v26, s96, v26
    v_mov_b32 v28, 0
    v_mov_b32 v10, v27
    s_nop 1
    v_permlane32_swap_b32 v27, v10
    v_max_f32 v27, v27, v10
    v_mov_b32 v10, v27
    s_nop 1
    v_permlane16_swap_b32 v27, v10
    v_max_f32 v27, v27, v10
    v_mul_f32 v27, s96, v27
    v_mov_b32 v29, 0
    v_accvgpr_read_b32 v10, a0
    v_accvgpr_read_b32 v11, a1
    v_accvgpr_read_b32 v12, a2
    v_accvgpr_read_b32 v13, a3
    v_accvgpr_read_b32 v14, a8
    v_accvgpr_read_b32 v15, a9
    v_accvgpr_read_b32 v16, a10
    v_accvgpr_read_b32 v17, a11
    v_accvgpr_read_b32 v18, a4
    v_accvgpr_read_b32 v19, a5
    v_accvgpr_read_b32 v20, a6
    v_accvgpr_read_b32 v21, a7
    v_accvgpr_read_b32 v22, a12
    v_accvgpr_read_b32 v23, a13
    v_accvgpr_read_b32 v24, a14
    v_accvgpr_read_b32 v25, a15
    v_fma_f32 v10, v10, s96, -v26
    v_fma_f32 v11, v11, s96, -v26
    v_fma_f32 v12, v12, s96, -v26
    v_fma_f32 v13, v13, s96, -v26
    v_fma_f32 v14, v14, s96, -v26
    v_fma_f32 v15, v15, s96, -v26
    v_fma_f32 v16, v16, s96, -v26
    v_fma_f32 v17, v17, s96, -v26
    v_fma_f32 v18, v18, s96, -v27
    v_fma_f32 v19, v19, s96, -v27
    v_fma_f32 v20, v20, s96, -v27
    v_fma_f32 v21, v21, s96, -v27
    v_fma_f32 v22, v22, s96, -v27
    v_fma_f32 v23, v23, s96, -v27
    v_fma_f32 v24, v24, s96, -v27
    v_fma_f32 v25, v25, s96, -v27
    v_exp_f32 v10, v10
    v_exp_f32 v11, v11
    v_exp_f32 v12, v12
    v_exp_f32 v13, v13
    v_exp_f32 v14, v14
    v_exp_f32 v15, v15
    v_exp_f32 v16, v16
    v_exp_f32 v17, v17
    v_exp_f32 v18, v18
    v_exp_f32 v19, v19
    v_exp_f32 v20, v20
    v_exp_f32 v21, v21
    v_exp_f32 v22, v22
    v_exp_f32 v23, v23
    v_exp_f32 v24, v24
    v_exp_f32 v25, v25
    v_add_f32 v28, v28, v10
    v_add_f32 v28, v28, v11
    v_add_f32 v28, v28, v12
    v_add_f32 v28, v28, v13
    v_add_f32 v28, v28, v14
    v_add_f32 v28, v28, v15
    v_add_f32 v28, v28, v16
    v_add_f32 v28, v28, v17
    v_add_f32 v29, v29, v18
    v_add_f32 v29, v29, v19
    v_add_f32 v29, v29, v20
    v_add_f32 v29, v29, v21
    v_add_f32 v29, v29, v22
    v_add_f32 v29, v29, v23
    v_add_f32 v29, v29, v24
    v_add_f32 v29, v29, v25
    v_cvt_pk_bf16_f32 v10, v10, v11
    v_cvt_pk_bf16_f32 v12, v12, v13
    v_cvt_pk_bf16_f32 v14, v14, v15
    v_cvt_pk_bf16_f32 v16, v16, v17
    v_cvt_pk_bf16_f32 v18, v18, v19
    v_cvt_pk_bf16_f32 v20, v20, v21
    v_cvt_pk_bf16_f32 v22, v22, v23
    v_cvt_pk_bf16_f32 v24, v24, v25
    v_accvgpr_write_b32 a0, v10
    v_accvgpr_write_b32 a1, v12
    v_accvgpr_write_b32 a2, v14
    v_accvgpr_write_b32 a3, v16
    v_accvgpr_write_b32 a4, v18
    v_accvgpr_write_b32 a5, v20
    v_accvgpr_write_b32 a6, v22
    v_accvgpr_write_b32 a7, v24
    v_accvgpr_read_b32 v10, a16
    v_accvgpr_read_b32 v11, a17
    v_accvgpr_read_b32 v12, a18
    v_accvgpr_read_b32 v13, a19
    v_accvgpr_read_b32 v14, a24
    v_accvgpr_read_b32 v15, a25
    v_accvgpr_read_b32 v16, a26
    v_accvgpr_read_b32 v17, a27
    v_accvgpr_read_b32 v18, a20
    v_accvgpr_read_b32 v19, a21
    v_accvgpr_read_b32 v20, a22
    v_accvgpr_read_b32 v21, a23
    v_accvgpr_read_b32 v22, a28
    v_accvgpr_read_b32 v23, a29
    v_accvgpr_read_b32 v24, a30
    v_accvgpr_read_b32 v25, a31
    v_fma_f32 v10, v10, s96, -v26
    v_fma_f32 v11, v11, s96, -v26
    v_fma_f32 v12, v12, s96, -v26
    v_fma_f32 v13, v13, s96, -v26
    v_fma_f32 v14, v14, s96, -v26
    v_fma_f32 v15, v15, s96, -v26
    v_fma_f32 v16, v16, s96, -v26
    v_fma_f32 v17, v17, s96, -v26
    v_fma_f32 v18, v18, s96, -v27
    v_fma_f32 v19, v19, s96, -v27
    v_fma_f32 v20, v20, s96, -v27
    v_fma_f32 v21, v21, s96, -v27
    v_fma_f32 v22, v22, s96, -v27
    v_fma_f32 v23, v23, s96, -v27
    v_fma_f32 v24, v24, s96, -v27
    v_fma_f32 v25, v25, s96, -v27
    v_exp_f32 v10, v10
    v_exp_f32 v11, v11
    v_exp_f32 v12, v12
    v_exp_f32 v13, v13
    v_exp_f32 v14, v14
    v_exp_f32 v15, v15
    v_exp_f32 v16, v16
    v_exp_f32 v17, v17
    v_exp_f32 v18, v18
    v_exp_f32 v19, v19
    v_exp_f32 v20, v20
    v_exp_f32 v21, v21
    v_exp_f32 v22, v22
    v_exp_f32 v23, v23
    v_exp_f32 v24, v24
    v_exp_f32 v25, v25
    v_add_f32 v28, v28, v10
    v_add_f32 v28, v28, v11
    v_add_f32 v28, v28, v12
    v_add_f32 v28, v28, v13
    v_add_f32 v28, v28, v14
    v_add_f32 v28, v28, v15
    v_add_f32 v28, v28, v16
    v_add_f32 v28, v28, v17
    v_add_f32 v29, v29, v18
    v_add_f32 v29, v29, v19
    v_add_f32 v29, v29, v20
    v_add_f32 v29, v29, v21
    v_add_f32 v29, v29, v22
    v_add_f32 v29, v29, v23
    v_add_f32 v29, v29, v24
    v_add_f32 v29, v29, v25
    v_cvt_pk_bf16_f32 v10, v10, v11
    v_cvt_pk_bf16_f32 v12, v12, v13
    v_cvt_pk_bf16_f32 v14, v14, v15
    v_cvt_pk_bf16_f32 v16, v16, v17
    v_cvt_pk_bf16_f32 v18, v18, v19
    v_cvt_pk_bf16_f32 v20, v20, v21
    v_cvt_pk_bf16_f32 v22, v22, v23
    v_cvt_pk_bf16_f32 v24, v24, v25
    v_accvgpr_write_b32 a16, v10
    v_accvgpr_write_b32 a17, v12
    v_accvgpr_write_b32 a18, v14
    v_accvgpr_write_b32 a19, v16
    v_accvgpr_write_b32 a20, v18
    v_accvgpr_write_b32 a21, v20
    v_accvgpr_write_b32 a22, v22
    v_accvgpr_write_b32 a23, v24
    v_accvgpr_read_b32 v10, a32
    v_accvgpr_read_b32 v11, a33
    v_accvgpr_read_b32 v12, a34
    v_accvgpr_read_b32 v13, a35
    v_accvgpr_read_b32 v14, a40
    v_accvgpr_read_b32 v15, a41
    v_accvgpr_read_b32 v16, a42
    v_accvgpr_read_b32 v17, a43
    v_accvgpr_read_b32 v18, a36
    v_accvgpr_read_b32 v19, a37
    v_accvgpr_read_b32 v20, a38
    v_accvgpr_read_b32 v21, a39
    v_accvgpr_read_b32 v22, a44
    v_accvgpr_read_b32 v23, a45
    v_accvgpr_read_b32 v24, a46
    v_accvgpr_read_b32 v25, a47
    v_fma_f32 v10, v10, s96, -v26
    v_fma_f32 v11, v11, s96, -v26
    v_fma_f32 v12, v12, s96, -v26
    v_fma_f32 v13, v13, s96, -v26
    v_fma_f32 v14, v14, s96, -v26
    v_fma_f32 v15, v15, s96, -v26
    v_fma_f32 v16, v16, s96, -v26
    v_fma_f32 v17, v17, s96, -v26
    v_fma_f32 v18, v18, s96, -v27
    v_fma_f32 v19, v19, s96, -v27
    v_fma_f32 v20, v20, s96, -v27
    v_fma_f32 v21, v21, s96, -v27
    v_fma_f32 v22, v22, s96, -v27
    v_fma_f32 v23, v23, s96, -v27
    v_fma_f32 v24, v24, s96, -v27
    v_fma_f32 v25, v25, s96, -v27
    v_exp_f32 v10, v10
    v_exp_f32 v11, v11
    v_exp_f32 v12, v12
    v_exp_f32 v13, v13
    v_exp_f32 v14, v14
    v_exp_f32 v15, v15
    v_exp_f32 v16, v16
    v_exp_f32 v17, v17
    v_exp_f32 v18, v18
    v_exp_f32 v19, v19
    v_exp_f32 v20, v20
    v_exp_f32 v21, v21
    v_exp_f32 v22, v22
    v_exp_f32 v23, v23
    v_exp_f32 v24, v24
    v_exp_f32 v25, v25
    v_add_f32 v28, v28, v10
    v_add_f32 v28, v28, v11
    v_add_f32 v28, v28, v12
    v_add_f32 v28, v28, v13
    v_add_f32 v28, v28, v14
    v_add_f32 v28, v28, v15
    v_add_f32 v28, v28, v16
    v_add_f32 v28, v28, v17
    v_add_f32 v29, v29, v18
    v_add_f32 v29, v29, v19
    v_add_f32 v29, v29, v20
    v_add_f32 v29, v29, v21
    v_add_f32 v29, v29, v22
    v_add_f32 v29, v29, v23
    v_add_f32 v29, v29, v24
    v_add_f32 v29, v29, v25
    v_cvt_pk_bf16_f32 v10, v10, v11
    v_cvt_pk_bf16_f32 v12, v12, v13
    v_cvt_pk_bf16_f32 v14, v14, v15
    v_cvt_pk_bf16_f32 v16, v16, v17
    v_cvt_pk_bf16_f32 v18, v18, v19
    v_cvt_pk_bf16_f32 v20, v20, v21
    v_cvt_pk_bf16_f32 v22, v22, v23
    v_cvt_pk_bf16_f32 v24, v24, v25
    v_accvgpr_write_b32 a32, v10
    v_accvgpr_write_b32 a33, v12
    v_accvgpr_write_b32 a34, v14
    v_accvgpr_write_b32 a35, v16
    v_accvgpr_write_b32 a36, v18
    v_accvgpr_write_b32 a37, v20
    v_accvgpr_write_b32 a38, v22
    v_accvgpr_write_b32 a39, v24
    v_accvgpr_read_b32 v10, a48
    v_accvgpr_read_b32 v11, a49
    v_accvgpr_read_b32 v12, a50
    v_accvgpr_read_b32 v13, a51
    v_accvgpr_read_b32 v14, a56
    v_accvgpr_read_b32 v15, a57
    v_accvgpr_read_b32 v16, a58
    v_accvgpr_read_b32 v17, a59
    v_accvgpr_read_b32 v18, a52
    v_accvgpr_read_b32 v19, a53
    v_accvgpr_read_b32 v20, a54
    v_accvgpr_read_b32 v21, a55
    v_accvgpr_read_b32 v22, a60
    v_accvgpr_read_b32 v23, a61
    v_accvgpr_read_b32 v24, a62
    v_accvgpr_read_b32 v25, a63
    v_fma_f32 v10, v10, s96, -v26
    v_fma_f32 v11, v11, s96, -v26
    v_fma_f32 v12, v12, s96, -v26
    v_fma_f32 v13, v13, s96, -v26
    v_fma_f32 v14, v14, s96, -v26
    v_fma_f32 v15, v15, s96, -v26
    v_fma_f32 v16, v16, s96, -v26
    v_fma_f32 v17, v17, s96, -v26
    v_fma_f32 v18, v18, s96, -v27
    v_fma_f32 v19, v19, s96, -v27
    v_fma_f32 v20, v20, s96, -v27
    v_fma_f32 v21, v21, s96, -v27
    v_fma_f32 v22, v22, s96, -v27
    v_fma_f32 v23, v23, s96, -v27
    v_fma_f32 v24, v24, s96, -v27
    v_fma_f32 v25, v25, s96, -v27
    v_exp_f32 v10, v10
    v_exp_f32 v11, v11
    v_exp_f32 v12, v12
    v_exp_f32 v13, v13
    v_exp_f32 v14, v14
    v_exp_f32 v15, v15
    v_exp_f32 v16, v16
    v_exp_f32 v17, v17
    v_exp_f32 v18, v18
    v_exp_f32 v19, v19
    v_exp_f32 v20, v20
    v_exp_f32 v21, v21
    v_exp_f32 v22, v22
    v_exp_f32 v23, v23
    v_exp_f32 v24, v24
    v_exp_f32 v25, v25
    v_add_f32 v28, v28, v10
    v_add_f32 v28, v28, v11
    v_add_f32 v28, v28, v12
    v_add_f32 v28, v28, v13
    v_add_f32 v28, v28, v14
    v_add_f32 v28, v28, v15
    v_add_f32 v28, v28, v16
    v_add_f32 v28, v28, v17
    v_add_f32 v29, v29, v18
    v_add_f32 v29, v29, v19
    v_add_f32 v29, v29, v20
    v_add_f32 v29, v29, v21
    v_add_f32 v29, v29, v22
    v_add_f32 v29, v29, v23
    v_add_f32 v29, v29, v24
    v_add_f32 v29, v29, v25
    v_cvt_pk_bf16_f32 v10, v10, v11
    v_cvt_pk_bf16_f32 v12, v12, v13
    v_cvt_pk_bf16_f32 v14, v14, v15
    v_cvt_pk_bf16_f32 v16, v16, v17
    v_cvt_pk_bf16_f32 v18, v18, v19
    v_cvt_pk_bf16_f32 v20, v20, v21
    v_cvt_pk_bf16_f32 v22, v22, v23
    v_cvt_pk_bf16_f32 v24, v24, v25
    v_accvgpr_write_b32 a48, v10
    v_accvgpr_write_b32 a49, v12
    v_accvgpr_write_b32 a50, v14
    v_accvgpr_write_b32 a51, v16
    v_accvgpr_write_b32 a52, v18
    v_accvgpr_write_b32 a53, v20
    v_accvgpr_write_b32 a54, v22
    v_accvgpr_write_b32 a55, v24
    v_accvgpr_read_b32 v10, a64
    v_accvgpr_read_b32 v11, a65
    v_accvgpr_read_b32 v12, a66
    v_accvgpr_read_b32 v13, a67
    v_accvgpr_read_b32 v14, a72
    v_accvgpr_read_b32 v15, a73
    v_accvgpr_read_b32 v16, a74
    v_accvgpr_read_b32 v17, a75
    v_accvgpr_read_b32 v18, a68
    v_accvgpr_read_b32 v19, a69
    v_accvgpr_read_b32 v20, a70
    v_accvgpr_read_b32 v21, a71
    v_accvgpr_read_b32 v22, a76
    v_accvgpr_read_b32 v23, a77
    v_accvgpr_read_b32 v24, a78
    v_accvgpr_read_b32 v25, a79
    v_fma_f32 v10, v10, s96, -v26
    v_fma_f32 v11, v11, s96, -v26
    v_fma_f32 v12, v12, s96, -v26
    v_fma_f32 v13, v13, s96, -v26
    v_fma_f32 v14, v14, s96, -v26
    v_fma_f32 v15, v15, s96, -v26
    v_fma_f32 v16, v16, s96, -v26
    v_fma_f32 v17, v17, s96, -v26
    v_fma_f32 v18, v18, s96, -v27
    v_fma_f32 v19, v19, s96, -v27
    v_fma_f32 v20, v20, s96, -v27
    v_fma_f32 v21, v21, s96, -v27
    v_fma_f32 v22, v22, s96, -v27
    v_fma_f32 v23, v23, s96, -v27
    v_fma_f32 v24, v24, s96, -v27
    v_fma_f32 v25, v25, s96, -v27
    v_exp_f32 v10, v10
    v_exp_f32 v11, v11
    v_exp_f32 v12, v12
    v_exp_f32 v13, v13
    v_exp_f32 v14, v14
    v_exp_f32 v15, v15
    v_exp_f32 v16, v16
    v_exp_f32 v17, v17
    v_exp_f32 v18, v18
    v_exp_f32 v19, v19
    v_exp_f32 v20, v20
    v_exp_f32 v21, v21
    v_exp_f32 v22, v22
    v_exp_f32 v23, v23
    v_exp_f32 v24, v24
    v_exp_f32 v25, v25
    v_add_f32 v28, v28, v10
    v_add_f32 v28, v28, v11
    v_add_f32 v28, v28, v12
    v_add_f32 v28, v28, v13
    v_add_f32 v28, v28, v14
    v_add_f32 v28, v28, v15
    v_add_f32 v28, v28, v16
    v_add_f32 v28, v28, v17
    v_add_f32 v29, v29, v18
    v_add_f32 v29, v29, v19
    v_add_f32 v29, v29, v20
    v_add_f32 v29, v29, v21
    v_add_f32 v29, v29, v22
    v_add_f32 v29, v29, v23
    v_add_f32 v29, v29, v24
    v_add_f32 v29, v29, v25
    v_cvt_pk_bf16_f32 v10, v10, v11
    v_cvt_pk_bf16_f32 v12, v12, v13
    v_cvt_pk_bf16_f32 v14, v14, v15
    v_cvt_pk_bf16_f32 v16, v16, v17
    v_cvt_pk_bf16_f32 v18, v18, v19
    v_cvt_pk_bf16_f32 v20, v20, v21
    v_cvt_pk_bf16_f32 v22, v22, v23
    v_cvt_pk_bf16_f32 v24, v24, v25
    v_accvgpr_write_b32 a64, v10
    v_accvgpr_write_b32 a65, v12
    v_accvgpr_write_b32 a66, v14
    v_accvgpr_write_b32 a67, v16
    v_accvgpr_write_b32 a68, v18
    v_accvgpr_write_b32 a69, v20
    v_accvgpr_write_b32 a70, v22
    v_accvgpr_write_b32 a71, v24
    v_accvgpr_read_b32 v10, a80
    v_accvgpr_read_b32 v11, a81
    v_accvgpr_read_b32 v12, a82
    v_accvgpr_read_b32 v13, a83
    v_accvgpr_read_b32 v14, a88
    v_accvgpr_read_b32 v15, a89
    v_accvgpr_read_b32 v16, a90
    v_accvgpr_read_b32 v17, a91
    v_accvgpr_read_b32 v18, a84
    v_accvgpr_read_b32 v19, a85
    v_accvgpr_read_b32 v20, a86
    v_accvgpr_read_b32 v21, a87
    v_accvgpr_read_b32 v22, a92
    v_accvgpr_read_b32 v23, a93
    v_accvgpr_read_b32 v24, a94
    v_accvgpr_read_b32 v25, a95
    v_fma_f32 v10, v10, s96, -v26
    v_fma_f32 v11, v11, s96, -v26
    v_fma_f32 v12, v12, s96, -v26
    v_fma_f32 v13, v13, s96, -v26
    v_fma_f32 v14, v14, s96, -v26
    v_fma_f32 v15, v15, s96, -v26
    v_fma_f32 v16, v16, s96, -v26
    v_fma_f32 v17, v17, s96, -v26
    v_fma_f32 v18, v18, s96, -v27
    v_fma_f32 v19, v19, s96, -v27
    v_fma_f32 v20, v20, s96, -v27
    v_fma_f32 v21, v21, s96, -v27
    v_fma_f32 v22, v22, s96, -v27
    v_fma_f32 v23, v23, s96, -v27
    v_fma_f32 v24, v24, s96, -v27
    v_fma_f32 v25, v25, s96, -v27
    v_exp_f32 v10, v10
    v_exp_f32 v11, v11
    v_exp_f32 v12, v12
    v_exp_f32 v13, v13
    v_exp_f32 v14, v14
    v_exp_f32 v15, v15
    v_exp_f32 v16, v16
    v_exp_f32 v17, v17
    v_exp_f32 v18, v18
    v_exp_f32 v19, v19
    v_exp_f32 v20, v20
    v_exp_f32 v21, v21
    v_exp_f32 v22, v22
    v_exp_f32 v23, v23
    v_exp_f32 v24, v24
    v_exp_f32 v25, v25
    v_add_f32 v28, v28, v10
    v_add_f32 v28, v28, v11
    v_add_f32 v28, v28, v12
    v_add_f32 v28, v28, v13
    v_add_f32 v28, v28, v14
    v_add_f32 v28, v28, v15
    v_add_f32 v28, v28, v16
    v_add_f32 v28, v28, v17
    v_add_f32 v29, v29, v18
    v_add_f32 v29, v29, v19
    v_add_f32 v29, v29, v20
    v_add_f32 v29, v29, v21
    v_add_f32 v29, v29, v22
    v_add_f32 v29, v29, v23
    v_add_f32 v29, v29, v24
    v_add_f32 v29, v29, v25
    v_cvt_pk_bf16_f32 v10, v10, v11
    v_cvt_pk_bf16_f32 v12, v12, v13
    v_cvt_pk_bf16_f32 v14, v14, v15
    v_cvt_pk_bf16_f32 v16, v16, v17
    v_cvt_pk_bf16_f32 v18, v18, v19
    v_cvt_pk_bf16_f32 v20, v20, v21
    v_cvt_pk_bf16_f32 v22, v22, v23
    v_cvt_pk_bf16_f32 v24, v24, v25
    v_accvgpr_write_b32 a80, v10
    v_accvgpr_write_b32 a81, v12
    v_accvgpr_write_b32 a82, v14
    v_accvgpr_write_b32 a83, v16
    v_accvgpr_write_b32 a84, v18
    v_accvgpr_write_b32 a85, v20
    v_accvgpr_write_b32 a86, v22
    v_accvgpr_write_b32 a87, v24
    v_accvgpr_read_b32 v10, a96
    v_accvgpr_read_b32 v11, a97
    v_accvgpr_read_b32 v12, a98
    v_accvgpr_read_b32 v13, a99
    v_accvgpr_read_b32 v14, a104
    v_accvgpr_read_b32 v15, a105
    v_accvgpr_read_b32 v16, a106
    v_accvgpr_read_b32 v17, a107
    v_accvgpr_read_b32 v18, a100
    v_accvgpr_read_b32 v19, a101
    v_accvgpr_read_b32 v20, a102
    v_accvgpr_read_b32 v21, a103
    v_accvgpr_read_b32 v22, a108
    v_accvgpr_read_b32 v23, a109
    v_accvgpr_read_b32 v24, a110
    v_accvgpr_read_b32 v25, a111
    v_fma_f32 v10, v10, s96, -v26
    v_fma_f32 v11, v11, s96, -v26
    v_fma_f32 v12, v12, s96, -v26
    v_fma_f32 v13, v13, s96, -v26
    v_fma_f32 v14, v14, s96, -v26
    v_fma_f32 v15, v15, s96, -v26
    v_fma_f32 v16, v16, s96, -v26
    v_fma_f32 v17, v17, s96, -v26
    v_fma_f32 v18, v18, s96, -v27
    v_fma_f32 v19, v19, s96, -v27
    v_fma_f32 v20, v20, s96, -v27
    v_fma_f32 v21, v21, s96, -v27
    v_fma_f32 v22, v22, s96, -v27
    v_fma_f32 v23, v23, s96, -v27
    v_fma_f32 v24, v24, s96, -v27
    v_fma_f32 v25, v25, s96, -v27
    v_exp_f32 v10, v10
    v_exp_f32 v11, v11
    v_exp_f32 v12, v12
    v_exp_f32 v13, v13
    v_exp_f32 v14, v14
    v_exp_f32 v15, v15
    v_exp_f32 v16, v16
    v_exp_f32 v17, v17
    v_exp_f32 v18, v18
    v_exp_f32 v19, v19
    v_exp_f32 v20, v20
    v_exp_f32 v21, v21
    v_exp_f32 v22, v22
    v_exp_f32 v23, v23
    v_exp_f32 v24, v24
    v_exp_f32 v25, v25
    v_add_f32 v28, v28, v10
    v_add_f32 v28, v28, v11
    v_add_f32 v28, v28, v12
    v_add_f32 v28, v28, v13
    v_add_f32 v28, v28, v14
    v_add_f32 v28, v28, v15
    v_add_f32 v28, v28, v16
    v_add_f32 v28, v28, v17
    v_add_f32 v29, v29, v18
    v_add_f32 v29, v29, v19
    v_add_f32 v29, v29, v20
    v_add_f32 v29, v29, v21
    v_add_f32 v29, v29, v22
    v_add_f32 v29, v29, v23
    v_add_f32 v29, v29, v24
    v_add_f32 v29, v29, v25
    v_cvt_pk_bf16_f32 v10, v10, v11
    v_cvt_pk_bf16_f32 v12, v12, v13
    v_cvt_pk_bf16_f32 v14, v14, v15
    v_cvt_pk_bf16_f32 v16, v16, v17
    v_cvt_pk_bf16_f32 v18, v18, v19
    v_cvt_pk_bf16_f32 v20, v20, v21
    v_cvt_pk_bf16_f32 v22, v22, v23
    v_cvt_pk_bf16_f32 v24, v24, v25
    v_accvgpr_write_b32 a96, v10
    v_accvgpr_write_b32 a97, v12
    v_accvgpr_write_b32 a98, v14
    v_accvgpr_write_b32 a99, v16
    v_accvgpr_write_b32 a100, v18
    v_accvgpr_write_b32 a101, v20
    v_accvgpr_write_b32 a102, v22
    v_accvgpr_write_b32 a103, v24
    v_accvgpr_read_b32 v10, a112
    v_accvgpr_read_b32 v11, a113
    v_accvgpr_read_b32 v12, a114
    v_accvgpr_read_b32 v13, a115
    v_accvgpr_read_b32 v14, a120
    v_accvgpr_read_b32 v15, a121
    v_accvgpr_read_b32 v16, a122
    v_accvgpr_read_b32 v17, a123
    v_accvgpr_read_b32 v18, a116
    v_accvgpr_read_b32 v19, a117
    v_accvgpr_read_b32 v20, a118
    v_accvgpr_read_b32 v21, a119
    v_accvgpr_read_b32 v22, a124
    v_accvgpr_read_b32 v23, a125
    v_accvgpr_read_b32 v24, a126
    v_accvgpr_read_b32 v25, a127
    v_fma_f32 v10, v10, s96, -v26
    v_fma_f32 v11, v11, s96, -v26
    v_fma_f32 v12, v12, s96, -v26
    v_fma_f32 v13, v13, s96, -v26
    v_fma_f32 v14, v14, s96, -v26
    v_fma_f32 v15, v15, s96, -v26
    v_fma_f32 v16, v16, s96, -v26
    v_fma_f32 v17, v17, s96, -v26
    v_fma_f32 v18, v18, s96, -v27
    v_fma_f32 v19, v19, s96, -v27
    v_fma_f32 v20, v20, s96, -v27
    v_fma_f32 v21, v21, s96, -v27
    v_fma_f32 v22, v22, s96, -v27
    v_fma_f32 v23, v23, s96, -v27
    v_fma_f32 v24, v24, s96, -v27
    v_fma_f32 v25, v25, s96, -v27
    v_exp_f32 v10, v10
    v_exp_f32 v11, v11
    v_exp_f32 v12, v12
    v_exp_f32 v13, v13
    v_exp_f32 v14, v14
    v_exp_f32 v15, v15
    v_exp_f32 v16, v16
    v_exp_f32 v17, v17
    v_exp_f32 v18, v18
    v_exp_f32 v19, v19
    v_exp_f32 v20, v20
    v_exp_f32 v21, v21
    v_exp_f32 v22, v22
    v_exp_f32 v23, v23
    v_exp_f32 v24, v24
    v_exp_f32 v25, v25
    v_add_f32 v28, v28, v10
    v_add_f32 v28, v28, v11
    v_add_f32 v28, v28, v12
    v_add_f32 v28, v28, v13
    v_add_f32 v28, v28, v14
    v_add_f32 v28, v28, v15
    v_add_f32 v28, v28, v16
    v_add_f32 v28, v28, v17
    v_add_f32 v29, v29, v18
    v_add_f32 v29, v29, v19
    v_add_f32 v29, v29, v20
    v_add_f32 v29, v29, v21
    v_add_f32 v29, v29, v22
    v_add_f32 v29, v29, v23
    v_add_f32 v29, v29, v24
    v_add_f32 v29, v29, v25
    v_cvt_pk_bf16_f32 v10, v10, v11
    v_cvt_pk_bf16_f32 v12, v12, v13
    v_cvt_pk_bf16_f32 v14, v14, v15
    v_cvt_pk_bf16_f32 v16, v16, v17
    v_cvt_pk_bf16_f32 v18, v18, v19
    v_cvt_pk_bf16_f32 v20, v20, v21
    v_cvt_pk_bf16_f32 v22, v22, v23
    v_cvt_pk_bf16_f32 v24, v24, v25
    v_accvgpr_write_b32 a112, v10
    v_accvgpr_write_b32 a113, v12
    v_accvgpr_write_b32 a114, v14
    v_accvgpr_write_b32 a115, v16
    v_accvgpr_write_b32 a116, v18
    v_accvgpr_write_b32 a117, v20
    v_accvgpr_write_b32 a118, v22
    v_accvgpr_write_b32 a119, v24
    s_waitcnt lgkmcnt(0)
    s_barrier
    buffer_load_dword v30, v9, s[72:75], 0 offen sc1
    ds_read_b128 v[32:35], v0
    ds_read_b128 v[36:39], v0 offset:1024
    ds_read_b128 v[40:43], v0 offset:2048
    ds_read_b128 v[44:47], v0 offset:3072
    ds_read_b128 v[48:51], v0 offset:4096
    ds_read_b128 v[52:55], v0 offset:5120
    ds_read_b128 v[56:59], v0 offset:6144
    ds_read_b128 v[60:63], v0 offset:7168
    ds_read_b128 v[128:131], v0 offset:8192
    ds_read_b128 v[132:135], v0 offset:9216
    ds_read_b128 v[136:139], v0 offset:10240
    ds_read_b128 v[140:143], v0 offset:11264
    ds_read_b128 v[144:147], v0 offset:12288
    ds_read_b128 v[148:151], v0 offset:13312
    ds_read_b128 v[152:155], v0 offset:14336
    ds_read_b128 v[156:159], v0 offset:15360
    s_waitcnt lgkmcnt(15)
    v_mfma_f32_16x16x32_bf16 a[8:11], v[32:35], a[0:3], 0
    v_accvgpr_read_b32 v10, a128
    v_accvgpr_read_b32 v11, a129
    v_accvgpr_read_b32 v12, a130
    v_accvgpr_read_b32 v13, a131
    v_accvgpr_read_b32 v14, a136
    v_mfma_f32_16x16x32_bf16 a[12:15], v[32:35], a[4:7], 0
    v_accvgpr_read_b32 v15, a137
    v_accvgpr_read_b32 v16, a138
    v_accvgpr_read_b32 v17, a139
    v_accvgpr_read_b32 v18, a132
    v_accvgpr_read_b32 v19, a133
    ds_read_b128 v[160:163], v0 offset:16384
    s_waitcnt lgkmcnt(15)
    v_mfma_f32_16x16x32_bf16 a[24:27], v[36:39], a[0:3], 0
    v_accvgpr_read_b32 v20, a134
    v_accvgpr_read_b32 v21, a135
    v_accvgpr_read_b32 v22, a140
    v_accvgpr_read_b32 v23, a141
    v_accvgpr_read_b32 v24, a142
    v_mfma_f32_16x16x32_bf16 a[28:31], v[36:39], a[4:7], 0
    v_accvgpr_read_b32 v25, a143
    v_fma_f32 v10, v10, s96, -v26
    v_fma_f32 v11, v11, s96, -v26
    v_fma_f32 v12, v12, s96, -v26
    v_fma_f32 v13, v13, s96, -v26
    ds_read_b128 v[164:167], v0 offset:17408
    s_waitcnt lgkmcnt(15)
    v_mfma_f32_16x16x32_bf16 a[40:43], v[40:43], a[0:3], 0
    v_fma_f32 v14, v14, s96, -v26
    v_fma_f32 v15, v15, s96, -v26
    v_fma_f32 v16, v16, s96, -v26
    v_fma_f32 v17, v17, s96, -v26
    v_fma_f32 v18, v18, s96, -v27
    v_mfma_f32_16x16x32_bf16 a[44:47], v[40:43], a[4:7], 0
    v_fma_f32 v19, v19, s96, -v27
    v_fma_f32 v20, v20, s96, -v27
    v_fma_f32 v21, v21, s96, -v27
    v_fma_f32 v22, v22, s96, -v27
    v_fma_f32 v23, v23, s96, -v27
    ds_read_b128 v[168:171], v0 offset:18432
    s_waitcnt lgkmcnt(15)
    v_mfma_f32_16x16x32_bf16 a[56:59], v[44:47], a[0:3], 0
    v_fma_f32 v24, v24, s96, -v27
    v_fma_f32 v25, v25, s96, -v27
    v_exp_f32 v10, v10
    v_exp_f32 v11, v11
    v_exp_f32 v12, v12
    v_mfma_f32_16x16x32_bf16 a[60:63], v[44:47], a[4:7], 0
    v_exp_f32 v13, v13
    v_exp_f32 v14, v14
    v_exp_f32 v15, v15
    v_exp_f32 v16, v16
    v_exp_f32 v17, v17
    ds_read_b128 v[172:175], v0 offset:19456
    s_waitcnt lgkmcnt(15)
    v_mfma_f32_16x16x32_bf16 a[72:75], v[48:51], a[0:3], 0
    v_exp_f32 v18, v18
    v_exp_f32 v19, v19
    v_exp_f32 v20, v20
    v_exp_f32 v21, v21
    v_exp_f32 v22, v22
    v_mfma_f32_16x16x32_bf16 a[76:79], v[48:51], a[4:7], 0
    v_exp_f32 v23, v23
    v_exp_f32 v24, v24
    v_exp_f32 v25, v25
    v_add_f32 v28, v28, v10
    v_add_f32 v28, v28, v11
    ds_read_b128 v[176:179], v0 offset:20480
    s_waitcnt lgkmcnt(15)
    v_mfma_f32_16x16x32_bf16 a[88:91], v[52:55], a[0:3], 0
    v_add_f32 v28, v28, v12
    v_add_f32 v28, v28, v13
    v_add_f32 v28, v28, v14
    v_add_f32 v28, v28, v15
    v_add_f32 v28, v28, v16
    v_mfma_f32_16x16x32_bf16 a[92:95], v[52:55], a[4:7], 0
    v_add_f32 v28, v28, v17
    v_add_f32 v29, v29, v18
    v_add_f32 v29, v29, v19
    v_add_f32 v29, v29, v20
    v_add_f32 v29, v29, v21
    ds_read_b128 v[180:183], v0 offset:21504
    s_waitcnt lgkmcnt(15)
    v_mfma_f32_16x16x32_bf16 a[104:107], v[56:59], a[0:3], 0
    v_add_f32 v29, v29, v22
    v_add_f32 v29, v29, v23
    v_add_f32 v29, v29, v24
    v_add_f32 v29, v29, v25
    v_cvt_pk_bf16_f32 v10, v10, v11
    v_mfma_f32_16x16x32_bf16 a[108:111], v[56:59], a[4:7], 0
    v_cvt_pk_bf16_f32 v12, v12, v13
    v_cvt_pk_bf16_f32 v14, v14, v15
    v_cvt_pk_bf16_f32 v16, v16, v17
    v_cvt_pk_bf16_f32 v18, v18, v19
    v_cvt_pk_bf16_f32 v20, v20, v21
    ds_read_b128 v[184:187], v0 offset:22528
    s_waitcnt lgkmcnt(15)
    v_mfma_f32_16x16x32_bf16 a[120:123], v[60:63], a[0:3], 0
    v_cvt_pk_bf16_f32 v22, v22, v23
    v_cvt_pk_bf16_f32 v24, v24, v25
    v_accvgpr_write_b32 a128, v10
    v_accvgpr_write_b32 a129, v12
    v_accvgpr_write_b32 a130, v14
    v_mfma_f32_16x16x32_bf16 a[124:127], v[60:63], a[4:7], 0
    v_accvgpr_write_b32 a131, v16
    v_accvgpr_write_b32 a132, v18
    v_accvgpr_write_b32 a133, v20
    v_accvgpr_write_b32 a134, v22
    v_accvgpr_write_b32 a135, v24
    ds_read_b128 v[188:191], v0 offset:23552
    s_waitcnt lgkmcnt(15)
    v_mfma_f32_16x16x32_bf16 a[8:11], v[128:131], a[16:19], a[8:11]
    v_accvgpr_read_b32 v10, a144
    v_accvgpr_read_b32 v11, a145
    v_accvgpr_read_b32 v12, a146
    v_accvgpr_read_b32 v13, a147
    v_accvgpr_read_b32 v14, a152
    v_mfma_f32_16x16x32_bf16 a[12:15], v[128:131], a[20:23], a[12:15]
    v_accvgpr_read_b32 v15, a153
    v_accvgpr_read_b32 v16, a154
    v_accvgpr_read_b32 v17, a155
    v_accvgpr_read_b32 v18, a148
    v_accvgpr_read_b32 v19, a149
    ds_read_b128 v[32:35], v0 offset:24576
    s_waitcnt lgkmcnt(15)
    v_mfma_f32_16x16x32_bf16 a[24:27], v[132:135], a[16:19], a[24:27]
    v_accvgpr_read_b32 v20, a150
    v_accvgpr_read_b32 v21, a151
    v_accvgpr_read_b32 v22, a156
    v_accvgpr_read_b32 v23, a157
    v_accvgpr_read_b32 v24, a158
    v_mfma_f32_16x16x32_bf16 a[28:31], v[132:135], a[20:23], a[28:31]
    v_accvgpr_read_b32 v25, a159
    v_fma_f32 v10, v10, s96, -v26
    v_fma_f32 v11, v11, s96, -v26
    v_fma_f32 v12, v12, s96, -v26
    v_fma_f32 v13, v13, s96, -v26
    ds_read_b128 v[36:39], v0 offset:25600
    s_waitcnt lgkmcnt(15)
    v_mfma_f32_16x16x32_bf16 a[40:43], v[136:139], a[16:19], a[40:43]
    v_fma_f32 v14, v14, s96, -v26
    v_fma_f32 v15, v15, s96, -v26
    v_fma_f32 v16, v16, s96, -v26
    v_fma_f32 v17, v17, s96, -v26
    v_fma_f32 v18, v18, s96, -v27
    v_mfma_f32_16x16x32_bf16 a[44:47], v[136:139], a[20:23], a[44:47]
    v_fma_f32 v19, v19, s96, -v27
    v_fma_f32 v20, v20, s96, -v27
    v_fma_f32 v21, v21, s96, -v27
    v_fma_f32 v22, v22, s96, -v27
    v_fma_f32 v23, v23, s96, -v27
    ds_read_b128 v[40:43], v0 offset:26624
    s_waitcnt lgkmcnt(15)
    v_mfma_f32_16x16x32_bf16 a[56:59], v[140:143], a[16:19], a[56:59]
    v_fma_f32 v24, v24, s96, -v27
    v_fma_f32 v25, v25, s96, -v27
    v_exp_f32 v10, v10
    v_exp_f32 v11, v11
    v_exp_f32 v12, v12
    v_mfma_f32_16x16x32_bf16 a[60:63], v[140:143], a[20:23], a[60:63]
    v_exp_f32 v13, v13
    v_exp_f32 v14, v14
    v_exp_f32 v15, v15
    v_exp_f32 v16, v16
    v_exp_f32 v17, v17
    ds_read_b128 v[44:47], v0 offset:27648
    s_waitcnt lgkmcnt(15)
    v_mfma_f32_16x16x32_bf16 a[72:75], v[144:147], a[16:19], a[72:75]
    v_exp_f32 v18, v18
    v_exp_f32 v19, v19
    v_exp_f32 v20, v20
    v_exp_f32 v21, v21
    v_exp_f32 v22, v22
    v_mfma_f32_16x16x32_bf16 a[76:79], v[144:147], a[20:23], a[76:79]
    v_exp_f32 v23, v23
    v_exp_f32 v24, v24
    v_exp_f32 v25, v25
    v_add_f32 v28, v28, v10
    v_add_f32 v28, v28, v11
    ds_read_b128 v[48:51], v0 offset:28672
    s_waitcnt lgkmcnt(15)
    v_mfma_f32_16x16x32_bf16 a[88:91], v[148:151], a[16:19], a[88:91]
    v_add_f32 v28, v28, v12
    v_add_f32 v28, v28, v13
    v_add_f32 v28, v28, v14
    v_add_f32 v28, v28, v15
    v_add_f32 v28, v28, v16
    v_mfma_f32_16x16x32_bf16 a[92:95], v[148:151], a[20:23], a[92:95]
    v_add_f32 v28, v28, v17
    v_add_f32 v29, v29, v18
    v_add_f32 v29, v29, v19
    v_add_f32 v29, v29, v20
    v_add_f32 v29, v29, v21
    ds_read_b128 v[52:55], v0 offset:29696
    s_waitcnt lgkmcnt(15)
    v_mfma_f32_16x16x32_bf16 a[104:107], v[152:155], a[16:19], a[104:107]
    v_add_f32 v29, v29, v22
    v_add_f32 v29, v29, v23
    v_add_f32 v29, v29, v24
    v_add_f32 v29, v29, v25
    v_cvt_pk_bf16_f32 v10, v10, v11
    v_mfma_f32_16x16x32_bf16 a[108:111], v[152:155], a[20:23], a[108:111]
    v_cvt_pk_bf16_f32 v12, v12, v13
    v_cvt_pk_bf16_f32 v14, v14, v15
    v_cvt_pk_bf16_f32 v16, v16, v17
    v_cvt_pk_bf16_f32 v18, v18, v19
    v_cvt_pk_bf16_f32 v20, v20, v21
    ds_read_b128 v[56:59], v0 offset:30720
    s_waitcnt lgkmcnt(15)
    v_mfma_f32_16x16x32_bf16 a[120:123], v[156:159], a[16:19], a[120:123]
    v_cvt_pk_bf16_f32 v22, v22, v23
    v_cvt_pk_bf16_f32 v24, v24, v25
    v_accvgpr_write_b32 a144, v10
    v_accvgpr_write_b32 a145, v12
    v_accvgpr_write_b32 a146, v14
    v_mfma_f32_16x16x32_bf16 a[124:127], v[156:159], a[20:23], a[124:127]
    v_accvgpr_write_b32 a147, v16
    v_accvgpr_write_b32 a148, v18
    v_accvgpr_write_b32 a149, v20
    v_accvgpr_write_b32 a150, v22
    v_accvgpr_write_b32 a151, v24
    ds_read_b128 v[60:63], v0 offset:31744
    s_waitcnt lgkmcnt(15)
    v_mfma_f32_16x16x32_bf16 a[8:11], v[160:163], a[32:35], a[8:11]
    v_accvgpr_read_b32 v10, a160
    v_accvgpr_read_b32 v11, a161
    v_accvgpr_read_b32 v12, a162
    v_accvgpr_read_b32 v13, a163
    v_accvgpr_read_b32 v14, a168
    v_mfma_f32_16x16x32_bf16 a[12:15], v[160:163], a[36:39], a[12:15]
    v_accvgpr_read_b32 v15, a169
    v_accvgpr_read_b32 v16, a170
    v_accvgpr_read_b32 v17, a171
    v_accvgpr_read_b32 v18, a164
    v_accvgpr_read_b32 v19, a165
    ds_read_b128 v[128:131], v0 offset:33280
    s_waitcnt lgkmcnt(15)
    v_mfma_f32_16x16x32_bf16 a[24:27], v[164:167], a[32:35], a[24:27]
    v_accvgpr_read_b32 v20, a166
    v_accvgpr_read_b32 v21, a167
    v_accvgpr_read_b32 v22, a172
    v_accvgpr_read_b32 v23, a173
    v_accvgpr_read_b32 v24, a174
    v_mfma_f32_16x16x32_bf16 a[28:31], v[164:167], a[36:39], a[28:31]
    v_accvgpr_read_b32 v25, a175
    v_fma_f32 v10, v10, s96, -v26
    v_fma_f32 v11, v11, s96, -v26
    v_fma_f32 v12, v12, s96, -v26
    v_fma_f32 v13, v13, s96, -v26
    ds_read_b128 v[132:135], v0 offset:34304
    s_waitcnt lgkmcnt(15)
    v_mfma_f32_16x16x32_bf16 a[40:43], v[168:171], a[32:35], a[40:43]
    v_fma_f32 v14, v14, s96, -v26
    v_fma_f32 v15, v15, s96, -v26
    v_fma_f32 v16, v16, s96, -v26
    v_fma_f32 v17, v17, s96, -v26
    v_fma_f32 v18, v18, s96, -v27
    v_mfma_f32_16x16x32_bf16 a[44:47], v[168:171], a[36:39], a[44:47]
    v_fma_f32 v19, v19, s96, -v27
    v_fma_f32 v20, v20, s96, -v27
    v_fma_f32 v21, v21, s96, -v27
    v_fma_f32 v22, v22, s96, -v27
    v_fma_f32 v23, v23, s96, -v27
    ds_read_b128 v[136:139], v0 offset:35328
    s_waitcnt lgkmcnt(15)
    v_mfma_f32_16x16x32_bf16 a[56:59], v[172:175], a[32:35], a[56:59]
    v_fma_f32 v24, v24, s96, -v27
    v_fma_f32 v25, v25, s96, -v27
    v_exp_f32 v10, v10
    v_exp_f32 v11, v11
    v_exp_f32 v12, v12
    v_mfma_f32_16x16x32_bf16 a[60:63], v[172:175], a[36:39], a[60:63]
    v_exp_f32 v13, v13
    v_exp_f32 v14, v14
    v_exp_f32 v15, v15
    v_exp_f32 v16, v16
    v_exp_f32 v17, v17
    ds_read_b128 v[140:143], v0 offset:36352
    s_waitcnt lgkmcnt(15)
    v_mfma_f32_16x16x32_bf16 a[72:75], v[176:179], a[32:35], a[72:75]
    v_exp_f32 v18, v18
    v_exp_f32 v19, v19
    v_exp_f32 v20, v20
    v_exp_f32 v21, v21
    v_exp_f32 v22, v22
    v_mfma_f32_16x16x32_bf16 a[76:79], v[176:179], a[36:39], a[76:79]
    v_exp_f32 v23, v23
    v_exp_f32 v24, v24
    v_exp_f32 v25, v25
    v_add_f32 v28, v28, v10
    v_add_f32 v28, v28, v11
    ds_read_b128 v[144:147], v0 offset:37376
    s_waitcnt lgkmcnt(15)
    v_mfma_f32_16x16x32_bf16 a[88:91], v[180:183], a[32:35], a[88:91]
    v_add_f32 v28, v28, v12
    v_add_f32 v28, v28, v13
    v_add_f32 v28, v28, v14
    v_add_f32 v28, v28, v15
    v_add_f32 v28, v28, v16
    v_mfma_f32_16x16x32_bf16 a[92:95], v[180:183], a[36:39], a[92:95]
    v_add_f32 v28, v28, v17
    v_add_f32 v29, v29, v18
    v_add_f32 v29, v29, v19
    v_add_f32 v29, v29, v20
    v_add_f32 v29, v29, v21
    ds_read_b128 v[148:151], v0 offset:38400
    s_waitcnt lgkmcnt(15)
    v_mfma_f32_16x16x32_bf16 a[104:107], v[184:187], a[32:35], a[104:107]
    v_add_f32 v29, v29, v22
    v_add_f32 v29, v29, v23
    v_add_f32 v29, v29, v24
    v_add_f32 v29, v29, v25
    v_cvt_pk_bf16_f32 v10, v10, v11
    v_mfma_f32_16x16x32_bf16 a[108:111], v[184:187], a[36:39], a[108:111]
    v_cvt_pk_bf16_f32 v12, v12, v13
    v_cvt_pk_bf16_f32 v14, v14, v15
    v_cvt_pk_bf16_f32 v16, v16, v17
    v_cvt_pk_bf16_f32 v18, v18, v19
    v_cvt_pk_bf16_f32 v20, v20, v21
    ds_read_b128 v[152:155], v0 offset:39424
    s_waitcnt lgkmcnt(15)
    v_mfma_f32_16x16x32_bf16 a[120:123], v[188:191], a[32:35], a[120:123]
    v_cvt_pk_bf16_f32 v22, v22, v23
    v_cvt_pk_bf16_f32 v24, v24, v25
    v_accvgpr_write_b32 a160, v10
    v_accvgpr_write_b32 a161, v12
    v_accvgpr_write_b32 a162, v14
    v_mfma_f32_16x16x32_bf16 a[124:127], v[188:191], a[36:39], a[124:127]
    v_accvgpr_write_b32 a163, v16
    v_accvgpr_write_b32 a164, v18
    v_accvgpr_write_b32 a165, v20
    v_accvgpr_write_b32 a166, v22
    v_accvgpr_write_b32 a167, v24
    ds_read_b128 v[156:159], v0 offset:40448
    s_waitcnt lgkmcnt(15)
    v_mfma_f32_16x16x32_bf16 a[8:11], v[32:35], a[48:51], a[8:11]
    v_accvgpr_read_b32 v10, a176
    v_accvgpr_read_b32 v11, a177
    v_accvgpr_read_b32 v12, a178
    v_accvgpr_read_b32 v13, a179
    v_accvgpr_read_b32 v14, a184
    v_mfma_f32_16x16x32_bf16 a[12:15], v[32:35], a[52:55], a[12:15]
    v_accvgpr_read_b32 v15, a185
    v_accvgpr_read_b32 v16, a186
    v_accvgpr_read_b32 v17, a187
    v_accvgpr_read_b32 v18, a180
    v_accvgpr_read_b32 v19, a181
    ds_read_b128 v[160:163], v0 offset:41472
    s_waitcnt lgkmcnt(15)
    v_mfma_f32_16x16x32_bf16 a[24:27], v[36:39], a[48:51], a[24:27]
    v_accvgpr_read_b32 v20, a182
    v_accvgpr_read_b32 v21, a183
    v_accvgpr_read_b32 v22, a188
    v_accvgpr_read_b32 v23, a189
    v_accvgpr_read_b32 v24, a190
    v_mfma_f32_16x16x32_bf16 a[28:31], v[36:39], a[52:55], a[28:31]
    v_accvgpr_read_b32 v25, a191
    v_fma_f32 v10, v10, s96, -v26
    v_fma_f32 v11, v11, s96, -v26
    v_fma_f32 v12, v12, s96, -v26
    v_fma_f32 v13, v13, s96, -v26
    ds_read_b128 v[164:167], v0 offset:42496
    s_waitcnt lgkmcnt(15)
    v_mfma_f32_16x16x32_bf16 a[40:43], v[40:43], a[48:51], a[40:43]
    v_fma_f32 v14, v14, s96, -v26
    v_fma_f32 v15, v15, s96, -v26
    v_fma_f32 v16, v16, s96, -v26
    v_fma_f32 v17, v17, s96, -v26
    v_fma_f32 v18, v18, s96, -v27
    v_mfma_f32_16x16x32_bf16 a[44:47], v[40:43], a[52:55], a[44:47]
    v_fma_f32 v19, v19, s96, -v27
    v_fma_f32 v20, v20, s96, -v27
    v_fma_f32 v21, v21, s96, -v27
    v_fma_f32 v22, v22, s96, -v27
    v_fma_f32 v23, v23, s96, -v27
    ds_read_b128 v[168:171], v0 offset:43520
    s_waitcnt lgkmcnt(15)
    v_mfma_f32_16x16x32_bf16 a[56:59], v[44:47], a[48:51], a[56:59]
    v_fma_f32 v24, v24, s96, -v27
    v_fma_f32 v25, v25, s96, -v27
    v_exp_f32 v10, v10
    v_exp_f32 v11, v11
    v_exp_f32 v12, v12
    v_mfma_f32_16x16x32_bf16 a[60:63], v[44:47], a[52:55], a[60:63]
    v_exp_f32 v13, v13
    v_exp_f32 v14, v14
    v_exp_f32 v15, v15
    v_exp_f32 v16, v16
    v_exp_f32 v17, v17
    ds_read_b128 v[172:175], v0 offset:44544
    s_waitcnt lgkmcnt(15)
    v_mfma_f32_16x16x32_bf16 a[72:75], v[48:51], a[48:51], a[72:75]
    v_exp_f32 v18, v18
    v_exp_f32 v19, v19
    v_exp_f32 v20, v20
    v_exp_f32 v21, v21
    v_exp_f32 v22, v22
    v_mfma_f32_16x16x32_bf16 a[76:79], v[48:51], a[52:55], a[76:79]
    v_exp_f32 v23, v23
    v_exp_f32 v24, v24
    v_exp_f32 v25, v25
    v_add_f32 v28, v28, v10
    v_add_f32 v28, v28, v11
    ds_read_b128 v[176:179], v0 offset:45568
    s_waitcnt lgkmcnt(15)
    v_mfma_f32_16x16x32_bf16 a[88:91], v[52:55], a[48:51], a[88:91]
    v_add_f32 v28, v28, v12
    v_add_f32 v28, v28, v13
    v_add_f32 v28, v28, v14
    v_add_f32 v28, v28, v15
    v_add_f32 v28, v28, v16
    v_mfma_f32_16x16x32_bf16 a[92:95], v[52:55], a[52:55], a[92:95]
    v_add_f32 v28, v28, v17
    v_add_f32 v29, v29, v18
    v_add_f32 v29, v29, v19
    v_add_f32 v29, v29, v20
    v_add_f32 v29, v29, v21
    ds_read_b128 v[180:183], v0 offset:46592
    s_waitcnt lgkmcnt(15)
    v_mfma_f32_16x16x32_bf16 a[104:107], v[56:59], a[48:51], a[104:107]
    v_add_f32 v29, v29, v22
    v_add_f32 v29, v29, v23
    v_add_f32 v29, v29, v24
    v_add_f32 v29, v29, v25
    v_cvt_pk_bf16_f32 v10, v10, v11
    v_mfma_f32_16x16x32_bf16 a[108:111], v[56:59], a[52:55], a[108:111]
    v_cvt_pk_bf16_f32 v12, v12, v13
    v_cvt_pk_bf16_f32 v14, v14, v15
    v_cvt_pk_bf16_f32 v16, v16, v17
    v_cvt_pk_bf16_f32 v18, v18, v19
    v_cvt_pk_bf16_f32 v20, v20, v21
    ds_read_b128 v[184:187], v0 offset:47616
    s_waitcnt lgkmcnt(15)
    v_mfma_f32_16x16x32_bf16 a[120:123], v[60:63], a[48:51], a[120:123]
    v_cvt_pk_bf16_f32 v22, v22, v23
    v_cvt_pk_bf16_f32 v24, v24, v25
    v_accvgpr_write_b32 a176, v10
    v_accvgpr_write_b32 a177, v12
    v_accvgpr_write_b32 a178, v14
    v_mfma_f32_16x16x32_bf16 a[124:127], v[60:63], a[52:55], a[124:127]
    v_accvgpr_write_b32 a179, v16
    v_accvgpr_write_b32 a180, v18
    v_accvgpr_write_b32 a181, v20
    v_accvgpr_write_b32 a182, v22
    v_accvgpr_write_b32 a183, v24
    ds_read_b128 v[188:191], v0 offset:48640
    s_waitcnt lgkmcnt(15)
    v_mfma_f32_16x16x32_bf16 a[8:11], v[128:131], a[64:67], a[8:11]
    v_accvgpr_read_b32 v10, a192
    v_accvgpr_read_b32 v11, a193
    v_accvgpr_read_b32 v12, a194
    v_accvgpr_read_b32 v13, a195
    v_accvgpr_read_b32 v14, a200
    v_mfma_f32_16x16x32_bf16 a[12:15], v[128:131], a[68:71], a[12:15]
    v_accvgpr_read_b32 v15, a201
    v_accvgpr_read_b32 v16, a202
    v_accvgpr_read_b32 v17, a203
    v_accvgpr_read_b32 v18, a196
    v_accvgpr_read_b32 v19, a197
    ds_read_b128 v[32:35], v0 offset:49664
    s_waitcnt lgkmcnt(15)
    v_mfma_f32_16x16x32_bf16 a[24:27], v[132:135], a[64:67], a[24:27]
    v_accvgpr_read_b32 v20, a198
    v_accvgpr_read_b32 v21, a199
    v_accvgpr_read_b32 v22, a204
    v_accvgpr_read_b32 v23, a205
    v_accvgpr_read_b32 v24, a206
    v_mfma_f32_16x16x32_bf16 a[28:31], v[132:135], a[68:71], a[28:31]
    v_accvgpr_read_b32 v25, a207
    v_fma_f32 v10, v10, s96, -v26
    v_fma_f32 v11, v11, s96, -v26
    v_fma_f32 v12, v12, s96, -v26
    v_fma_f32 v13, v13, s96, -v26
    ds_read_b128 v[36:39], v0 offset:50688
    s_waitcnt lgkmcnt(15)
    v_mfma_f32_16x16x32_bf16 a[40:43], v[136:139], a[64:67], a[40:43]
    v_fma_f32 v14, v14, s96, -v26
    v_fma_f32 v15, v15, s96, -v26
    v_fma_f32 v16, v16, s96, -v26
    v_fma_f32 v17, v17, s96, -v26
    v_fma_f32 v18, v18, s96, -v27
    v_mfma_f32_16x16x32_bf16 a[44:47], v[136:139], a[68:71], a[44:47]
    v_fma_f32 v19, v19, s96, -v27
    v_fma_f32 v20, v20, s96, -v27
    v_fma_f32 v21, v21, s96, -v27
    v_fma_f32 v22, v22, s96, -v27
    v_fma_f32 v23, v23, s96, -v27
    ds_read_b128 v[40:43], v0 offset:51712
    s_waitcnt lgkmcnt(15)
    v_mfma_f32_16x16x32_bf16 a[56:59], v[140:143], a[64:67], a[56:59]
    v_fma_f32 v24, v24, s96, -v27
    v_fma_f32 v25, v25, s96, -v27
    v_exp_f32 v10, v10
    v_exp_f32 v11, v11
    v_exp_f32 v12, v12
    v_mfma_f32_16x16x32_bf16 a[60:63], v[140:143], a[68:71], a[60:63]
    v_exp_f32 v13, v13
    v_exp_f32 v14, v14
    v_exp_f32 v15, v15
    v_exp_f32 v16, v16
    v_exp_f32 v17, v17
    ds_read_b128 v[44:47], v0 offset:52736
    s_waitcnt lgkmcnt(15)
    v_mfma_f32_16x16x32_bf16 a[72:75], v[144:147], a[64:67], a[72:75]
    v_exp_f32 v18, v18
    v_exp_f32 v19, v19
    v_exp_f32 v20, v20
    v_exp_f32 v21, v21
    v_exp_f32 v22, v22
    v_mfma_f32_16x16x32_bf16 a[76:79], v[144:147], a[68:71], a[76:79]
    v_exp_f32 v23, v23
    v_exp_f32 v24, v24
    v_exp_f32 v25, v25
    v_add_f32 v28, v28, v10
    v_add_f32 v28, v28, v11
    ds_read_b128 v[48:51], v0 offset:53760
    s_waitcnt lgkmcnt(15)
    v_mfma_f32_16x16x32_bf16 a[88:91], v[148:151], a[64:67], a[88:91]
    v_add_f32 v28, v28, v12
    v_add_f32 v28, v28, v13
    v_add_f32 v28, v28, v14
    v_add_f32 v28, v28, v15
    v_add_f32 v28, v28, v16
    v_mfma_f32_16x16x32_bf16 a[92:95], v[148:151], a[68:71], a[92:95]
    v_add_f32 v28, v28, v17
    v_add_f32 v29, v29, v18
    v_add_f32 v29, v29, v19
    v_add_f32 v29, v29, v20
    v_add_f32 v29, v29, v21
    ds_read_b128 v[52:55], v0 offset:54784
    s_waitcnt lgkmcnt(15)
    v_mfma_f32_16x16x32_bf16 a[104:107], v[152:155], a[64:67], a[104:107]
    v_add_f32 v29, v29, v22
    v_add_f32 v29, v29, v23
    v_add_f32 v29, v29, v24
    v_add_f32 v29, v29, v25
    v_cvt_pk_bf16_f32 v10, v10, v11
    v_mfma_f32_16x16x32_bf16 a[108:111], v[152:155], a[68:71], a[108:111]
    v_cvt_pk_bf16_f32 v12, v12, v13
    v_cvt_pk_bf16_f32 v14, v14, v15
    v_cvt_pk_bf16_f32 v16, v16, v17
    v_cvt_pk_bf16_f32 v18, v18, v19
    v_cvt_pk_bf16_f32 v20, v20, v21
    ds_read_b128 v[56:59], v0 offset:55808
    s_waitcnt lgkmcnt(15)
    v_mfma_f32_16x16x32_bf16 a[120:123], v[156:159], a[64:67], a[120:123]
    v_cvt_pk_bf16_f32 v22, v22, v23
    v_cvt_pk_bf16_f32 v24, v24, v25
    v_accvgpr_write_b32 a192, v10
    v_accvgpr_write_b32 a193, v12
    v_accvgpr_write_b32 a194, v14
    v_mfma_f32_16x16x32_bf16 a[124:127], v[156:159], a[68:71], a[124:127]
    v_accvgpr_write_b32 a195, v16
    v_accvgpr_write_b32 a196, v18
    v_accvgpr_write_b32 a197, v20
    v_accvgpr_write_b32 a198, v22
    v_accvgpr_write_b32 a199, v24
    ds_read_b128 v[60:63], v0 offset:56832
    s_waitcnt lgkmcnt(15)
    v_mfma_f32_16x16x32_bf16 a[8:11], v[160:163], a[80:83], a[8:11]
    v_accvgpr_read_b32 v10, a208
    v_accvgpr_read_b32 v11, a209
    v_accvgpr_read_b32 v12, a210
    v_accvgpr_read_b32 v13, a211
    v_accvgpr_read_b32 v14, a216
    v_mfma_f32_16x16x32_bf16 a[12:15], v[160:163], a[84:87], a[12:15]
    v_accvgpr_read_b32 v15, a217
    v_accvgpr_read_b32 v16, a218
    v_accvgpr_read_b32 v17, a219
    v_accvgpr_read_b32 v18, a212
    v_accvgpr_read_b32 v19, a213
    ds_read_b128 v[128:131], v0 offset:57856
    s_waitcnt lgkmcnt(15)
    v_mfma_f32_16x16x32_bf16 a[24:27], v[164:167], a[80:83], a[24:27]
    v_accvgpr_read_b32 v20, a214
    v_accvgpr_read_b32 v21, a215
    v_accvgpr_read_b32 v22, a220
    v_accvgpr_read_b32 v23, a221
    v_accvgpr_read_b32 v24, a222
    v_mfma_f32_16x16x32_bf16 a[28:31], v[164:167], a[84:87], a[28:31]
    v_accvgpr_read_b32 v25, a223
    v_fma_f32 v10, v10, s96, -v26
    v_fma_f32 v11, v11, s96, -v26
    v_fma_f32 v12, v12, s96, -v26
    v_fma_f32 v13, v13, s96, -v26
    ds_read_b128 v[132:135], v0 offset:58880
    s_waitcnt lgkmcnt(15)
    v_mfma_f32_16x16x32_bf16 a[40:43], v[168:171], a[80:83], a[40:43]
    v_fma_f32 v14, v14, s96, -v26
    v_fma_f32 v15, v15, s96, -v26
    v_fma_f32 v16, v16, s96, -v26
    v_fma_f32 v17, v17, s96, -v26
    v_fma_f32 v18, v18, s96, -v27
    v_mfma_f32_16x16x32_bf16 a[44:47], v[168:171], a[84:87], a[44:47]
    v_fma_f32 v19, v19, s96, -v27
    v_fma_f32 v20, v20, s96, -v27
    v_fma_f32 v21, v21, s96, -v27
    v_fma_f32 v22, v22, s96, -v27
    v_fma_f32 v23, v23, s96, -v27
    ds_read_b128 v[136:139], v0 offset:59904
    s_waitcnt lgkmcnt(15)
    v_mfma_f32_16x16x32_bf16 a[56:59], v[172:175], a[80:83], a[56:59]
    v_fma_f32 v24, v24, s96, -v27
    v_fma_f32 v25, v25, s96, -v27
    v_exp_f32 v10, v10
    v_exp_f32 v11, v11
    v_exp_f32 v12, v12
    v_mfma_f32_16x16x32_bf16 a[60:63], v[172:175], a[84:87], a[60:63]
    v_exp_f32 v13, v13
    v_exp_f32 v14, v14
    v_exp_f32 v15, v15
    v_exp_f32 v16, v16
    v_exp_f32 v17, v17
    ds_read_b128 v[140:143], v0 offset:60928
    s_waitcnt lgkmcnt(15)
    v_mfma_f32_16x16x32_bf16 a[72:75], v[176:179], a[80:83], a[72:75]
    v_exp_f32 v18, v18
    v_exp_f32 v19, v19
    v_exp_f32 v20, v20
    v_exp_f32 v21, v21
    v_exp_f32 v22, v22
    v_mfma_f32_16x16x32_bf16 a[76:79], v[176:179], a[84:87], a[76:79]
    v_exp_f32 v23, v23
    v_exp_f32 v24, v24
    v_exp_f32 v25, v25
    v_add_f32 v28, v28, v10
    v_add_f32 v28, v28, v11
    ds_read_b128 v[144:147], v0 offset:61952
    s_waitcnt lgkmcnt(15)
    v_mfma_f32_16x16x32_bf16 a[88:91], v[180:183], a[80:83], a[88:91]
    v_add_f32 v28, v28, v12
    v_add_f32 v28, v28, v13
    v_add_f32 v28, v28, v14
    v_add_f32 v28, v28, v15
    v_add_f32 v28, v28, v16
    v_mfma_f32_16x16x32_bf16 a[92:95], v[180:183], a[84:87], a[92:95]
    v_add_f32 v28, v28, v17
    v_add_f32 v29, v29, v18
    v_add_f32 v29, v29, v19
    v_add_f32 v29, v29, v20
    v_add_f32 v29, v29, v21
    ds_read_b128 v[148:151], v0 offset:62976
    s_waitcnt lgkmcnt(15)
    v_mfma_f32_16x16x32_bf16 a[104:107], v[184:187], a[80:83], a[104:107]
    v_add_f32 v29, v29, v22
    v_add_f32 v29, v29, v23
    v_add_f32 v29, v29, v24
    v_add_f32 v29, v29, v25
    v_cvt_pk_bf16_f32 v10, v10, v11
    v_mfma_f32_16x16x32_bf16 a[108:111], v[184:187], a[84:87], a[108:111]
    v_cvt_pk_bf16_f32 v12, v12, v13
    v_cvt_pk_bf16_f32 v14, v14, v15
    v_cvt_pk_bf16_f32 v16, v16, v17
    v_cvt_pk_bf16_f32 v18, v18, v19
    v_cvt_pk_bf16_f32 v20, v20, v21
    ds_read_b128 v[152:155], v0 offset:64000
    s_waitcnt lgkmcnt(15)
    v_mfma_f32_16x16x32_bf16 a[120:123], v[188:191], a[80:83], a[120:123]
    v_cvt_pk_bf16_f32 v22, v22, v23
    v_cvt_pk_bf16_f32 v24, v24, v25
    v_accvgpr_write_b32 a208, v10
    v_accvgpr_write_b32 a209, v12
    v_accvgpr_write_b32 a210, v14
    v_mfma_f32_16x16x32_bf16 a[124:127], v[188:191], a[84:87], a[124:127]
    v_accvgpr_write_b32 a211, v16
    v_accvgpr_write_b32 a212, v18
    v_accvgpr_write_b32 a213, v20
    v_accvgpr_write_b32 a214, v22
    v_accvgpr_write_b32 a215, v24
    ds_read_b128 v[156:159], v0 offset:65024
    s_waitcnt lgkmcnt(15)
    v_mfma_f32_16x16x32_bf16 a[8:11], v[32:35], a[96:99], a[8:11]
    v_accvgpr_read_b32 v10, a224
    v_accvgpr_read_b32 v11, a225
    v_accvgpr_read_b32 v12, a226
    v_accvgpr_read_b32 v13, a227
    v_accvgpr_read_b32 v14, a232
    v_mfma_f32_16x16x32_bf16 a[12:15], v[32:35], a[100:103], a[12:15]
    v_accvgpr_read_b32 v15, a233
    v_accvgpr_read_b32 v16, a234
    v_accvgpr_read_b32 v17, a235
    v_accvgpr_read_b32 v18, a228
    v_accvgpr_read_b32 v19, a229
    ds_read_b128 v[160:163], v6 offset:1024
    s_waitcnt lgkmcnt(15)
    v_mfma_f32_16x16x32_bf16 a[24:27], v[36:39], a[96:99], a[24:27]
    v_accvgpr_read_b32 v20, a230
    v_accvgpr_read_b32 v21, a231
    v_accvgpr_read_b32 v22, a236
    v_accvgpr_read_b32 v23, a237
    v_accvgpr_read_b32 v24, a238
    v_mfma_f32_16x16x32_bf16 a[28:31], v[36:39], a[100:103], a[28:31]
    v_accvgpr_read_b32 v25, a239
    v_fma_f32 v10, v10, s96, -v26
    v_fma_f32 v11, v11, s96, -v26
    v_fma_f32 v12, v12, s96, -v26
    v_fma_f32 v13, v13, s96, -v26
    ds_read_b128 v[164:167], v6 offset:2048
    s_waitcnt lgkmcnt(15)
    v_mfma_f32_16x16x32_bf16 a[40:43], v[40:43], a[96:99], a[40:43]
    v_fma_f32 v14, v14, s96, -v26
    v_fma_f32 v15, v15, s96, -v26
    v_fma_f32 v16, v16, s96, -v26
    v_fma_f32 v17, v17, s96, -v26
    v_fma_f32 v18, v18, s96, -v27
    v_mfma_f32_16x16x32_bf16 a[44:47], v[40:43], a[100:103], a[44:47]
    v_fma_f32 v19, v19, s96, -v27
    v_fma_f32 v20, v20, s96, -v27
    v_fma_f32 v21, v21, s96, -v27
    v_fma_f32 v22, v22, s96, -v27
    v_fma_f32 v23, v23, s96, -v27
    ds_read_b128 v[168:171], v6 offset:3072
    s_waitcnt lgkmcnt(15)
    v_mfma_f32_16x16x32_bf16 a[56:59], v[44:47], a[96:99], a[56:59]
    v_fma_f32 v24, v24, s96, -v27
    v_fma_f32 v25, v25, s96, -v27
    v_exp_f32 v10, v10
    v_exp_f32 v11, v11
    v_exp_f32 v12, v12
    v_mfma_f32_16x16x32_bf16 a[60:63], v[44:47], a[100:103], a[60:63]
    v_exp_f32 v13, v13
    v_exp_f32 v14, v14
    v_exp_f32 v15, v15
    v_exp_f32 v16, v16
    v_exp_f32 v17, v17
    ds_read_b128 v[172:175], v6 offset:4096
    s_waitcnt lgkmcnt(15)
    v_mfma_f32_16x16x32_bf16 a[72:75], v[48:51], a[96:99], a[72:75]
    v_exp_f32 v18, v18
    v_exp_f32 v19, v19
    v_exp_f32 v20, v20
    v_exp_f32 v21, v21
    v_exp_f32 v22, v22
    v_mfma_f32_16x16x32_bf16 a[76:79], v[48:51], a[100:103], a[76:79]
    v_exp_f32 v23, v23
    v_exp_f32 v24, v24
    v_exp_f32 v25, v25
    v_add_f32 v28, v28, v10
    v_add_f32 v28, v28, v11
    ds_read_b128 v[176:179], v6 offset:5120
    s_waitcnt lgkmcnt(15)
    v_mfma_f32_16x16x32_bf16 a[88:91], v[52:55], a[96:99], a[88:91]
    v_add_f32 v28, v28, v12
    v_add_f32 v28, v28, v13
    v_add_f32 v28, v28, v14
    v_add_f32 v28, v28, v15
    v_add_f32 v28, v28, v16
    v_mfma_f32_16x16x32_bf16 a[92:95], v[52:55], a[100:103], a[92:95]
    v_add_f32 v28, v28, v17
    v_add_f32 v29, v29, v18
    v_add_f32 v29, v29, v19
    v_add_f32 v29, v29, v20
    v_add_f32 v29, v29, v21
    ds_read_b128 v[180:183], v6 offset:6144
    s_waitcnt lgkmcnt(15)
    v_mfma_f32_16x16x32_bf16 a[104:107], v[56:59], a[96:99], a[104:107]
    v_add_f32 v29, v29, v22
    v_add_f32 v29, v29, v23
    v_add_f32 v29, v29, v24
    v_add_f32 v29, v29, v25
    v_cvt_pk_bf16_f32 v10, v10, v11
    v_mfma_f32_16x16x32_bf16 a[108:111], v[56:59], a[100:103], a[108:111]
    v_cvt_pk_bf16_f32 v12, v12, v13
    v_cvt_pk_bf16_f32 v14, v14, v15
    v_cvt_pk_bf16_f32 v16, v16, v17
    v_cvt_pk_bf16_f32 v18, v18, v19
    v_cvt_pk_bf16_f32 v20, v20, v21
    ds_read_b128 v[184:187], v6 offset:7168
    s_waitcnt lgkmcnt(15)
    v_mfma_f32_16x16x32_bf16 a[120:123], v[60:63], a[96:99], a[120:123]
    v_cvt_pk_bf16_f32 v22, v22, v23
    v_cvt_pk_bf16_f32 v24, v24, v25
    v_accvgpr_write_b32 a224, v10
    v_accvgpr_write_b32 a225, v12
    v_accvgpr_write_b32 a226, v14
    v_mfma_f32_16x16x32_bf16 a[124:127], v[60:63], a[100:103], a[124:127]
    v_accvgpr_write_b32 a227, v16
    v_accvgpr_write_b32 a228, v18
    v_accvgpr_write_b32 a229, v20
    v_accvgpr_write_b32 a230, v22
    v_accvgpr_write_b32 a231, v24
    ds_read_b128 v[188:191], v6 offset:8192
    s_waitcnt lgkmcnt(15)
    v_mfma_f32_16x16x32_bf16 a[8:11], v[128:131], a[112:115], a[8:11]
    v_accvgpr_read_b32 v10, a240
    v_accvgpr_read_b32 v11, a241
    v_accvgpr_read_b32 v12, a242
    v_accvgpr_read_b32 v13, a243
    v_accvgpr_read_b32 v14, a248
    v_mfma_f32_16x16x32_bf16 a[12:15], v[128:131], a[116:119], a[12:15]
    v_accvgpr_read_b32 v15, a249
    v_accvgpr_read_b32 v16, a250
    v_accvgpr_read_b32 v17, a251
    v_accvgpr_read_b32 v18, a244
    v_accvgpr_read_b32 v19, a245
    ds_read_b128 v[32:35], v6 offset:9216
    s_waitcnt lgkmcnt(15)
    v_mfma_f32_16x16x32_bf16 a[24:27], v[132:135], a[112:115], a[24:27]
    v_accvgpr_read_b32 v20, a246
    v_accvgpr_read_b32 v21, a247
    v_accvgpr_read_b32 v22, a252
    v_accvgpr_read_b32 v23, a253
    v_accvgpr_read_b32 v24, a254
    v_mfma_f32_16x16x32_bf16 a[28:31], v[132:135], a[116:119], a[28:31]
    v_accvgpr_read_b32 v25, a255
    v_fma_f32 v10, v10, s96, -v26
    v_fma_f32 v11, v11, s96, -v26
    v_fma_f32 v12, v12, s96, -v26
    v_fma_f32 v13, v13, s96, -v26
    ds_read_b128 v[36:39], v6 offset:10240
    s_waitcnt lgkmcnt(15)
    v_mfma_f32_16x16x32_bf16 a[40:43], v[136:139], a[112:115], a[40:43]
    v_fma_f32 v14, v14, s96, -v26
    v_fma_f32 v15, v15, s96, -v26
    v_fma_f32 v16, v16, s96, -v26
    v_fma_f32 v17, v17, s96, -v26
    v_fma_f32 v18, v18, s96, -v27
    v_mfma_f32_16x16x32_bf16 a[44:47], v[136:139], a[116:119], a[44:47]
    v_fma_f32 v19, v19, s96, -v27
    v_fma_f32 v20, v20, s96, -v27
    v_fma_f32 v21, v21, s96, -v27
    v_fma_f32 v22, v22, s96, -v27
    v_fma_f32 v23, v23, s96, -v27
    ds_read_b128 v[40:43], v6 offset:11264
    s_waitcnt lgkmcnt(15)
    v_mfma_f32_16x16x32_bf16 a[56:59], v[140:143], a[112:115], a[56:59]
    v_fma_f32 v24, v24, s96, -v27
    v_fma_f32 v25, v25, s96, -v27
    v_exp_f32 v10, v10
    v_exp_f32 v11, v11
    v_exp_f32 v12, v12
    v_mfma_f32_16x16x32_bf16 a[60:63], v[140:143], a[116:119], a[60:63]
    v_exp_f32 v13, v13
    v_exp_f32 v14, v14
    v_exp_f32 v15, v15
    v_exp_f32 v16, v16
    v_exp_f32 v17, v17
    ds_read_b128 v[44:47], v6 offset:12288
    s_waitcnt lgkmcnt(15)
    v_mfma_f32_16x16x32_bf16 a[72:75], v[144:147], a[112:115], a[72:75]
    v_exp_f32 v18, v18
    v_exp_f32 v19, v19
    v_exp_f32 v20, v20
    v_exp_f32 v21, v21
    v_exp_f32 v22, v22
    v_mfma_f32_16x16x32_bf16 a[76:79], v[144:147], a[116:119], a[76:79]
    v_exp_f32 v23, v23
    v_exp_f32 v24, v24
    v_exp_f32 v25, v25
    v_add_f32 v28, v28, v10
    v_add_f32 v28, v28, v11
    ds_read_b128 v[48:51], v6 offset:13312
    s_waitcnt lgkmcnt(15)
    v_mfma_f32_16x16x32_bf16 a[88:91], v[148:151], a[112:115], a[88:91]
    v_add_f32 v28, v28, v12
    v_add_f32 v28, v28, v13
    v_add_f32 v28, v28, v14
    v_add_f32 v28, v28, v15
    v_add_f32 v28, v28, v16
    v_mfma_f32_16x16x32_bf16 a[92:95], v[148:151], a[116:119], a[92:95]
    v_add_f32 v28, v28, v17
    v_add_f32 v29, v29, v18
    v_add_f32 v29, v29, v19
    v_add_f32 v29, v29, v20
    v_add_f32 v29, v29, v21
    ds_read_b128 v[52:55], v6 offset:14336
    s_waitcnt lgkmcnt(15)
    v_mfma_f32_16x16x32_bf16 a[104:107], v[152:155], a[112:115], a[104:107]
    v_add_f32 v29, v29, v22
    v_add_f32 v29, v29, v23
    v_add_f32 v29, v29, v24
    v_add_f32 v29, v29, v25
    v_cvt_pk_bf16_f32 v10, v10, v11
    v_mfma_f32_16x16x32_bf16 a[108:111], v[152:155], a[116:119], a[108:111]
    v_cvt_pk_bf16_f32 v12, v12, v13
    v_cvt_pk_bf16_f32 v14, v14, v15
    v_cvt_pk_bf16_f32 v16, v16, v17
    v_cvt_pk_bf16_f32 v18, v18, v19
    v_cvt_pk_bf16_f32 v20, v20, v21
    ds_read_b128 v[56:59], v6 offset:15360
    s_waitcnt lgkmcnt(15)
    v_mfma_f32_16x16x32_bf16 a[120:123], v[156:159], a[112:115], a[120:123]
    v_cvt_pk_bf16_f32 v22, v22, v23
    v_cvt_pk_bf16_f32 v24, v24, v25
    v_accvgpr_write_b32 a240, v10
    v_accvgpr_write_b32 a241, v12
    v_accvgpr_write_b32 a242, v14
    v_mfma_f32_16x16x32_bf16 a[124:127], v[156:159], a[116:119], a[124:127]
    v_accvgpr_write_b32 a243, v16
    v_accvgpr_write_b32 a244, v18
    v_accvgpr_write_b32 a245, v20
    v_accvgpr_write_b32 a246, v22
    v_accvgpr_write_b32 a247, v24
    ds_read_b128 v[60:63], v6 offset:16384
    s_waitcnt lgkmcnt(15)
    v_mfma_f32_16x16x32_bf16 a[8:11], v[160:163], a[128:131], a[8:11]
    v_mfma_f32_16x16x32_bf16 a[12:15], v[160:163], a[132:135], a[12:15]
    ds_read_b128 v[128:131], v6 offset:17408
    s_waitcnt lgkmcnt(15)
    v_mfma_f32_16x16x32_bf16 a[24:27], v[164:167], a[128:131], a[24:27]
    v_mfma_f32_16x16x32_bf16 a[28:31], v[164:167], a[132:135], a[28:31]
    ds_read_b128 v[132:135], v6 offset:18432
    s_waitcnt lgkmcnt(15)
    v_mfma_f32_16x16x32_bf16 a[40:43], v[168:171], a[128:131], a[40:43]
    v_mfma_f32_16x16x32_bf16 a[44:47], v[168:171], a[132:135], a[44:47]
    ds_read_b128 v[136:139], v6 offset:19456
    s_waitcnt lgkmcnt(15)
    v_mfma_f32_16x16x32_bf16 a[56:59], v[172:175], a[128:131], a[56:59]
    v_mfma_f32_16x16x32_bf16 a[60:63], v[172:175], a[132:135], a[60:63]
    ds_read_b128 v[140:143], v6 offset:20480
    s_waitcnt lgkmcnt(15)
    v_mfma_f32_16x16x32_bf16 a[72:75], v[176:179], a[128:131], a[72:75]
    v_mfma_f32_16x16x32_bf16 a[76:79], v[176:179], a[132:135], a[76:79]
    ds_read_b128 v[144:147], v6 offset:21504
    s_waitcnt lgkmcnt(15)
    v_mfma_f32_16x16x32_bf16 a[88:91], v[180:183], a[128:131], a[88:91]
    v_mfma_f32_16x16x32_bf16 a[92:95], v[180:183], a[132:135], a[92:95]
    ds_read_b128 v[148:151], v6 offset:22528
    s_waitcnt lgkmcnt(15)
    v_mfma_f32_16x16x32_bf16 a[104:107], v[184:187], a[128:131], a[104:107]
    v_mfma_f32_16x16x32_bf16 a[108:111], v[184:187], a[132:135], a[108:111]
    ds_read_b128 v[152:155], v6 offset:23552
    s_waitcnt lgkmcnt(15)
    v_mfma_f32_16x16x32_bf16 a[120:123], v[188:191], a[128:131], a[120:123]
    v_mfma_f32_16x16x32_bf16 a[124:127], v[188:191], a[132:135], a[124:127]
    ds_read_b128 v[156:159], v6 offset:24576
    s_waitcnt lgkmcnt(15)
    v_mfma_f32_16x16x32_bf16 a[8:11], v[32:35], a[144:147], a[8:11]
    v_mfma_f32_16x16x32_bf16 a[12:15], v[32:35], a[148:151], a[12:15]
    ds_read_b128 v[160:163], v6 offset:25600
    s_waitcnt lgkmcnt(15)
    v_mfma_f32_16x16x32_bf16 a[24:27], v[36:39], a[144:147], a[24:27]
    v_mfma_f32_16x16x32_bf16 a[28:31], v[36:39], a[148:151], a[28:31]
    ds_read_b128 v[164:167], v6 offset:26624
    s_waitcnt lgkmcnt(15)
    v_mfma_f32_16x16x32_bf16 a[40:43], v[40:43], a[144:147], a[40:43]
    v_mfma_f32_16x16x32_bf16 a[44:47], v[40:43], a[148:151], a[44:47]
    ds_read_b128 v[168:171], v6 offset:27648
    s_waitcnt lgkmcnt(15)
    v_mfma_f32_16x16x32_bf16 a[56:59], v[44:47], a[144:147], a[56:59]
    v_mfma_f32_16x16x32_bf16 a[60:63], v[44:47], a[148:151], a[60:63]
    ds_read_b128 v[172:175], v6 offset:28672
    s_waitcnt lgkmcnt(15)
    v_mfma_f32_16x16x32_bf16 a[72:75], v[48:51], a[144:147], a[72:75]
    v_mfma_f32_16x16x32_bf16 a[76:79], v[48:51], a[148:151], a[76:79]
    ds_read_b128 v[176:179], v6 offset:29696
    s_waitcnt lgkmcnt(15)
    v_mfma_f32_16x16x32_bf16 a[88:91], v[52:55], a[144:147], a[88:91]
    v_mfma_f32_16x16x32_bf16 a[92:95], v[52:55], a[148:151], a[92:95]
    ds_read_b128 v[180:183], v6 offset:30720
    s_waitcnt lgkmcnt(15)
    v_mfma_f32_16x16x32_bf16 a[104:107], v[56:59], a[144:147], a[104:107]
    v_mfma_f32_16x16x32_bf16 a[108:111], v[56:59], a[148:151], a[108:111]
    ds_read_b128 v[184:187], v6 offset:31744
    s_waitcnt lgkmcnt(15)
    v_mfma_f32_16x16x32_bf16 a[120:123], v[60:63], a[144:147], a[120:123]
    v_mfma_f32_16x16x32_bf16 a[124:127], v[60:63], a[148:151], a[124:127]
    ds_read_b128 v[188:191], v6 offset:32768
    s_waitcnt lgkmcnt(15)
    v_mfma_f32_16x16x32_bf16 a[8:11], v[128:131], a[160:163], a[8:11]
    v_mfma_f32_16x16x32_bf16 a[12:15], v[128:131], a[164:167], a[12:15]
    ds_read_b128 v[32:35], v6 offset:34304
    s_waitcnt lgkmcnt(15)
    v_mfma_f32_16x16x32_bf16 a[24:27], v[132:135], a[160:163], a[24:27]
    v_mfma_f32_16x16x32_bf16 a[28:31], v[132:135], a[164:167], a[28:31]
    ds_read_b128 v[36:39], v6 offset:35328
    s_waitcnt lgkmcnt(15)
    v_mfma_f32_16x16x32_bf16 a[40:43], v[136:139], a[160:163], a[40:43]
    v_mfma_f32_16x16x32_bf16 a[44:47], v[136:139], a[164:167], a[44:47]
    ds_read_b128 v[40:43], v6 offset:36352
    s_waitcnt lgkmcnt(15)
    v_mfma_f32_16x16x32_bf16 a[56:59], v[140:143], a[160:163], a[56:59]
    v_mfma_f32_16x16x32_bf16 a[60:63], v[140:143], a[164:167], a[60:63]
    ds_read_b128 v[44:47], v6 offset:37376
    s_waitcnt lgkmcnt(15)
    v_mfma_f32_16x16x32_bf16 a[72:75], v[144:147], a[160:163], a[72:75]
    v_mfma_f32_16x16x32_bf16 a[76:79], v[144:147], a[164:167], a[76:79]
    ds_read_b128 v[48:51], v6 offset:38400
    s_waitcnt lgkmcnt(15)
    v_mfma_f32_16x16x32_bf16 a[88:91], v[148:151], a[160:163], a[88:91]
    v_mfma_f32_16x16x32_bf16 a[92:95], v[148:151], a[164:167], a[92:95]
    ds_read_b128 v[52:55], v6 offset:39424
    s_waitcnt lgkmcnt(15)
    v_mfma_f32_16x16x32_bf16 a[104:107], v[152:155], a[160:163], a[104:107]
    v_mfma_f32_16x16x32_bf16 a[108:111], v[152:155], a[164:167], a[108:111]
    ds_read_b128 v[56:59], v6 offset:40448
    s_waitcnt lgkmcnt(15)
    v_mfma_f32_16x16x32_bf16 a[120:123], v[156:159], a[160:163], a[120:123]
    v_mfma_f32_16x16x32_bf16 a[124:127], v[156:159], a[164:167], a[124:127]
    ds_read_b128 v[60:63], v6 offset:41472
    s_waitcnt lgkmcnt(15)
    v_mfma_f32_16x16x32_bf16 a[8:11], v[160:163], a[176:179], a[8:11]
    v_mfma_f32_16x16x32_bf16 a[12:15], v[160:163], a[180:183], a[12:15]
    ds_read_b128 v[128:131], v6 offset:42496
    s_waitcnt lgkmcnt(15)
    v_mfma_f32_16x16x32_bf16 a[24:27], v[164:167], a[176:179], a[24:27]
    v_mfma_f32_16x16x32_bf16 a[28:31], v[164:167], a[180:183], a[28:31]
    ds_read_b128 v[132:135], v6 offset:43520
    s_waitcnt lgkmcnt(15)
    v_mfma_f32_16x16x32_bf16 a[40:43], v[168:171], a[176:179], a[40:43]
    v_mfma_f32_16x16x32_bf16 a[44:47], v[168:171], a[180:183], a[44:47]
    ds_read_b128 v[136:139], v6 offset:44544
    s_waitcnt lgkmcnt(15)
    v_mfma_f32_16x16x32_bf16 a[56:59], v[172:175], a[176:179], a[56:59]
    v_mfma_f32_16x16x32_bf16 a[60:63], v[172:175], a[180:183], a[60:63]
    ds_read_b128 v[140:143], v6 offset:45568
    s_waitcnt lgkmcnt(15)
    v_mfma_f32_16x16x32_bf16 a[72:75], v[176:179], a[176:179], a[72:75]
    v_mfma_f32_16x16x32_bf16 a[76:79], v[176:179], a[180:183], a[76:79]
    ds_read_b128 v[144:147], v6 offset:46592
    s_waitcnt lgkmcnt(15)
    v_mfma_f32_16x16x32_bf16 a[88:91], v[180:183], a[176:179], a[88:91]
    v_mfma_f32_16x16x32_bf16 a[92:95], v[180:183], a[180:183], a[92:95]
    ds_read_b128 v[148:151], v6 offset:47616
    s_waitcnt lgkmcnt(15)
    v_mfma_f32_16x16x32_bf16 a[104:107], v[184:187], a[176:179], a[104:107]
    v_mfma_f32_16x16x32_bf16 a[108:111], v[184:187], a[180:183], a[108:111]
    ds_read_b128 v[152:155], v6 offset:48640
    s_waitcnt lgkmcnt(15)
    v_mfma_f32_16x16x32_bf16 a[120:123], v[188:191], a[176:179], a[120:123]
    v_mfma_f32_16x16x32_bf16 a[124:127], v[188:191], a[180:183], a[124:127]
    ds_read_b128 v[156:159], v6 offset:49664
    s_waitcnt lgkmcnt(15)
    v_mfma_f32_16x16x32_bf16 a[8:11], v[32:35], a[192:195], a[8:11]
    v_mfma_f32_16x16x32_bf16 a[12:15], v[32:35], a[196:199], a[12:15]
    ds_read_b128 v[160:163], v6 offset:50688
    s_waitcnt lgkmcnt(15)
    v_mfma_f32_16x16x32_bf16 a[24:27], v[36:39], a[192:195], a[24:27]
    v_mfma_f32_16x16x32_bf16 a[28:31], v[36:39], a[196:199], a[28:31]
    ds_read_b128 v[164:167], v6 offset:51712
    s_waitcnt lgkmcnt(15)
    v_mfma_f32_16x16x32_bf16 a[40:43], v[40:43], a[192:195], a[40:43]
    v_mfma_f32_16x16x32_bf16 a[44:47], v[40:43], a[196:199], a[44:47]
    ds_read_b128 v[168:171], v6 offset:52736
    s_waitcnt lgkmcnt(15)
    v_mfma_f32_16x16x32_bf16 a[56:59], v[44:47], a[192:195], a[56:59]
    v_mfma_f32_16x16x32_bf16 a[60:63], v[44:47], a[196:199], a[60:63]
    ds_read_b128 v[172:175], v6 offset:53760
    s_waitcnt lgkmcnt(15)
    v_mfma_f32_16x16x32_bf16 a[72:75], v[48:51], a[192:195], a[72:75]
    v_mfma_f32_16x16x32_bf16 a[76:79], v[48:51], a[196:199], a[76:79]
    ds_read_b128 v[176:179], v6 offset:54784
    s_waitcnt lgkmcnt(15)
    v_mfma_f32_16x16x32_bf16 a[88:91], v[52:55], a[192:195], a[88:91]
    v_mfma_f32_16x16x32_bf16 a[92:95], v[52:55], a[196:199], a[92:95]
    ds_read_b128 v[180:183], v6 offset:55808
    s_waitcnt lgkmcnt(15)
    v_mfma_f32_16x16x32_bf16 a[104:107], v[56:59], a[192:195], a[104:107]
    v_mfma_f32_16x16x32_bf16 a[108:111], v[56:59], a[196:199], a[108:111]
    ds_read_b128 v[184:187], v6 offset:56832
    s_waitcnt lgkmcnt(15)
    v_mfma_f32_16x16x32_bf16 a[120:123], v[60:63], a[192:195], a[120:123]
    v_mfma_f32_16x16x32_bf16 a[124:127], v[60:63], a[196:199], a[124:127]
    ds_read_b128 v[188:191], v6 offset:57856
    s_waitcnt lgkmcnt(15)
    v_mfma_f32_16x16x32_bf16 a[8:11], v[128:131], a[208:211], a[8:11]
    v_mfma_f32_16x16x32_bf16 a[12:15], v[128:131], a[212:215], a[12:15]
    ds_read_b128 v[32:35], v6 offset:58880
    s_waitcnt lgkmcnt(15)
    v_mfma_f32_16x16x32_bf16 a[24:27], v[132:135], a[208:211], a[24:27]
    v_mfma_f32_16x16x32_bf16 a[28:31], v[132:135], a[212:215], a[28:31]
    ds_read_b128 v[36:39], v6 offset:59904
    s_waitcnt lgkmcnt(15)
    v_mfma_f32_16x16x32_bf16 a[40:43], v[136:139], a[208:211], a[40:43]
    v_mfma_f32_16x16x32_bf16 a[44:47], v[136:139], a[212:215], a[44:47]
    ds_read_b128 v[40:43], v6 offset:60928
    s_waitcnt lgkmcnt(15)
    v_mfma_f32_16x16x32_bf16 a[56:59], v[140:143], a[208:211], a[56:59]
    v_mfma_f32_16x16x32_bf16 a[60:63], v[140:143], a[212:215], a[60:63]
    ds_read_b128 v[44:47], v6 offset:61952
    s_waitcnt lgkmcnt(15)
    v_mfma_f32_16x16x32_bf16 a[72:75], v[144:147], a[208:211], a[72:75]
    v_mfma_f32_16x16x32_bf16 a[76:79], v[144:147], a[212:215], a[76:79]
    ds_read_b128 v[48:51], v6 offset:62976
    s_waitcnt lgkmcnt(15)
    v_mfma_f32_16x16x32_bf16 a[88:91], v[148:151], a[208:211], a[88:91]
    v_mfma_f32_16x16x32_bf16 a[92:95], v[148:151], a[212:215], a[92:95]
    ds_read_b128 v[52:55], v6 offset:64000
    s_waitcnt lgkmcnt(15)
    v_mfma_f32_16x16x32_bf16 a[104:107], v[152:155], a[208:211], a[104:107]
    v_mfma_f32_16x16x32_bf16 a[108:111], v[152:155], a[212:215], a[108:111]
    ds_read_b128 v[56:59], v6 offset:65024
    s_waitcnt lgkmcnt(15)
    v_mfma_f32_16x16x32_bf16 a[120:123], v[156:159], a[208:211], a[120:123]
    v_mfma_f32_16x16x32_bf16 a[124:127], v[156:159], a[212:215], a[124:127]
    ds_read_b128 v[60:63], v7 offset:512
    s_waitcnt lgkmcnt(15)
    v_mfma_f32_16x16x32_bf16 a[8:11], v[160:163], a[224:227], a[8:11]
    v_mfma_f32_16x16x32_bf16 a[12:15], v[160:163], a[228:231], a[12:15]
    s_waitcnt lgkmcnt(14)
    v_mfma_f32_16x16x32_bf16 a[24:27], v[164:167], a[224:227], a[24:27]
    v_mfma_f32_16x16x32_bf16 a[28:31], v[164:167], a[228:231], a[28:31]
    s_waitcnt lgkmcnt(13)
    v_mfma_f32_16x16x32_bf16 a[40:43], v[168:171], a[224:227], a[40:43]
    v_mfma_f32_16x16x32_bf16 a[44:47], v[168:171], a[228:231], a[44:47]
    s_waitcnt lgkmcnt(12)
    v_mfma_f32_16x16x32_bf16 a[56:59], v[172:175], a[224:227], a[56:59]
    v_mfma_f32_16x16x32_bf16 a[60:63], v[172:175], a[228:231], a[60:63]
    s_waitcnt lgkmcnt(11)
    v_mfma_f32_16x16x32_bf16 a[72:75], v[176:179], a[224:227], a[72:75]
    v_mfma_f32_16x16x32_bf16 a[76:79], v[176:179], a[228:231], a[76:79]
    s_waitcnt lgkmcnt(10)
    v_mfma_f32_16x16x32_bf16 a[88:91], v[180:183], a[224:227], a[88:91]
    v_mfma_f32_16x16x32_bf16 a[92:95], v[180:183], a[228:231], a[92:95]
    s_waitcnt lgkmcnt(9)
    v_mfma_f32_16x16x32_bf16 a[104:107], v[184:187], a[224:227], a[104:107]
    v_mfma_f32_16x16x32_bf16 a[108:111], v[184:187], a[228:231], a[108:111]
    s_waitcnt lgkmcnt(8)
    v_mfma_f32_16x16x32_bf16 a[120:123], v[188:191], a[224:227], a[120:123]
    v_mfma_f32_16x16x32_bf16 a[124:127], v[188:191], a[228:231], a[124:127]
    s_waitcnt lgkmcnt(7)
    v_mfma_f32_16x16x32_bf16 a[8:11], v[32:35], a[240:243], a[8:11]
    v_mfma_f32_16x16x32_bf16 a[12:15], v[32:35], a[244:247], a[12:15]
    s_waitcnt lgkmcnt(6)
    v_mfma_f32_16x16x32_bf16 a[24:27], v[36:39], a[240:243], a[24:27]
    v_mfma_f32_16x16x32_bf16 a[28:31], v[36:39], a[244:247], a[28:31]
    s_waitcnt lgkmcnt(5)
    v_mfma_f32_16x16x32_bf16 a[40:43], v[40:43], a[240:243], a[40:43]
    v_mfma_f32_16x16x32_bf16 a[44:47], v[40:43], a[244:247], a[44:47]
    s_waitcnt lgkmcnt(4)
    v_mfma_f32_16x16x32_bf16 a[56:59], v[44:47], a[240:243], a[56:59]
    v_mfma_f32_16x16x32_bf16 a[60:63], v[44:47], a[244:247], a[60:63]
    s_waitcnt lgkmcnt(3)
    v_mfma_f32_16x16x32_bf16 a[72:75], v[48:51], a[240:243], a[72:75]
    v_mfma_f32_16x16x32_bf16 a[76:79], v[48:51], a[244:247], a[76:79]
    s_waitcnt lgkmcnt(2)
    v_mfma_f32_16x16x32_bf16 a[88:91], v[52:55], a[240:243], a[88:91]
    v_mfma_f32_16x16x32_bf16 a[92:95], v[52:55], a[244:247], a[92:95]
    s_waitcnt lgkmcnt(1)
    v_mfma_f32_16x16x32_bf16 a[104:107], v[56:59], a[240:243], a[104:107]
    v_mfma_f32_16x16x32_bf16 a[108:111], v[56:59], a[244:247], a[108:111]
    s_waitcnt lgkmcnt(0)
    v_mfma_f32_16x16x32_bf16 a[120:123], v[60:63], a[240:243], a[120:123]
    v_mfma_f32_16x16x32_bf16 a[124:127], v[60:63], a[244:247], a[124:127]
    v_mov_b32 v10, v28
    s_nop 1
    v_permlane32_swap_b32 v28, v10
    v_add_f32 v28, v28, v10
    v_mov_b32 v10, v28
    s_nop 1
    v_permlane16_swap_b32 v28, v10
    v_add_f32 v28, v28, v10
    v_rcp_f32 v28, v28
    v_mov_b32 v10, v29
    s_nop 1
    v_permlane32_swap_b32 v29, v10
    v_add_f32 v29, v29, v10
    v_mov_b32 v10, v29
    s_nop 1
    v_permlane16_swap_b32 v29, v10
    v_add_f32 v29, v29, v10
    v_rcp_f32 v29, v29
    v_accvgpr_read_b32 v128, a8
    v_accvgpr_read_b32 v129, a24
    v_accvgpr_read_b32 v130, a40
    v_accvgpr_read_b32 v131, a56
    v_accvgpr_read_b32 v132, a72
    v_accvgpr_read_b32 v133, a88
    v_accvgpr_read_b32 v134, a104
    v_accvgpr_read_b32 v135, a120
    v_mul_f32 v128, v128, v28
    v_mul_f32 v129, v129, v28
    v_mul_f32 v130, v130, v28
    v_mul_f32 v131, v131, v28
    v_mul_f32 v132, v132, v28
    v_mul_f32 v133, v133, v28
    v_mul_f32 v134, v134, v28
    v_mul_f32 v135, v135, v28
    v_cvt_pk_bf16_f32 v128, v128, v129
    v_cvt_pk_bf16_f32 v129, v130, v131
    v_cvt_pk_bf16_f32 v130, v132, v133
    v_cvt_pk_bf16_f32 v131, v134, v135
    s_mov_b32 s7, 0x0
    buffer_store_dwordx4 v[128:131], v0, s[64:67], s7 offen sc1
    v_accvgpr_read_b32 v136, a9
    v_accvgpr_read_b32 v137, a25
    v_accvgpr_read_b32 v138, a41
    v_accvgpr_read_b32 v139, a57
    v_accvgpr_read_b32 v140, a73
    v_accvgpr_read_b32 v141, a89
    v_accvgpr_read_b32 v142, a105
    v_accvgpr_read_b32 v143, a121
    v_mul_f32 v136, v136, v28
    v_mul_f32 v137, v137, v28
    v_mul_f32 v138, v138, v28
    v_mul_f32 v139, v139, v28
    v_mul_f32 v140, v140, v28
    v_mul_f32 v141, v141, v28
    v_mul_f32 v142, v142, v28
    v_mul_f32 v143, v143, v28
    v_cvt_pk_bf16_f32 v136, v136, v137
    v_cvt_pk_bf16_f32 v137, v138, v139
    v_cvt_pk_bf16_f32 v138, v140, v141
    v_cvt_pk_bf16_f32 v139, v142, v143
    s_mov_b32 s7, 0x800
    buffer_store_dwordx4 v[136:139], v0, s[64:67], s7 offen sc1
    v_accvgpr_read_b32 v144, a10
    v_accvgpr_read_b32 v145, a26
    v_accvgpr_read_b32 v146, a42
    v_accvgpr_read_b32 v147, a58
    v_accvgpr_read_b32 v148, a74
    v_accvgpr_read_b32 v149, a90
    v_accvgpr_read_b32 v150, a106
    v_accvgpr_read_b32 v151, a122
    v_mul_f32 v144, v144, v28
    v_mul_f32 v145, v145, v28
    v_mul_f32 v146, v146, v28
    v_mul_f32 v147, v147, v28
    v_mul_f32 v148, v148, v28
    v_mul_f32 v149, v149, v28
    v_mul_f32 v150, v150, v28
    v_mul_f32 v151, v151, v28
    v_cvt_pk_bf16_f32 v144, v144, v145
    v_cvt_pk_bf16_f32 v145, v146, v147
    v_cvt_pk_bf16_f32 v146, v148, v149
    v_cvt_pk_bf16_f32 v147, v150, v151
    s_mov_b32 s7, 0x1000
    buffer_store_dwordx4 v[144:147], v0, s[64:67], s7 offen sc1
    v_accvgpr_read_b32 v152, a11
    v_accvgpr_read_b32 v153, a27
    v_accvgpr_read_b32 v154, a43
    v_accvgpr_read_b32 v155, a59
    v_accvgpr_read_b32 v156, a75
    v_accvgpr_read_b32 v157, a91
    v_accvgpr_read_b32 v158, a107
    v_accvgpr_read_b32 v159, a123
    v_mul_f32 v152, v152, v28
    v_mul_f32 v153, v153, v28
    v_mul_f32 v154, v154, v28
    v_mul_f32 v155, v155, v28
    v_mul_f32 v156, v156, v28
    v_mul_f32 v157, v157, v28
    v_mul_f32 v158, v158, v28
    v_mul_f32 v159, v159, v28
    v_cvt_pk_bf16_f32 v152, v152, v153
    v_cvt_pk_bf16_f32 v153, v154, v155
    v_cvt_pk_bf16_f32 v154, v156, v157
    v_cvt_pk_bf16_f32 v155, v158, v159
    s_mov_b32 s7, 0x1800
    buffer_store_dwordx4 v[152:155], v0, s[64:67], s7 offen sc1
    v_accvgpr_read_b32 v160, a12
    v_accvgpr_read_b32 v161, a28
    v_accvgpr_read_b32 v162, a44
    v_accvgpr_read_b32 v163, a60
    v_accvgpr_read_b32 v164, a76
    v_accvgpr_read_b32 v165, a92
    v_accvgpr_read_b32 v166, a108
    v_accvgpr_read_b32 v167, a124
    v_mul_f32 v160, v160, v29
    v_mul_f32 v161, v161, v29
    v_mul_f32 v162, v162, v29
    v_mul_f32 v163, v163, v29
    v_mul_f32 v164, v164, v29
    v_mul_f32 v165, v165, v29
    v_mul_f32 v166, v166, v29
    v_mul_f32 v167, v167, v29
    v_cvt_pk_bf16_f32 v160, v160, v161
    v_cvt_pk_bf16_f32 v161, v162, v163
    v_cvt_pk_bf16_f32 v162, v164, v165
    v_cvt_pk_bf16_f32 v163, v166, v167
    s_mov_b32 s7, 0x400
    buffer_store_dwordx4 v[160:163], v0, s[64:67], s7 offen sc1
    v_accvgpr_read_b32 v168, a13
    v_accvgpr_read_b32 v169, a29
    v_accvgpr_read_b32 v170, a45
    v_accvgpr_read_b32 v171, a61
    v_accvgpr_read_b32 v172, a77
    v_accvgpr_read_b32 v173, a93
    v_accvgpr_read_b32 v174, a109
    v_accvgpr_read_b32 v175, a125
    v_mul_f32 v168, v168, v29
    v_mul_f32 v169, v169, v29
    v_mul_f32 v170, v170, v29
    v_mul_f32 v171, v171, v29
    v_mul_f32 v172, v172, v29
    v_mul_f32 v173, v173, v29
    v_mul_f32 v174, v174, v29
    v_mul_f32 v175, v175, v29
    v_cvt_pk_bf16_f32 v168, v168, v169
    v_cvt_pk_bf16_f32 v169, v170, v171
    v_cvt_pk_bf16_f32 v170, v172, v173
    v_cvt_pk_bf16_f32 v171, v174, v175
    s_mov_b32 s7, 0xc00
    buffer_store_dwordx4 v[168:171], v0, s[64:67], s7 offen sc1
    v_accvgpr_read_b32 v176, a14
    v_accvgpr_read_b32 v177, a30
    v_accvgpr_read_b32 v178, a46
    v_accvgpr_read_b32 v179, a62
    v_accvgpr_read_b32 v180, a78
    v_accvgpr_read_b32 v181, a94
    v_accvgpr_read_b32 v182, a110
    v_accvgpr_read_b32 v183, a126
    v_mul_f32 v176, v176, v29
    v_mul_f32 v177, v177, v29
    v_mul_f32 v178, v178, v29
    v_mul_f32 v179, v179, v29
    v_mul_f32 v180, v180, v29
    v_mul_f32 v181, v181, v29
    v_mul_f32 v182, v182, v29
    v_mul_f32 v183, v183, v29
    v_cvt_pk_bf16_f32 v176, v176, v177
    v_cvt_pk_bf16_f32 v177, v178, v179
    v_cvt_pk_bf16_f32 v178, v180, v181
    v_cvt_pk_bf16_f32 v179, v182, v183
    s_mov_b32 s7, 0x1400
    buffer_store_dwordx4 v[176:179], v0, s[64:67], s7 offen sc1
    v_accvgpr_read_b32 v184, a15
    v_accvgpr_read_b32 v185, a31
    v_accvgpr_read_b32 v186, a47
    v_accvgpr_read_b32 v187, a63
    v_accvgpr_read_b32 v188, a79
    v_accvgpr_read_b32 v189, a95
    v_accvgpr_read_b32 v190, a111
    v_accvgpr_read_b32 v191, a127
    v_mul_f32 v184, v184, v29
    v_mul_f32 v185, v185, v29
    v_mul_f32 v186, v186, v29
    v_mul_f32 v187, v187, v29
    v_mul_f32 v188, v188, v29
    v_mul_f32 v189, v189, v29
    v_mul_f32 v190, v190, v29
    v_mul_f32 v191, v191, v29
    v_cvt_pk_bf16_f32 v184, v184, v185
    v_cvt_pk_bf16_f32 v185, v186, v187
    v_cvt_pk_bf16_f32 v186, v188, v189
    v_cvt_pk_bf16_f32 v187, v190, v191
    s_mov_b32 s7, 0x1c00
    buffer_store_dwordx4 v[184:187], v0, s[64:67], s7 offen sc1
    s_waitcnt lgkmcnt(0)
    s_barrier
    s_waitcnt vmcnt(33)
    v_perm_b32 v32, v196, v192, s38
    v_perm_b32 v33, v204, v200, s38
    v_perm_b32 v34, v212, v208, s38
    v_perm_b32 v35, v220, v216, s38
    ds_write_b128 v5, v[32:35]
    v_perm_b32 v36, v196, v192, s39
    v_perm_b32 v37, v204, v200, s39
    v_perm_b32 v38, v212, v208, s39
    v_perm_b32 v39, v220, v216, s39
    ds_write_b128 v5, v[36:39] offset:1024
    v_perm_b32 v40, v197, v193, s38
    v_perm_b32 v41, v205, v201, s38
    v_perm_b32 v42, v213, v209, s38
    v_perm_b32 v43, v221, v217, s38
    ds_write_b128 v5, v[40:43] offset:2048
    v_perm_b32 v44, v197, v193, s39
    v_perm_b32 v45, v205, v201, s39
    v_perm_b32 v46, v213, v209, s39
    v_perm_b32 v47, v221, v217, s39
    ds_write_b128 v5, v[44:47] offset:3072
    v_perm_b32 v48, v198, v194, s38
    v_perm_b32 v49, v206, v202, s38
    v_perm_b32 v50, v214, v210, s38
    v_perm_b32 v51, v222, v218, s38
    ds_write_b128 v5, v[48:51] offset:4096
    v_perm_b32 v52, v198, v194, s39
    v_perm_b32 v53, v206, v202, s39
    v_perm_b32 v54, v214, v210, s39
    v_perm_b32 v55, v222, v218, s39
    ds_write_b128 v5, v[52:55] offset:5120
    v_perm_b32 v56, v199, v195, s38
    v_perm_b32 v57, v207, v203, s38
    v_perm_b32 v58, v215, v211, s38
    v_perm_b32 v59, v223, v219, s38
    ds_write_b128 v5, v[56:59] offset:6144
    v_perm_b32 v60, v199, v195, s39
    v_perm_b32 v61, v207, v203, s39
    v_perm_b32 v62, v215, v211, s39
    v_perm_b32 v63, v223, v219, s39
    ds_write_b128 v5, v[60:63] offset:7168
    s_waitcnt vmcnt(25)
    s_waitcnt lgkmcnt(0)
    v_perm_b32 v32, v228, v224, s38
    v_perm_b32 v33, v236, v232, s38
    v_perm_b32 v34, v244, v240, s38
    v_perm_b32 v35, v252, v248, s38
    ds_write_b128 v5, v[32:35] offset:8192
    v_perm_b32 v36, v228, v224, s39
    v_perm_b32 v37, v236, v232, s39
    v_perm_b32 v38, v244, v240, s39
    v_perm_b32 v39, v252, v248, s39
    ds_write_b128 v5, v[36:39] offset:9216
    v_perm_b32 v40, v229, v225, s38
    v_perm_b32 v41, v237, v233, s38
    v_perm_b32 v42, v245, v241, s38
    v_perm_b32 v43, v253, v249, s38
    ds_write_b128 v5, v[40:43] offset:10240
    v_perm_b32 v44, v229, v225, s39
    v_perm_b32 v45, v237, v233, s39
    v_perm_b32 v46, v245, v241, s39
    v_perm_b32 v47, v253, v249, s39
    ds_write_b128 v5, v[44:47] offset:11264
    v_perm_b32 v48, v230, v226, s38
    v_perm_b32 v49, v238, v234, s38
    v_perm_b32 v50, v246, v242, s38
    v_perm_b32 v51, v254, v250, s38
    ds_write_b128 v5, v[48:51] offset:12288
    v_perm_b32 v52, v230, v226, s39
    v_perm_b32 v53, v238, v234, s39
    v_perm_b32 v54, v246, v242, s39
    v_perm_b32 v55, v254, v250, s39
    ds_write_b128 v5, v[52:55] offset:13312
    v_perm_b32 v56, v231, v227, s38
    v_perm_b32 v57, v239, v235, s38
    v_perm_b32 v58, v247, v243, s38
    v_perm_b32 v59, v255, v251, s38
    ds_write_b128 v5, v[56:59] offset:14336
    v_perm_b32 v60, v231, v227, s39
    v_perm_b32 v61, v239, v235, s39
    v_perm_b32 v62, v247, v243, s39
    v_perm_b32 v63, v255, v251, s39
    ds_write_b128 v5, v[60:63] offset:15360
    s_waitcnt vmcnt(17)
    s_waitcnt lgkmcnt(0)
    v_perm_b32 v32, v68, v64, s38
    v_perm_b32 v33, v76, v72, s38
    v_perm_b32 v34, v84, v80, s38
    v_perm_b32 v35, v92, v88, s38
    ds_write_b128 v5, v[32:35] offset:16384
    v_perm_b32 v36, v68, v64, s39
    v_perm_b32 v37, v76, v72, s39
    v_perm_b32 v38, v84, v80, s39
    v_perm_b32 v39, v92, v88, s39
    ds_write_b128 v5, v[36:39] offset:17408
    v_perm_b32 v40, v69, v65, s38
    v_perm_b32 v41, v77, v73, s38
    v_perm_b32 v42, v85, v81, s38
    v_perm_b32 v43, v93, v89, s38
    ds_write_b128 v5, v[40:43] offset:18432
    v_perm_b32 v44, v69, v65, s39
    v_perm_b32 v45, v77, v73, s39
    v_perm_b32 v46, v85, v81, s39
    v_perm_b32 v47, v93, v89, s39
    ds_write_b128 v5, v[44:47] offset:19456
    v_perm_b32 v48, v70, v66, s38
    v_perm_b32 v49, v78, v74, s38
    v_perm_b32 v50, v86, v82, s38
    v_perm_b32 v51, v94, v90, s38
    ds_write_b128 v5, v[48:51] offset:20480
    v_perm_b32 v52, v70, v66, s39
    v_perm_b32 v53, v78, v74, s39
    v_perm_b32 v54, v86, v82, s39
    v_perm_b32 v55, v94, v90, s39
    ds_write_b128 v5, v[52:55] offset:21504
    v_perm_b32 v56, v71, v67, s38
    v_perm_b32 v57, v79, v75, s38
    v_perm_b32 v58, v87, v83, s38
    v_perm_b32 v59, v95, v91, s38
    ds_write_b128 v5, v[56:59] offset:22528
    v_perm_b32 v60, v71, v67, s39
    v_perm_b32 v61, v79, v75, s39
    v_perm_b32 v62, v87, v83, s39
    v_perm_b32 v63, v95, v91, s39
    ds_write_b128 v5, v[60:63] offset:23552
    s_waitcnt vmcnt(9)
    s_waitcnt lgkmcnt(0)
    v_perm_b32 v32, v100, v96, s38
    v_perm_b32 v33, v108, v104, s38
    v_perm_b32 v34, v116, v112, s38
    v_perm_b32 v35, v124, v120, s38
    ds_write_b128 v5, v[32:35] offset:24576
    v_perm_b32 v36, v100, v96, s39
    v_perm_b32 v37, v108, v104, s39
    v_perm_b32 v38, v116, v112, s39
    v_perm_b32 v39, v124, v120, s39
    ds_write_b128 v5, v[36:39] offset:25600
    v_perm_b32 v40, v101, v97, s38
    v_perm_b32 v41, v109, v105, s38
    v_perm_b32 v42, v117, v113, s38
    v_perm_b32 v43, v125, v121, s38
    ds_write_b128 v5, v[40:43] offset:26624
    v_perm_b32 v44, v101, v97, s39
    v_perm_b32 v45, v109, v105, s39
    v_perm_b32 v46, v117, v113, s39
    v_perm_b32 v47, v125, v121, s39
    ds_write_b128 v5, v[44:47] offset:27648
    v_perm_b32 v48, v102, v98, s38
    v_perm_b32 v49, v110, v106, s38
    v_perm_b32 v50, v118, v114, s38
    v_perm_b32 v51, v126, v122, s38
    ds_write_b128 v5, v[48:51] offset:28672
    v_perm_b32 v52, v102, v98, s39
    v_perm_b32 v53, v110, v106, s39
    v_perm_b32 v54, v118, v114, s39
    v_perm_b32 v55, v126, v122, s39
    ds_write_b128 v5, v[52:55] offset:29696
    v_perm_b32 v56, v103, v99, s38
    v_perm_b32 v57, v111, v107, s38
    v_perm_b32 v58, v119, v115, s38
    v_perm_b32 v59, v127, v123, s38
    ds_write_b128 v5, v[56:59] offset:30720
    v_perm_b32 v60, v103, v99, s39
    v_perm_b32 v61, v111, v107, s39
    v_perm_b32 v62, v119, v115, s39
    v_perm_b32 v63, v127, v123, s39
    ds_write_b128 v5, v[60:63] offset:31744
    s_waitcnt vmcnt(8)
    s_mov_b32 s100, 0x01010101
    v_cmp_ne_u32 vcc, s100, v30
    s_nop 4
    s_cmp_eq_u64 vcc, 0
    s_cbranch_scc1 CERT_OKA
    s_mov_b32 s100, 0x1010101
    s_mov_b32 s101, 20000
    s_nop 4
PG2:
    buffer_load_dword v10, v9, s[72:75], 0 offen sc1
    s_waitcnt vmcnt(0)
    v_cmp_ne_u32 vcc, s100, v10
    s_nop 4
    s_cmp_eq_u64 vcc, 0
    s_cbranch_scc1 PG2_done
    s_sleep 1
    s_sub_u32 s101, s101, 1
    s_cbranch_scc0 PG2
PG2_done:
CERT_OKA:
    s_waitcnt vmcnt(0)
    v_mov_b32 v10, 1
    s_mov_b64 exec, 1
    buffer_store_dword v10, v8, s[68:71], s80 offen sc1
    s_mov_b64 exec, -1
    s_lshl_b32 s6, s4, 19
    s_lshl_b32 s7, s34, 15
    s_add_u32 s6, s6, s7
    s_lshl_b32 s7, s37, 8
    s_add_u32 s6, s6, s7
    s_sub_u32 s7, 0x400000, s6
    s_add_u32 s76, s26, s6
    s_addc_u32 s77, s27, 0
    s_and_b32 s77, s77, 0xffff
    s_mov_b32 s78, s7
    s_mov_b32 s79, 0x20000
    v_lshrrev_b32 v12, 5, v0
    v_lshlrev_b32 v12, 10, v12
    v_and_b32 v11, 16, v0
    v_lshl_add_u32 v12, v11, 3, v12
    buffer_load_dword v30, v12, s[76:79], 0 offen
    s_waitcnt vmcnt(0) lgkmcnt(0)
OPROJ:
    s_nop 7
    s_add_u32 s6, s34, s84
    s_lshl_b32 s6, s6, 3
    s_add_u32 s6, s6, s4
    s_lshl_b32 s85, s6, 7
    s_lshl_b32 s7, s6, 15
    s_add_u32 s7, s7, 0x800000
    s_add_u32 s44, s32, s7
    s_addc_u32 s45, s33, 0
    s_and_b32 s45, s45, 0xffff
    s_mov_b32 s46, 32768
    s_mov_b32 s47, 0x20000
    s_lshl_b32 s6, s6, 2
    s_add_u32 s6, s6, s37
    s_lshl_b32 s6, s6, 14
    s_add_u32 s6, s6, 0x1000000
    s_add_u32 s48, s32, s6
    s_addc_u32 s49, s33, 0
    s_and_b32 s49, s49, 0xffff
    s_mov_b32 s50, 16384
    s_mov_b32 s51, 0x20000
    s_waitcnt lgkmcnt(0)
    s_barrier
    ds_read_b128 v[32:35], v0
    ds_read_b128 v[36:39], v0 offset:1024
    ds_read_b128 v[40:43], v0 offset:2048
    ds_read_b128 v[44:47], v0 offset:3072
    ds_read_b128 v[48:51], v0 offset:4096
    ds_read_b128 v[52:55], v0 offset:5120
    ds_read_b128 v[56:59], v0 offset:6144
    ds_read_b128 v[60:63], v0 offset:7168
    ds_read_b128 v[64:67], v0 offset:8192
    ds_read_b128 v[68:71], v0 offset:9216
    ds_read_b128 v[72:75], v0 offset:10240
    ds_read_b128 v[76:79], v0 offset:11264
    ds_read_b128 v[80:83], v0 offset:12288
    ds_read_b128 v[84:87], v0 offset:13312
    ds_read_b128 v[88:91], v0 offset:14336
    ds_read_b128 v[92:95], v0 offset:15360
    ds_read_b128 v[96:99], v0 offset:16384
    ds_read_b128 v[100:103], v0 offset:17408
    ds_read_b128 v[104:107], v0 offset:18432
    ds_read_b128 v[108:111], v0 offset:19456
    ds_read_b128 v[112:115], v0 offset:20480
    ds_read_b128 v[116:119], v0 offset:21504
    ds_read_b128 v[120:123], v0 offset:22528
    ds_read_b128 v[124:127], v0 offset:23552
    ds_read_b128 v[128:131], v0 offset:24576
    ds_read_b128 v[132:135], v0 offset:25600
    ds_read_b128 v[136:139], v0 offset:26624
    ds_read_b128 v[140:143], v0 offset:27648
    ds_read_b128 v[144:147], v0 offset:28672
    ds_read_b128 v[148:151], v0 offset:29696
    ds_read_b128 v[152:155], v0 offset:30720
    ds_read_b128 v[156:159], v0 offset:31744
    ds_read_b128 v[160:163], v0 offset:33280
    ds_read_b128 v[164:167], v0 offset:34304
    ds_read_b128 v[168:171], v0 offset:35328
    ds_read_b128 v[172:175], v0 offset:36352
    ds_read_b128 v[176:179], v0 offset:37376
    ds_read_b128 v[180:183], v0 offset:38400
    ds_read_b128 v[184:187], v0 offset:39424
    ds_read_b128 v[188:191], v0 offset:40448
    ds_read_b128 v[192:195], v0 offset:41472
    ds_read_b128 v[196:199], v0 offset:42496
    ds_read_b128 v[200:203], v0 offset:43520
    ds_read_b128 v[204:207], v0 offset:44544
    ds_read_b128 v[208:211], v0 offset:45568
    ds_read_b128 v[212:215], v0 offset:46592
    ds_read_b128 v[216:219], v0 offset:47616
    ds_read_b128 v[220:223], v0 offset:48640
    ds_read_b128 v[224:227], v0 offset:49664
    ds_read_b128 v[228:231], v0 offset:50688
    ds_read_b128 v[232:235], v0 offset:51712
    ds_read_b128 v[236:239], v0 offset:52736
    ds_read_b128 v[240:243], v0 offset:53760
    ds_read_b128 v[244:247], v0 offset:54784
    ds_read_b128 v[248:251], v0 offset:55808
    ds_read_b128 v[252:255], v0 offset:56832
    ds_read_b128 a[192:195], v0 offset:57856
    ds_read_b128 a[196:199], v0 offset:58880
    ds_read_b128 a[200:203], v0 offset:59904
    ds_read_b128 a[204:207], v0 offset:60928
    ds_read_b128 a[208:211], v0 offset:61952
    ds_read_b128 a[212:215], v0 offset:62976
    ds_read_b128 a[216:219], v0 offset:64000
    ds_read_b128 a[220:223], v0 offset:65024
    ds_read_b128 a[224:227], v6 offset:1024
    ds_read_b128 a[228:231], v6 offset:2048
    ds_read_b128 a[232:235], v6 offset:3072
    ds_read_b128 a[236:239], v6 offset:4096
    ds_read_b128 a[240:243], v6 offset:5120
    ds_read_b128 a[244:247], v6 offset:6144
    ds_read_b128 a[248:251], v6 offset:7168
    ds_read_b128 a[252:255], v6 offset:8192
    s_mov_b32 s100, 0x1
    s_mov_b32 s101, 20000
    s_mov_b64 exec, 0xf
    s_nop 4
PG3:
    buffer_load_dword v10, v9, s[68:71], s85 offen sc1
    s_waitcnt vmcnt(0)
    v_cmp_ne_u32 vcc, s100, v10
    s_nop 4
    s_cmp_eq_u64 vcc, 0
    s_cbranch_scc1 PG3_done
    s_sleep 2
    s_sub_u32 s101, s101, 1
    s_cbranch_scc0 PG3
PG3_done:
    s_mov_b64 exec, -1
    s_mov_b32 s97, 0x0
    buffer_load_dwordx4 a[0:3], v0, s[44:47], s97 offen sc1
    s_mov_b32 s97, 0x400
    buffer_load_dwordx4 a[4:7], v0, s[44:47], s97 offen sc1
    s_mov_b32 s97, 0x800
    buffer_load_dwordx4 a[8:11], v0, s[44:47], s97 offen sc1
    s_mov_b32 s97, 0xc00
    buffer_load_dwordx4 a[12:15], v0, s[44:47], s97 offen sc1
    s_mov_b32 s97, 0x1000
    buffer_load_dwordx4 a[16:19], v0, s[44:47], s97 offen sc1
    s_mov_b32 s97, 0x1400
    buffer_load_dwordx4 a[20:23], v0, s[44:47], s97 offen sc1
    s_mov_b32 s97, 0x1800
    buffer_load_dwordx4 a[24:27], v0, s[44:47], s97 offen sc1
    s_mov_b32 s97, 0x1c00
    buffer_load_dwordx4 a[28:31], v0, s[44:47], s97 offen sc1
    s_mov_b32 s97, 0x2000
    buffer_load_dwordx4 a[32:35], v0, s[44:47], s97 offen sc1
    s_mov_b32 s97, 0x2400
    buffer_load_dwordx4 a[36:39], v0, s[44:47], s97 offen sc1
    s_mov_b32 s97, 0x2800
    buffer_load_dwordx4 a[40:43], v0, s[44:47], s97 offen sc1
    s_mov_b32 s97, 0x2c00
    buffer_load_dwordx4 a[44:47], v0, s[44:47], s97 offen sc1
    s_mov_b32 s97, 0x3000
    buffer_load_dwordx4 a[48:51], v0, s[44:47], s97 offen sc1
    s_mov_b32 s97, 0x3400
    buffer_load_dwordx4 a[52:55], v0, s[44:47], s97 offen sc1
    s_mov_b32 s97, 0x3800
    buffer_load_dwordx4 a[56:59], v0, s[44:47], s97 offen sc1
    s_mov_b32 s97, 0x3c00
    buffer_load_dwordx4 a[60:63], v0, s[44:47], s97 offen sc1
    s_mov_b32 s97, 0x4000
    buffer_load_dwordx4 a[64:67], v0, s[44:47], s97 offen sc1
    s_mov_b32 s97, 0x4400
    buffer_load_dwordx4 a[68:71], v0, s[44:47], s97 offen sc1
    s_mov_b32 s97, 0x4800
    buffer_load_dwordx4 a[72:75], v0, s[44:47], s97 offen sc1
    s_mov_b32 s97, 0x4c00
    buffer_load_dwordx4 a[76:79], v0, s[44:47], s97 offen sc1
    s_mov_b32 s97, 0x5000
    buffer_load_dwordx4 a[80:83], v0, s[44:47], s97 offen sc1
    s_mov_b32 s97, 0x5400
    buffer_load_dwordx4 a[84:87], v0, s[44:47], s97 offen sc1
    s_mov_b32 s97, 0x5800
    buffer_load_dwordx4 a[88:91], v0, s[44:47], s97 offen sc1
    s_mov_b32 s97, 0x5c00
    buffer_load_dwordx4 a[92:95], v0, s[44:47], s97 offen sc1
    s_mov_b32 s97, 0x6000
    buffer_load_dwordx4 a[96:99], v0, s[44:47], s97 offen sc1
    s_mov_b32 s97, 0x6400
    buffer_load_dwordx4 a[100:103], v0, s[44:47], s97 offen sc1
    s_mov_b32 s97, 0x6800
    buffer_load_dwordx4 a[104:107], v0, s[44:47], s97 offen sc1
    s_mov_b32 s97, 0x6c00
    buffer_load_dwordx4 a[108:111], v0, s[44:47], s97 offen sc1
    s_mov_b32 s97, 0x7000
    buffer_load_dwordx4 a[112:115], v0, s[44:47], s97 offen sc1
    s_mov_b32 s97, 0x7400
    buffer_load_dwordx4 a[116:119], v0, s[44:47], s97 offen sc1
    s_mov_b32 s97, 0x7800
    buffer_load_dwordx4 a[120:123], v0, s[44:47], s97 offen sc1
    s_mov_b32 s97, 0x7c00
    buffer_load_dwordx4 a[124:127], v0, s[44:47], s97 offen sc1
    s_waitcnt lgkmcnt(0)
    s_waitcnt vmcnt(30)
    v_mfma_f32_16x16x32_bf16 a[128:131], v[32:35], a[0:3], 0
    v_mfma_f32_16x16x32_bf16 a[132:135], v[32:35], a[4:7], 0
    v_mfma_f32_16x16x32_bf16 a[136:139], v[36:39], a[0:3], 0
    v_mfma_f32_16x16x32_bf16 a[140:143], v[36:39], a[4:7], 0
    v_mfma_f32_16x16x32_bf16 a[144:147], v[40:43], a[0:3], 0
    v_mfma_f32_16x16x32_bf16 a[148:151], v[40:43], a[4:7], 0
    ds_read_b128 v[32:35], v6 offset:9216
    v_mfma_f32_16x16x32_bf16 a[152:155], v[44:47], a[0:3], 0
    v_mfma_f32_16x16x32_bf16 a[156:159], v[44:47], a[4:7], 0
    ds_read_b128 v[36:39], v6 offset:10240
    v_mfma_f32_16x16x32_bf16 a[160:163], v[48:51], a[0:3], 0
    v_mfma_f32_16x16x32_bf16 a[164:167], v[48:51], a[4:7], 0
    ds_read_b128 v[40:43], v6 offset:11264
    v_mfma_f32_16x16x32_bf16 a[168:171], v[52:55], a[0:3], 0
    v_mfma_f32_16x16x32_bf16 a[172:175], v[52:55], a[4:7], 0
    ds_read_b128 v[44:47], v6 offset:12288
    v_mfma_f32_16x16x32_bf16 a[176:179], v[56:59], a[0:3], 0
    v_mfma_f32_16x16x32_bf16 a[180:183], v[56:59], a[4:7], 0
    ds_read_b128 v[48:51], v6 offset:13312
    v_mfma_f32_16x16x32_bf16 a[184:187], v[60:63], a[0:3], 0
    v_mfma_f32_16x16x32_bf16 a[188:191], v[60:63], a[4:7], 0
    ds_read_b128 v[52:55], v6 offset:14336
    s_waitcnt vmcnt(28)
    v_mfma_f32_16x16x32_bf16 a[128:131], v[64:67], a[8:11], a[128:131]
    v_mfma_f32_16x16x32_bf16 a[132:135], v[64:67], a[12:15], a[132:135]
    ds_read_b128 v[56:59], v6 offset:15360
    v_mfma_f32_16x16x32_bf16 a[136:139], v[68:71], a[8:11], a[136:139]
    v_mfma_f32_16x16x32_bf16 a[140:143], v[68:71], a[12:15], a[140:143]
    ds_read_b128 v[60:63], v6 offset:16384
    v_mfma_f32_16x16x32_bf16 a[144:147], v[72:75], a[8:11], a[144:147]
    v_mfma_f32_16x16x32_bf16 a[148:151], v[72:75], a[12:15], a[148:151]
    ds_read_b128 v[64:67], v6 offset:17408
    v_mfma_f32_16x16x32_bf16 a[152:155], v[76:79], a[8:11], a[152:155]
    v_mfma_f32_16x16x32_bf16 a[156:159], v[76:79], a[12:15], a[156:159]
    ds_read_b128 v[68:71], v6 offset:18432
    v_mfma_f32_16x16x32_bf16 a[160:163], v[80:83], a[8:11], a[160:163]
    v_mfma_f32_16x16x32_bf16 a[164:167], v[80:83], a[12:15], a[164:167]
    ds_read_b128 v[72:75], v6 offset:19456
    v_mfma_f32_16x16x32_bf16 a[168:171], v[84:87], a[8:11], a[168:171]
    v_mfma_f32_16x16x32_bf16 a[172:175], v[84:87], a[12:15], a[172:175]
    ds_read_b128 v[76:79], v6 offset:20480
    v_mfma_f32_16x16x32_bf16 a[176:179], v[88:91], a[8:11], a[176:179]
    v_mfma_f32_16x16x32_bf16 a[180:183], v[88:91], a[12:15], a[180:183]
    ds_read_b128 v[80:83], v6 offset:21504
    v_mfma_f32_16x16x32_bf16 a[184:187], v[92:95], a[8:11], a[184:187]
    v_mfma_f32_16x16x32_bf16 a[188:191], v[92:95], a[12:15], a[188:191]
    ds_read_b128 v[84:87], v6 offset:22528
    s_waitcnt vmcnt(26)
    v_mfma_f32_16x16x32_bf16 a[128:131], v[96:99], a[16:19], a[128:131]
    v_mfma_f32_16x16x32_bf16 a[132:135], v[96:99], a[20:23], a[132:135]
    ds_read_b128 v[88:91], v6 offset:23552
    v_mfma_f32_16x16x32_bf16 a[136:139], v[100:103], a[16:19], a[136:139]
    v_mfma_f32_16x16x32_bf16 a[140:143], v[100:103], a[20:23], a[140:143]
    ds_read_b128 v[92:95], v6 offset:24576
    v_mfma_f32_16x16x32_bf16 a[144:147], v[104:107], a[16:19], a[144:147]
    v_mfma_f32_16x16x32_bf16 a[148:151], v[104:107], a[20:23], a[148:151]
    ds_read_b128 v[96:99], v6 offset:25600
    v_mfma_f32_16x16x32_bf16 a[152:155], v[108:111], a[16:19], a[152:155]
    v_mfma_f32_16x16x32_bf16 a[156:159], v[108:111], a[20:23], a[156:159]
    ds_read_b128 v[100:103], v6 offset:26624
    v_mfma_f32_16x16x32_bf16 a[160:163], v[112:115], a[16:19], a[160:163]
    v_mfma_f32_16x16x32_bf16 a[164:167], v[112:115], a[20:23], a[164:167]
    ds_read_b128 v[104:107], v6 offset:27648
    v_mfma_f32_16x16x32_bf16 a[168:171], v[116:119], a[16:19], a[168:171]
    v_mfma_f32_16x16x32_bf16 a[172:175], v[116:119], a[20:23], a[172:175]
    ds_read_b128 v[108:111], v6 offset:28672
    v_mfma_f32_16x16x32_bf16 a[176:179], v[120:123], a[16:19], a[176:179]
    v_mfma_f32_16x16x32_bf16 a[180:183], v[120:123], a[20:23], a[180:183]
    ds_read_b128 v[112:115], v6 offset:29696
    v_mfma_f32_16x16x32_bf16 a[184:187], v[124:127], a[16:19], a[184:187]
    v_mfma_f32_16x16x32_bf16 a[188:191], v[124:127], a[20:23], a[188:191]
    ds_read_b128 v[116:119], v6 offset:30720
    s_waitcnt vmcnt(24)
    v_mfma_f32_16x16x32_bf16 a[128:131], v[128:131], a[24:27], a[128:131]
    v_mfma_f32_16x16x32_bf16 a[132:135], v[128:131], a[28:31], a[132:135]
    ds_read_b128 v[120:123], v6 offset:31744
    v_mfma_f32_16x16x32_bf16 a[136:139], v[132:135], a[24:27], a[136:139]
    v_mfma_f32_16x16x32_bf16 a[140:143], v[132:135], a[28:31], a[140:143]
    ds_read_b128 v[124:127], v6 offset:32768
    v_mfma_f32_16x16x32_bf16 a[144:147], v[136:139], a[24:27], a[144:147]
    v_mfma_f32_16x16x32_bf16 a[148:151], v[136:139], a[28:31], a[148:151]
    ds_read_b128 v[128:131], v6 offset:34304
    v_mfma_f32_16x16x32_bf16 a[152:155], v[140:143], a[24:27], a[152:155]
    v_mfma_f32_16x16x32_bf16 a[156:159], v[140:143], a[28:31], a[156:159]
    ds_read_b128 v[132:135], v6 offset:35328
    v_mfma_f32_16x16x32_bf16 a[160:163], v[144:147], a[24:27], a[160:163]
    v_mfma_f32_16x16x32_bf16 a[164:167], v[144:147], a[28:31], a[164:167]
    ds_read_b128 v[136:139], v6 offset:36352
    v_mfma_f32_16x16x32_bf16 a[168:171], v[148:151], a[24:27], a[168:171]
    v_mfma_f32_16x16x32_bf16 a[172:175], v[148:151], a[28:31], a[172:175]
    ds_read_b128 v[140:143], v6 offset:37376
    v_mfma_f32_16x16x32_bf16 a[176:179], v[152:155], a[24:27], a[176:179]
    v_mfma_f32_16x16x32_bf16 a[180:183], v[152:155], a[28:31], a[180:183]
    ds_read_b128 v[144:147], v6 offset:38400
    v_mfma_f32_16x16x32_bf16 a[184:187], v[156:159], a[24:27], a[184:187]
    v_mfma_f32_16x16x32_bf16 a[188:191], v[156:159], a[28:31], a[188:191]
    ds_read_b128 v[148:151], v6 offset:39424
    s_waitcnt vmcnt(22)
    v_mfma_f32_16x16x32_bf16 a[128:131], v[160:163], a[32:35], a[128:131]
    v_mfma_f32_16x16x32_bf16 a[132:135], v[160:163], a[36:39], a[132:135]
    ds_read_b128 v[152:155], v6 offset:40448
    v_mfma_f32_16x16x32_bf16 a[136:139], v[164:167], a[32:35], a[136:139]
    v_mfma_f32_16x16x32_bf16 a[140:143], v[164:167], a[36:39], a[140:143]
    ds_read_b128 v[156:159], v6 offset:41472
    v_mfma_f32_16x16x32_bf16 a[144:147], v[168:171], a[32:35], a[144:147]
    v_mfma_f32_16x16x32_bf16 a[148:151], v[168:171], a[36:39], a[148:151]
    ds_read_b128 v[160:163], v6 offset:42496
    v_mfma_f32_16x16x32_bf16 a[152:155], v[172:175], a[32:35], a[152:155]
    v_mfma_f32_16x16x32_bf16 a[156:159], v[172:175], a[36:39], a[156:159]
    ds_read_b128 v[164:167], v6 offset:43520
    v_mfma_f32_16x16x32_bf16 a[160:163], v[176:179], a[32:35], a[160:163]
    v_mfma_f32_16x16x32_bf16 a[164:167], v[176:179], a[36:39], a[164:167]
    ds_read_b128 v[168:171], v6 offset:44544
    v_mfma_f32_16x16x32_bf16 a[168:171], v[180:183], a[32:35], a[168:171]
    v_mfma_f32_16x16x32_bf16 a[172:175], v[180:183], a[36:39], a[172:175]
    ds_read_b128 v[172:175], v6 offset:45568
    v_mfma_f32_16x16x32_bf16 a[176:179], v[184:187], a[32:35], a[176:179]
    v_mfma_f32_16x16x32_bf16 a[180:183], v[184:187], a[36:39], a[180:183]
    ds_read_b128 v[176:179], v6 offset:46592
    v_mfma_f32_16x16x32_bf16 a[184:187], v[188:191], a[32:35], a[184:187]
    v_mfma_f32_16x16x32_bf16 a[188:191], v[188:191], a[36:39], a[188:191]
    ds_read_b128 v[180:183], v6 offset:47616
    s_waitcnt vmcnt(20)
    v_mfma_f32_16x16x32_bf16 a[128:131], v[192:195], a[40:43], a[128:131]
    v_mfma_f32_16x16x32_bf16 a[132:135], v[192:195], a[44:47], a[132:135]
    ds_read_b128 v[184:187], v6 offset:48640
    v_mfma_f32_16x16x32_bf16 a[136:139], v[196:199], a[40:43], a[136:139]
    v_mfma_f32_16x16x32_bf16 a[140:143], v[196:199], a[44:47], a[140:143]
    ds_read_b128 v[188:191], v6 offset:49664
    v_mfma_f32_16x16x32_bf16 a[144:147], v[200:203], a[40:43], a[144:147]
    v_mfma_f32_16x16x32_bf16 a[148:151], v[200:203], a[44:47], a[148:151]
    ds_read_b128 v[192:195], v6 offset:50688
    v_mfma_f32_16x16x32_bf16 a[152:155], v[204:207], a[40:43], a[152:155]
    v_mfma_f32_16x16x32_bf16 a[156:159], v[204:207], a[44:47], a[156:159]
    ds_read_b128 v[196:199], v6 offset:51712
    v_mfma_f32_16x16x32_bf16 a[160:163], v[208:211], a[40:43], a[160:163]
    v_mfma_f32_16x16x32_bf16 a[164:167], v[208:211], a[44:47], a[164:167]
    ds_read_b128 v[200:203], v6 offset:52736
    v_mfma_f32_16x16x32_bf16 a[168:171], v[212:215], a[40:43], a[168:171]
    v_mfma_f32_16x16x32_bf16 a[172:175], v[212:215], a[44:47], a[172:175]
    ds_read_b128 v[204:207], v6 offset:53760
    v_mfma_f32_16x16x32_bf16 a[176:179], v[216:219], a[40:43], a[176:179]
    v_mfma_f32_16x16x32_bf16 a[180:183], v[216:219], a[44:47], a[180:183]
    ds_read_b128 v[208:211], v6 offset:54784
    v_mfma_f32_16x16x32_bf16 a[184:187], v[220:223], a[40:43], a[184:187]
    v_mfma_f32_16x16x32_bf16 a[188:191], v[220:223], a[44:47], a[188:191]
    ds_read_b128 v[212:215], v6 offset:55808
    s_waitcnt vmcnt(18)
    v_mfma_f32_16x16x32_bf16 a[128:131], v[224:227], a[48:51], a[128:131]
    v_mfma_f32_16x16x32_bf16 a[132:135], v[224:227], a[52:55], a[132:135]
    ds_read_b128 v[216:219], v6 offset:56832
    v_mfma_f32_16x16x32_bf16 a[136:139], v[228:231], a[48:51], a[136:139]
    v_mfma_f32_16x16x32_bf16 a[140:143], v[228:231], a[52:55], a[140:143]
    ds_read_b128 v[220:223], v6 offset:57856
    v_mfma_f32_16x16x32_bf16 a[144:147], v[232:235], a[48:51], a[144:147]
    v_mfma_f32_16x16x32_bf16 a[148:151], v[232:235], a[52:55], a[148:151]
    ds_read_b128 v[224:227], v6 offset:58880
    v_mfma_f32_16x16x32_bf16 a[152:155], v[236:239], a[48:51], a[152:155]
    v_mfma_f32_16x16x32_bf16 a[156:159], v[236:239], a[52:55], a[156:159]
    ds_read_b128 v[228:231], v6 offset:59904
    v_mfma_f32_16x16x32_bf16 a[160:163], v[240:243], a[48:51], a[160:163]
    v_mfma_f32_16x16x32_bf16 a[164:167], v[240:243], a[52:55], a[164:167]
    ds_read_b128 v[232:235], v6 offset:60928
    v_mfma_f32_16x16x32_bf16 a[168:171], v[244:247], a[48:51], a[168:171]
    v_mfma_f32_16x16x32_bf16 a[172:175], v[244:247], a[52:55], a[172:175]
    ds_read_b128 v[236:239], v6 offset:61952
    v_mfma_f32_16x16x32_bf16 a[176:179], v[248:251], a[48:51], a[176:179]
    v_mfma_f32_16x16x32_bf16 a[180:183], v[248:251], a[52:55], a[180:183]
    ds_read_b128 v[240:243], v6 offset:62976
    v_mfma_f32_16x16x32_bf16 a[184:187], v[252:255], a[48:51], a[184:187]
    v_mfma_f32_16x16x32_bf16 a[188:191], v[252:255], a[52:55], a[188:191]
    ds_read_b128 v[244:247], v6 offset:64000
    s_waitcnt vmcnt(16)
    v_mfma_f32_16x16x32_bf16 a[128:131], a[192:195], a[56:59], a[128:131]
    v_mfma_f32_16x16x32_bf16 a[132:135], a[192:195], a[60:63], a[132:135]
    ds_read_b128 v[248:251], v6 offset:65024
    v_mfma_f32_16x16x32_bf16 a[136:139], a[196:199], a[56:59], a[136:139]
    v_mfma_f32_16x16x32_bf16 a[140:143], a[196:199], a[60:63], a[140:143]
    ds_read_b128 v[252:255], v7 offset:512
    v_mfma_f32_16x16x32_bf16 a[144:147], a[200:203], a[56:59], a[144:147]
    v_mfma_f32_16x16x32_bf16 a[148:151], a[200:203], a[60:63], a[148:151]
    v_mfma_f32_16x16x32_bf16 a[152:155], a[204:207], a[56:59], a[152:155]
    v_mfma_f32_16x16x32_bf16 a[156:159], a[204:207], a[60:63], a[156:159]
    v_mfma_f32_16x16x32_bf16 a[160:163], a[208:211], a[56:59], a[160:163]
    v_mfma_f32_16x16x32_bf16 a[164:167], a[208:211], a[60:63], a[164:167]
    v_mfma_f32_16x16x32_bf16 a[168:171], a[212:215], a[56:59], a[168:171]
    v_mfma_f32_16x16x32_bf16 a[172:175], a[212:215], a[60:63], a[172:175]
    v_mfma_f32_16x16x32_bf16 a[176:179], a[216:219], a[56:59], a[176:179]
    v_mfma_f32_16x16x32_bf16 a[180:183], a[216:219], a[60:63], a[180:183]
    v_mfma_f32_16x16x32_bf16 a[184:187], a[220:223], a[56:59], a[184:187]
    v_mfma_f32_16x16x32_bf16 a[188:191], a[220:223], a[60:63], a[188:191]
    s_waitcnt vmcnt(14)
    v_mfma_f32_16x16x32_bf16 a[128:131], a[224:227], a[64:67], a[128:131]
    v_mfma_f32_16x16x32_bf16 a[132:135], a[224:227], a[68:71], a[132:135]
    v_mfma_f32_16x16x32_bf16 a[136:139], a[228:231], a[64:67], a[136:139]
    v_mfma_f32_16x16x32_bf16 a[140:143], a[228:231], a[68:71], a[140:143]
    v_mfma_f32_16x16x32_bf16 a[144:147], a[232:235], a[64:67], a[144:147]
    v_mfma_f32_16x16x32_bf16 a[148:151], a[232:235], a[68:71], a[148:151]
    v_mfma_f32_16x16x32_bf16 a[152:155], a[236:239], a[64:67], a[152:155]
    v_mfma_f32_16x16x32_bf16 a[156:159], a[236:239], a[68:71], a[156:159]
    v_mfma_f32_16x16x32_bf16 a[160:163], a[240:243], a[64:67], a[160:163]
    v_mfma_f32_16x16x32_bf16 a[164:167], a[240:243], a[68:71], a[164:167]
    v_mfma_f32_16x16x32_bf16 a[168:171], a[244:247], a[64:67], a[168:171]
    v_mfma_f32_16x16x32_bf16 a[172:175], a[244:247], a[68:71], a[172:175]
    v_mfma_f32_16x16x32_bf16 a[176:179], a[248:251], a[64:67], a[176:179]
    v_mfma_f32_16x16x32_bf16 a[180:183], a[248:251], a[68:71], a[180:183]
    v_mfma_f32_16x16x32_bf16 a[184:187], a[252:255], a[64:67], a[184:187]
    v_mfma_f32_16x16x32_bf16 a[188:191], a[252:255], a[68:71], a[188:191]
    s_waitcnt vmcnt(12)
    s_waitcnt lgkmcnt(15)
    v_mfma_f32_16x16x32_bf16 a[128:131], v[32:35], a[72:75], a[128:131]
    v_mfma_f32_16x16x32_bf16 a[132:135], v[32:35], a[76:79], a[132:135]
    v_mfma_f32_16x16x32_bf16 a[136:139], v[36:39], a[72:75], a[136:139]
    v_mfma_f32_16x16x32_bf16 a[140:143], v[36:39], a[76:79], a[140:143]
    v_mfma_f32_16x16x32_bf16 a[144:147], v[40:43], a[72:75], a[144:147]
    v_mfma_f32_16x16x32_bf16 a[148:151], v[40:43], a[76:79], a[148:151]
    v_mfma_f32_16x16x32_bf16 a[152:155], v[44:47], a[72:75], a[152:155]
    v_mfma_f32_16x16x32_bf16 a[156:159], v[44:47], a[76:79], a[156:159]
    v_mfma_f32_16x16x32_bf16 a[160:163], v[48:51], a[72:75], a[160:163]
    v_mfma_f32_16x16x32_bf16 a[164:167], v[48:51], a[76:79], a[164:167]
    v_mfma_f32_16x16x32_bf16 a[168:171], v[52:55], a[72:75], a[168:171]
    v_mfma_f32_16x16x32_bf16 a[172:175], v[52:55], a[76:79], a[172:175]
    v_mfma_f32_16x16x32_bf16 a[176:179], v[56:59], a[72:75], a[176:179]
    v_mfma_f32_16x16x32_bf16 a[180:183], v[56:59], a[76:79], a[180:183]
    v_mfma_f32_16x16x32_bf16 a[184:187], v[60:63], a[72:75], a[184:187]
    v_mfma_f32_16x16x32_bf16 a[188:191], v[60:63], a[76:79], a[188:191]
    s_waitcnt vmcnt(10)
    v_mfma_f32_16x16x32_bf16 a[128:131], v[64:67], a[80:83], a[128:131]
    v_mfma_f32_16x16x32_bf16 a[132:135], v[64:67], a[84:87], a[132:135]
    v_mfma_f32_16x16x32_bf16 a[136:139], v[68:71], a[80:83], a[136:139]
    v_mfma_f32_16x16x32_bf16 a[140:143], v[68:71], a[84:87], a[140:143]
    v_mfma_f32_16x16x32_bf16 a[144:147], v[72:75], a[80:83], a[144:147]
    v_mfma_f32_16x16x32_bf16 a[148:151], v[72:75], a[84:87], a[148:151]
    v_mfma_f32_16x16x32_bf16 a[152:155], v[76:79], a[80:83], a[152:155]
    v_mfma_f32_16x16x32_bf16 a[156:159], v[76:79], a[84:87], a[156:159]
    v_mfma_f32_16x16x32_bf16 a[160:163], v[80:83], a[80:83], a[160:163]
    v_mfma_f32_16x16x32_bf16 a[164:167], v[80:83], a[84:87], a[164:167]
    v_mfma_f32_16x16x32_bf16 a[168:171], v[84:87], a[80:83], a[168:171]
    v_mfma_f32_16x16x32_bf16 a[172:175], v[84:87], a[84:87], a[172:175]
    v_mfma_f32_16x16x32_bf16 a[176:179], v[88:91], a[80:83], a[176:179]
    v_mfma_f32_16x16x32_bf16 a[180:183], v[88:91], a[84:87], a[180:183]
    v_mfma_f32_16x16x32_bf16 a[184:187], v[92:95], a[80:83], a[184:187]
    v_mfma_f32_16x16x32_bf16 a[188:191], v[92:95], a[84:87], a[188:191]
    s_waitcnt vmcnt(8)
    v_mfma_f32_16x16x32_bf16 a[128:131], v[96:99], a[88:91], a[128:131]
    v_mfma_f32_16x16x32_bf16 a[132:135], v[96:99], a[92:95], a[132:135]
    v_mfma_f32_16x16x32_bf16 a[136:139], v[100:103], a[88:91], a[136:139]
    v_mfma_f32_16x16x32_bf16 a[140:143], v[100:103], a[92:95], a[140:143]
    v_mfma_f32_16x16x32_bf16 a[144:147], v[104:107], a[88:91], a[144:147]
    v_mfma_f32_16x16x32_bf16 a[148:151], v[104:107], a[92:95], a[148:151]
    v_mfma_f32_16x16x32_bf16 a[152:155], v[108:111], a[88:91], a[152:155]
    v_mfma_f32_16x16x32_bf16 a[156:159], v[108:111], a[92:95], a[156:159]
    v_mfma_f32_16x16x32_bf16 a[160:163], v[112:115], a[88:91], a[160:163]
    v_mfma_f32_16x16x32_bf16 a[164:167], v[112:115], a[92:95], a[164:167]
    v_mfma_f32_16x16x32_bf16 a[168:171], v[116:119], a[88:91], a[168:171]
    v_mfma_f32_16x16x32_bf16 a[172:175], v[116:119], a[92:95], a[172:175]
    v_mfma_f32_16x16x32_bf16 a[176:179], v[120:123], a[88:91], a[176:179]
    v_mfma_f32_16x16x32_bf16 a[180:183], v[120:123], a[92:95], a[180:183]
    v_mfma_f32_16x16x32_bf16 a[184:187], v[124:127], a[88:91], a[184:187]
    v_mfma_f32_16x16x32_bf16 a[188:191], v[124:127], a[92:95], a[188:191]
    s_waitcnt vmcnt(6)
    v_mfma_f32_16x16x32_bf16 a[128:131], v[128:131], a[96:99], a[128:131]
    v_mfma_f32_16x16x32_bf16 a[132:135], v[128:131], a[100:103], a[132:135]
    v_mfma_f32_16x16x32_bf16 a[136:139], v[132:135], a[96:99], a[136:139]
    v_mfma_f32_16x16x32_bf16 a[140:143], v[132:135], a[100:103], a[140:143]
    v_mfma_f32_16x16x32_bf16 a[144:147], v[136:139], a[96:99], a[144:147]
    v_mfma_f32_16x16x32_bf16 a[148:151], v[136:139], a[100:103], a[148:151]
    v_mfma_f32_16x16x32_bf16 a[152:155], v[140:143], a[96:99], a[152:155]
    v_mfma_f32_16x16x32_bf16 a[156:159], v[140:143], a[100:103], a[156:159]
    v_mfma_f32_16x16x32_bf16 a[160:163], v[144:147], a[96:99], a[160:163]
    v_mfma_f32_16x16x32_bf16 a[164:167], v[144:147], a[100:103], a[164:167]
    v_mfma_f32_16x16x32_bf16 a[168:171], v[148:151], a[96:99], a[168:171]
    v_mfma_f32_16x16x32_bf16 a[172:175], v[148:151], a[100:103], a[172:175]
    v_mfma_f32_16x16x32_bf16 a[176:179], v[152:155], a[96:99], a[176:179]
    v_mfma_f32_16x16x32_bf16 a[180:183], v[152:155], a[100:103], a[180:183]
    v_mfma_f32_16x16x32_bf16 a[184:187], v[156:159], a[96:99], a[184:187]
    v_mfma_f32_16x16x32_bf16 a[188:191], v[156:159], a[100:103], a[188:191]
    s_waitcnt vmcnt(4)
    v_mfma_f32_16x16x32_bf16 a[128:131], v[160:163], a[104:107], a[128:131]
    v_mfma_f32_16x16x32_bf16 a[132:135], v[160:163], a[108:111], a[132:135]
    v_mfma_f32_16x16x32_bf16 a[136:139], v[164:167], a[104:107], a[136:139]
    v_mfma_f32_16x16x32_bf16 a[140:143], v[164:167], a[108:111], a[140:143]
    v_mfma_f32_16x16x32_bf16 a[144:147], v[168:171], a[104:107], a[144:147]
    v_mfma_f32_16x16x32_bf16 a[148:151], v[168:171], a[108:111], a[148:151]
    v_mfma_f32_16x16x32_bf16 a[152:155], v[172:175], a[104:107], a[152:155]
    v_mfma_f32_16x16x32_bf16 a[156:159], v[172:175], a[108:111], a[156:159]
    v_mfma_f32_16x16x32_bf16 a[160:163], v[176:179], a[104:107], a[160:163]
    v_mfma_f32_16x16x32_bf16 a[164:167], v[176:179], a[108:111], a[164:167]
    v_mfma_f32_16x16x32_bf16 a[168:171], v[180:183], a[104:107], a[168:171]
    v_mfma_f32_16x16x32_bf16 a[172:175], v[180:183], a[108:111], a[172:175]
    v_mfma_f32_16x16x32_bf16 a[176:179], v[184:187], a[104:107], a[176:179]
    v_mfma_f32_16x16x32_bf16 a[180:183], v[184:187], a[108:111], a[180:183]
    v_mfma_f32_16x16x32_bf16 a[184:187], v[188:191], a[104:107], a[184:187]
    v_mfma_f32_16x16x32_bf16 a[188:191], v[188:191], a[108:111], a[188:191]
    s_waitcnt vmcnt(2)
    v_mfma_f32_16x16x32_bf16 a[128:131], v[192:195], a[112:115], a[128:131]
    v_mfma_f32_16x16x32_bf16 a[132:135], v[192:195], a[116:119], a[132:135]
    s_waitcnt lgkmcnt(14)
    v_mfma_f32_16x16x32_bf16 a[136:139], v[196:199], a[112:115], a[136:139]
    v_mfma_f32_16x16x32_bf16 a[140:143], v[196:199], a[116:119], a[140:143]
    s_waitcnt lgkmcnt(13)
    v_mfma_f32_16x16x32_bf16 a[144:147], v[200:203], a[112:115], a[144:147]
    v_mfma_f32_16x16x32_bf16 a[148:151], v[200:203], a[116:119], a[148:151]
    s_waitcnt lgkmcnt(12)
    v_mfma_f32_16x16x32_bf16 a[152:155], v[204:207], a[112:115], a[152:155]
    v_mfma_f32_16x16x32_bf16 a[156:159], v[204:207], a[116:119], a[156:159]
    s_waitcnt lgkmcnt(11)
    v_mfma_f32_16x16x32_bf16 a[160:163], v[208:211], a[112:115], a[160:163]
    v_mfma_f32_16x16x32_bf16 a[164:167], v[208:211], a[116:119], a[164:167]
    s_waitcnt lgkmcnt(10)
    v_mfma_f32_16x16x32_bf16 a[168:171], v[212:215], a[112:115], a[168:171]
    v_mfma_f32_16x16x32_bf16 a[172:175], v[212:215], a[116:119], a[172:175]
    s_waitcnt lgkmcnt(9)
    v_mfma_f32_16x16x32_bf16 a[176:179], v[216:219], a[112:115], a[176:179]
    v_mfma_f32_16x16x32_bf16 a[180:183], v[216:219], a[116:119], a[180:183]
    s_waitcnt lgkmcnt(8)
    v_mfma_f32_16x16x32_bf16 a[184:187], v[220:223], a[112:115], a[184:187]
    v_mfma_f32_16x16x32_bf16 a[188:191], v[220:223], a[116:119], a[188:191]
    s_waitcnt vmcnt(0)
    s_waitcnt lgkmcnt(7)
    v_mfma_f32_16x16x32_bf16 a[128:131], v[224:227], a[120:123], a[128:131]
    v_mfma_f32_16x16x32_bf16 a[132:135], v[224:227], a[124:127], a[132:135]
    s_waitcnt lgkmcnt(6)
    v_mfma_f32_16x16x32_bf16 a[136:139], v[228:231], a[120:123], a[136:139]
    v_mfma_f32_16x16x32_bf16 a[140:143], v[228:231], a[124:127], a[140:143]
    s_waitcnt lgkmcnt(5)
    v_mfma_f32_16x16x32_bf16 a[144:147], v[232:235], a[120:123], a[144:147]
    v_mfma_f32_16x16x32_bf16 a[148:151], v[232:235], a[124:127], a[148:151]
    s_waitcnt lgkmcnt(4)
    v_mfma_f32_16x16x32_bf16 a[152:155], v[236:239], a[120:123], a[152:155]
    v_mfma_f32_16x16x32_bf16 a[156:159], v[236:239], a[124:127], a[156:159]
    s_waitcnt lgkmcnt(3)
    v_mfma_f32_16x16x32_bf16 a[160:163], v[240:243], a[120:123], a[160:163]
    v_mfma_f32_16x16x32_bf16 a[164:167], v[240:243], a[124:127], a[164:167]
    s_waitcnt lgkmcnt(2)
    v_mfma_f32_16x16x32_bf16 a[168:171], v[244:247], a[120:123], a[168:171]
    v_mfma_f32_16x16x32_bf16 a[172:175], v[244:247], a[124:127], a[172:175]
    s_waitcnt lgkmcnt(1)
    v_mfma_f32_16x16x32_bf16 a[176:179], v[248:251], a[120:123], a[176:179]
    v_mfma_f32_16x16x32_bf16 a[180:183], v[248:251], a[124:127], a[180:183]
    s_waitcnt lgkmcnt(0)
    v_mfma_f32_16x16x32_bf16 a[184:187], v[252:255], a[120:123], a[184:187]
    v_mfma_f32_16x16x32_bf16 a[188:191], v[252:255], a[124:127], a[188:191]
    v_accvgpr_read_b32 v64, a128
    v_accvgpr_read_b32 v65, a136
    v_accvgpr_read_b32 v66, a144
    v_accvgpr_read_b32 v67, a152
    v_accvgpr_read_b32 v68, a160
    v_accvgpr_read_b32 v69, a168
    v_accvgpr_read_b32 v70, a176
    v_accvgpr_read_b32 v71, a184
    s_mov_b32 s7, 0x0
    v_cvt_pk_bf16_f32 v64, v64, v65
    v_cvt_pk_bf16_f32 v65, v66, v67
    v_cvt_pk_bf16_f32 v66, v68, v69
    v_cvt_pk_bf16_f32 v67, v70, v71
    buffer_store_dwordx4 v[64:67], v0, s[48:51], s7 offen sc1
    v_accvgpr_read_b32 v72, a129
    v_accvgpr_read_b32 v73, a137
    v_accvgpr_read_b32 v74, a145
    v_accvgpr_read_b32 v75, a153
    v_accvgpr_read_b32 v76, a161
    v_accvgpr_read_b32 v77, a169
    v_accvgpr_read_b32 v78, a177
    v_accvgpr_read_b32 v79, a185
    s_mov_b32 s7, 0x800
    v_cvt_pk_bf16_f32 v72, v72, v73
    v_cvt_pk_bf16_f32 v73, v74, v75
    v_cvt_pk_bf16_f32 v74, v76, v77
    v_cvt_pk_bf16_f32 v75, v78, v79
    buffer_store_dwordx4 v[72:75], v0, s[48:51], s7 offen sc1
    v_accvgpr_read_b32 v80, a130
    v_accvgpr_read_b32 v81, a138
    v_accvgpr_read_b32 v82, a146
    v_accvgpr_read_b32 v83, a154
    v_accvgpr_read_b32 v84, a162
    v_accvgpr_read_b32 v85, a170
    v_accvgpr_read_b32 v86, a178
    v_accvgpr_read_b32 v87, a186
    s_mov_b32 s7, 0x1000
    v_cvt_pk_bf16_f32 v80, v80, v81
    v_cvt_pk_bf16_f32 v81, v82, v83
    v_cvt_pk_bf16_f32 v82, v84, v85
    v_cvt_pk_bf16_f32 v83, v86, v87
    buffer_store_dwordx4 v[80:83], v0, s[48:51], s7 offen sc1
    v_accvgpr_read_b32 v88, a131
    v_accvgpr_read_b32 v89, a139
    v_accvgpr_read_b32 v90, a147
    v_accvgpr_read_b32 v91, a155
    v_accvgpr_read_b32 v92, a163
    v_accvgpr_read_b32 v93, a171
    v_accvgpr_read_b32 v94, a179
    v_accvgpr_read_b32 v95, a187
    s_mov_b32 s7, 0x1800
    v_cvt_pk_bf16_f32 v88, v88, v89
    v_cvt_pk_bf16_f32 v89, v90, v91
    v_cvt_pk_bf16_f32 v90, v92, v93
    v_cvt_pk_bf16_f32 v91, v94, v95
    buffer_store_dwordx4 v[88:91], v0, s[48:51], s7 offen sc1
    v_accvgpr_read_b32 v96, a132
    v_accvgpr_read_b32 v97, a140
    v_accvgpr_read_b32 v98, a148
    v_accvgpr_read_b32 v99, a156
    v_accvgpr_read_b32 v100, a164
    v_accvgpr_read_b32 v101, a172
    v_accvgpr_read_b32 v102, a180
    v_accvgpr_read_b32 v103, a188
    s_mov_b32 s7, 0x2000
    v_cvt_pk_bf16_f32 v96, v96, v97
    v_cvt_pk_bf16_f32 v97, v98, v99
    v_cvt_pk_bf16_f32 v98, v100, v101
    v_cvt_pk_bf16_f32 v99, v102, v103
    buffer_store_dwordx4 v[96:99], v0, s[48:51], s7 offen sc1
    v_accvgpr_read_b32 v104, a133
    v_accvgpr_read_b32 v105, a141
    v_accvgpr_read_b32 v106, a149
    v_accvgpr_read_b32 v107, a157
    v_accvgpr_read_b32 v108, a165
    v_accvgpr_read_b32 v109, a173
    v_accvgpr_read_b32 v110, a181
    v_accvgpr_read_b32 v111, a189
    s_mov_b32 s7, 0x2800
    v_cvt_pk_bf16_f32 v104, v104, v105
    v_cvt_pk_bf16_f32 v105, v106, v107
    v_cvt_pk_bf16_f32 v106, v108, v109
    v_cvt_pk_bf16_f32 v107, v110, v111
    buffer_store_dwordx4 v[104:107], v0, s[48:51], s7 offen sc1
    v_accvgpr_read_b32 v112, a134
    v_accvgpr_read_b32 v113, a142
    v_accvgpr_read_b32 v114, a150
    v_accvgpr_read_b32 v115, a158
    v_accvgpr_read_b32 v116, a166
    v_accvgpr_read_b32 v117, a174
    v_accvgpr_read_b32 v118, a182
    v_accvgpr_read_b32 v119, a190
    s_mov_b32 s7, 0x3000
    v_cvt_pk_bf16_f32 v112, v112, v113
    v_cvt_pk_bf16_f32 v113, v114, v115
    v_cvt_pk_bf16_f32 v114, v116, v117
    v_cvt_pk_bf16_f32 v115, v118, v119
    buffer_store_dwordx4 v[112:115], v0, s[48:51], s7 offen sc1
    v_accvgpr_read_b32 v120, a135
    v_accvgpr_read_b32 v121, a143
    v_accvgpr_read_b32 v122, a151
    v_accvgpr_read_b32 v123, a159
    v_accvgpr_read_b32 v124, a167
    v_accvgpr_read_b32 v125, a175
    v_accvgpr_read_b32 v126, a183
    v_accvgpr_read_b32 v127, a191
    s_mov_b32 s7, 0x3800
    v_cvt_pk_bf16_f32 v120, v120, v121
    v_cvt_pk_bf16_f32 v121, v122, v123
    v_cvt_pk_bf16_f32 v122, v124, v125
    v_cvt_pk_bf16_f32 v123, v126, v127
    buffer_store_dwordx4 v[120:123], v0, s[48:51], s7 offen sc1
    s_waitcnt vmcnt(0)
    v_mov_b32 v10, 1
    s_mov_b64 exec, 1
    buffer_store_dword v10, v8, s[68:71], s81 offen sc1
    s_mov_b64 exec, -1
    s_cmp_lg_u32 s84, 0
    s_cbranch_scc1 FINISH
    s_waitcnt vmcnt(0) lgkmcnt(0)
RLOOP:
    s_nop 7
    s_lshr_b32 s90, s2, 3
    s_add_u32 s90, s90, s84
    s_and_b32 s87, s2, 7
    s_lshl_b32 s6, s90, 19
    s_lshl_b32 s7, s87, 2
    s_add_u32 s7, s7, s3
    s_lshl_b32 s7, s7, 11
    s_add_u32 s6, s6, s7
    s_add_u32 s6, s6, 0x1000000
    s_sub_u32 s7, 0x80000, s7
    s_add_u32 s44, s32, s6
    s_addc_u32 s45, s33, 0
    s_and_b32 s45, s45, 0xffff
    s_mov_b32 s46, s7
    s_mov_b32 s47, 0x20000
    s_lshl_b32 s6, s90, 2
    s_lshr_b32 s7, s87, 1
    s_add_u32 s6, s6, s7
    s_lshl_b32 s6, s6, 7
    s_add_u32 s85, s6, 32768
    s_and_b32 s6, s90, 15
    s_lshl_b32 s6, s6, 16
    s_lshr_b32 s7, s90, 4
    s_lshl_b32 s7, s7, 10
    s_add_u32 s6, s6, s7
    s_lshr_b32 s7, s87, 1
    s_lshl_b32 s7, s7, 8
    s_add_u32 s6, s6, s7
    s_and_b32 s7, s87, 1
    s_lshl_b32 s7, s7, 15
    s_add_u32 s6, s6, s7
    s_lshl_b32 s7, s3, 4
    s_add_u32 s6, s6, s7
    s_sub_u32 s7, 0x100000, s6
    s_add_u32 s76, s28, s6
    s_addc_u32 s77, s29, 0
    s_and_b32 s77, s77, 0xffff
    s_mov_b32 s78, s7
    s_mov_b32 s79, 0x20000
    v_lshrrev_b32 v12, 4, v0
    v_and_b32 v13, 15, v12
    v_lshrrev_b32 v12, 4, v12
    v_lshlrev_b32 v13, 11, v13
    v_lshl_add_u32 v13, v12, 6, v13
    s_waitcnt vmcnt(0) lgkmcnt(0)
    s_cmp_eq_u32 s3, 0
    s_cbranch_scc0 NOPOLL4
    s_mov_b32 s100, 0x1
    s_mov_b32 s101, 20000
    s_mov_b64 exec, 0xff
    s_nop 4
PG5:
    buffer_load_dword v10, v9, s[68:71], s85 offen sc1
    s_waitcnt vmcnt(0)
    v_cmp_ne_u32 vcc, s100, v10
    s_nop 4
    s_cmp_eq_u64 vcc, 0
    s_cbranch_scc1 PG5_done
    s_sleep 2
    s_sub_u32 s101, s101, 1
    s_cbranch_scc0 PG5
PG5_done:
    s_mov_b64 exec, -1
NOPOLL4:
    s_barrier
    s_mov_b32 s97, 0x0
    buffer_load_dwordx4 v[72:75], v0, s[44:47], s97 offen sc1
    s_mov_b32 s97, 0x10000
    buffer_load_dwordx4 v[76:79], v0, s[44:47], s97 offen sc1
    s_mov_b32 s97, 0x20000
    buffer_load_dwordx4 v[80:83], v0, s[44:47], s97 offen sc1
    s_mov_b32 s97, 0x30000
    buffer_load_dwordx4 v[84:87], v0, s[44:47], s97 offen sc1
    s_mov_b32 s97, 0x40000
    buffer_load_dwordx4 v[88:91], v0, s[44:47], s97 offen sc1
    s_mov_b32 s97, 0x50000
    buffer_load_dwordx4 v[92:95], v0, s[44:47], s97 offen sc1
    s_mov_b32 s97, 0x60000
    buffer_load_dwordx4 v[96:99], v0, s[44:47], s97 offen sc1
    s_mov_b32 s97, 0x70000
    buffer_load_dwordx4 v[100:103], v0, s[44:47], s97 offen sc1
    s_waitcnt vmcnt(7)
    v_lshlrev_b32 v64, 16, v72
    v_and_b32 v65, 0xffff0000, v72
    v_lshlrev_b32 v66, 16, v73
    v_and_b32 v67, 0xffff0000, v73
    v_lshlrev_b32 v68, 16, v74
    v_and_b32 v69, 0xffff0000, v74
    v_lshlrev_b32 v70, 16, v75
    v_and_b32 v71, 0xffff0000, v75
    s_waitcnt vmcnt(6)
    v_lshlrev_b32 v14, 16, v76
    v_and_b32 v15, 0xffff0000, v76
    v_add_f32 v64, v64, v14
    v_add_f32 v65, v65, v15
    v_lshlrev_b32 v14, 16, v77
    v_and_b32 v15, 0xffff0000, v77
    v_add_f32 v66, v66, v14
    v_add_f32 v67, v67, v15
    v_lshlrev_b32 v14, 16, v78
    v_and_b32 v15, 0xffff0000, v78
    v_add_f32 v68, v68, v14
    v_add_f32 v69, v69, v15
    v_lshlrev_b32 v14, 16, v79
    v_and_b32 v15, 0xffff0000, v79
    v_add_f32 v70, v70, v14
    v_add_f32 v71, v71, v15
    s_waitcnt vmcnt(5)
    v_lshlrev_b32 v14, 16, v80
    v_and_b32 v15, 0xffff0000, v80
    v_add_f32 v64, v64, v14
    v_add_f32 v65, v65, v15
    v_lshlrev_b32 v14, 16, v81
    v_and_b32 v15, 0xffff0000, v81
    v_add_f32 v66, v66, v14
    v_add_f32 v67, v67, v15
    v_lshlrev_b32 v14, 16, v82
    v_and_b32 v15, 0xffff0000, v82
    v_add_f32 v68, v68, v14
    v_add_f32 v69, v69, v15
    v_lshlrev_b32 v14, 16, v83
    v_and_b32 v15, 0xffff0000, v83
    v_add_f32 v70, v70, v14
    v_add_f32 v71, v71, v15
    s_waitcnt vmcnt(4)
    v_lshlrev_b32 v14, 16, v84
    v_and_b32 v15, 0xffff0000, v84
    v_add_f32 v64, v64, v14
    v_add_f32 v65, v65, v15
    v_lshlrev_b32 v14, 16, v85
    v_and_b32 v15, 0xffff0000, v85
    v_add_f32 v66, v66, v14
    v_add_f32 v67, v67, v15
    v_lshlrev_b32 v14, 16, v86
    v_and_b32 v15, 0xffff0000, v86
    v_add_f32 v68, v68, v14
    v_add_f32 v69, v69, v15
    v_lshlrev_b32 v14, 16, v87
    v_and_b32 v15, 0xffff0000, v87
    v_add_f32 v70, v70, v14
    v_add_f32 v71, v71, v15
    s_waitcnt vmcnt(3)
    v_lshlrev_b32 v14, 16, v88
    v_and_b32 v15, 0xffff0000, v88
    v_add_f32 v64, v64, v14
    v_add_f32 v65, v65, v15
    v_lshlrev_b32 v14, 16, v89
    v_and_b32 v15, 0xffff0000, v89
    v_add_f32 v66, v66, v14
    v_add_f32 v67, v67, v15
    v_lshlrev_b32 v14, 16, v90
    v_and_b32 v15, 0xffff0000, v90
    v_add_f32 v68, v68, v14
    v_add_f32 v69, v69, v15
    v_lshlrev_b32 v14, 16, v91
    v_and_b32 v15, 0xffff0000, v91
    v_add_f32 v70, v70, v14
    v_add_f32 v71, v71, v15
    s_waitcnt vmcnt(2)
    v_lshlrev_b32 v14, 16, v92
    v_and_b32 v15, 0xffff0000, v92
    v_add_f32 v64, v64, v14
    v_add_f32 v65, v65, v15
    v_lshlrev_b32 v14, 16, v93
    v_and_b32 v15, 0xffff0000, v93
    v_add_f32 v66, v66, v14
    v_add_f32 v67, v67, v15
    v_lshlrev_b32 v14, 16, v94
    v_and_b32 v15, 0xffff0000, v94
    v_add_f32 v68, v68, v14
    v_add_f32 v69, v69, v15
    v_lshlrev_b32 v14, 16, v95
    v_and_b32 v15, 0xffff0000, v95
    v_add_f32 v70, v70, v14
    v_add_f32 v71, v71, v15
    s_waitcnt vmcnt(1)
    v_lshlrev_b32 v14, 16, v96
    v_and_b32 v15, 0xffff0000, v96
    v_add_f32 v64, v64, v14
    v_add_f32 v65, v65, v15
    v_lshlrev_b32 v14, 16, v97
    v_and_b32 v15, 0xffff0000, v97
    v_add_f32 v66, v66, v14
    v_add_f32 v67, v67, v15
    v_lshlrev_b32 v14, 16, v98
    v_and_b32 v15, 0xffff0000, v98
    v_add_f32 v68, v68, v14
    v_add_f32 v69, v69, v15
    v_lshlrev_b32 v14, 16, v99
    v_and_b32 v15, 0xffff0000, v99
    v_add_f32 v70, v70, v14
    v_add_f32 v71, v71, v15
    s_waitcnt vmcnt(0)
    v_lshlrev_b32 v14, 16, v100
    v_and_b32 v15, 0xffff0000, v100
    v_add_f32 v64, v64, v14
    v_add_f32 v65, v65, v15
    v_lshlrev_b32 v14, 16, v101
    v_and_b32 v15, 0xffff0000, v101
    v_add_f32 v66, v66, v14
    v_add_f32 v67, v67, v15
    v_lshlrev_b32 v14, 16, v102
    v_and_b32 v15, 0xffff0000, v102
    v_add_f32 v68, v68, v14
    v_add_f32 v69, v69, v15
    v_lshlrev_b32 v14, 16, v103
    v_and_b32 v15, 0xffff0000, v103
    v_add_f32 v70, v70, v14
    v_add_f32 v71, v71, v15
    v_cvt_pk_bf16_f32 v64, v64, v65
    v_cvt_pk_bf16_f32 v65, v66, v67
    v_cvt_pk_bf16_f32 v66, v68, v69
    v_cvt_pk_bf16_f32 v67, v70, v71
    buffer_store_dwordx4 v[64:67], v13, s[76:79], 0 offen
    s_waitcnt vmcnt(0) lgkmcnt(0)
    s_add_u32 s84, s84, 16
    s_cmp_lt_u32 s84, 32
    s_cbranch_scc1 RLOOP
FINISH:
    s_nop 7
K_END:
    s_endpgm
.section .rodata,"a"
.p2align 6
.amdhsa_kernel concat_heads__gqa_block_cached__mha_block_cached__near_ridge_kernel
  .amdhsa_next_free_vgpr 512
  .amdhsa_next_free_sgpr 102
  .amdhsa_accum_offset 256
  .amdhsa_group_segment_fixed_size 0
  .amdhsa_kernarg_size 104
  .amdhsa_user_sgpr_count 2
  .amdhsa_user_sgpr_kernarg_segment_ptr 1
  .amdhsa_system_sgpr_workgroup_id_x 1
.end_amdhsa_kernel
```
